```python
import torch

def _softmax(x, axis=-1):
    return torch.softmax(x, dim=axis)
def _gelu(x):
    return torch.nn.functional.gelu(x, approximate="tanh")
def _silu(x):
    return torch.nn.functional.silu(x)
def _sigmoid(x):
    return torch.sigmoid(x)
def _layernorm(x, axis=-1, eps=1e-5):
    m = x.mean(dim=axis, keepdim=True)
    v = x.var(dim=axis, keepdim=True, unbiased=False)
    return (x - m) / torch.sqrt(v + eps)
def _scatter_add(tgt, idx, src, axis=0):
    return tgt.clone().index_add_(axis, idx, src)
def _segment_sum(src, seg, n):
    out = torch.zeros((n,) + src.shape[1:], dtype=src.dtype)
    return out.index_add_(0, seg, src)
def _pad(x, pw):
    flat = tuple(v for pair in reversed(pw) for v in pair)
    return torch.nn.functional.pad(x, flat)

kernel_name = 'interleave_layers__linear_kernel_hedgehog__mixer_channel_mlp__prompt'

def setup_inputs():

    _w = (lambda a: (lambda t: t.to(torch.bfloat16) if t.is_floating_point() else t)(torch.as_tensor(a)))
    def _A_setup():
        B, S, D, H = 1, 2048, 640, 32
        Dh = D // H
        return {
            "x": _w((lambda *s: torch.randn(*s, dtype=torch.bfloat16) * 0.05)(B, S, D)),
            "wqkv": _w((lambda *s: torch.randn(*s, dtype=torch.bfloat16) * 0.4)(D, 3 * D)),
            "w_phi": _w((lambda *s: torch.randn(*s, dtype=torch.bfloat16) * 0.4)(H, Dh, Dh) * (Dh ** -0.5)),
            "wo": _w((lambda *s: torch.randn(*s, dtype=torch.bfloat16) * 0.05)(D, D)),
        }
    _A_in = _A_setup()

    def _B_setup():
        B, S, D, F = 1, 2048, 640, 1728
        return {
            "x": _w((lambda *s: torch.randn(*s, dtype=torch.bfloat16) * 0.05)(B, S, D)),
            "w1": _w((lambda *s: torch.randn(*s, dtype=torch.bfloat16) * 3.2)(D, F) * (D ** -0.5)),
            "b1": _w((lambda *s: torch.randn(*s, dtype=torch.bfloat16) * 1.6)(F)),
            "w2": _w((lambda *s: torch.randn(*s, dtype=torch.bfloat16) * 1.6)(F, D) * (F ** -0.5)),
            "b2": _w((lambda *s: torch.randn(*s, dtype=torch.bfloat16) * 1.6)(D)),
        }
    _B_in = _B_setup()

    return {
        "A_x": _A_in["x"],
        "A_wqkv": _A_in["wqkv"],
        "A_w_phi": _A_in["w_phi"],
        "A_wo": _A_in["wo"],
        "B_x": _B_in["x"],
        "B_w1": _B_in["w1"],
        "B_b1": _B_in["b1"],
        "B_w2": _B_in["w2"],
        "B_b2": _B_in["b2"],
    }

def reference(A_x, A_wqkv, A_w_phi, A_wo, B_x, B_w1, B_b1, B_w2, B_b2):
    def _A_ref(x, wqkv, w_phi, wo):
        B, S, D = x.shape
        H = 32; Dh = D // H
        qkv = (lambda x, *d: x.permute(*d))((x @ wqkv).reshape(B, S, 3, H, Dh), 2, 0, 3, 1, 4)
        q, k, v = qkv[0], qkv[1], qkv[2]
        pq = torch.einsum("bhsd,hdf->bhsf", q, w_phi)
        pk = torch.einsum("bhsd,hdf->bhsf", k, w_phi)
        phi_q = torch.concatenate([_softmax(pq, axis=-1), _softmax(-pq, axis=-1)], axis=-1)
        phi_k = torch.concatenate([_softmax(pk, axis=-1), _softmax(-pk, axis=-1)], axis=-1)
        kv = torch.einsum("bhsf,bhsd->bhfd", phi_k, v)
        z  = torch.einsum("bhsf->bhf", phi_k)
        num = torch.einsum("bhqf,bhfd->bhqd", phi_q, kv)
        den = torch.einsum("bhqf,bhf->bhq", phi_q, z)[..., None] + 1e-6
        o = num / den
        return (lambda x, *d: x.permute(*d))(o, 0, 2, 1, 3).reshape(B, S, D) @ wo

    def _B_ref(x, w1, b1, w2, b2):
        y = _layernorm(x, axis=-1)
        h = _gelu(torch.einsum("bsd,df->bsf", y, w1) + b1)
        return torch.einsum("bsf,fd->bsd", h, w2) + b2

    x = A_x
    x = x + _A_ref(_layernorm(x, axis=-1), A_wqkv, A_w_phi, A_wo)
    x = x + _B_ref(_layernorm(x, axis=-1), B_w1, B_b1, B_w2, B_b2)
    x = x + _A_ref(_layernorm(x, axis=-1), A_wqkv, A_w_phi, A_wo)
    x = x + _B_ref(_layernorm(x, axis=-1), B_w1, B_b1, B_w2, B_b2)
    return x
```

```asm
; @launch grid=(256,1,1) block=(512,1,1) lds=163840
.amdgcn_target "amdgcn-amd-amdhsa--gfx950"
.text
.globl interleave_layers__linear_kernel_hedgehog__mixer_channel_mlp__prompt_kernel
.p2align 8
.type interleave_layers__linear_kernel_hedgehog__mixer_channel_mlp__prompt_kernel,@function
interleave_layers__linear_kernel_hedgehog__mixer_channel_mlp__prompt_kernel:
  s_cmp_ge_u32 s2, 256
  s_cbranch_scc1 main_done
  s_load_dwordx8 s[4:11], s[0:1], 0
  s_load_dwordx4 s[12:15], s[0:1], 40
  s_load_dwordx8 s[44:51], s[0:1], 56
  s_load_dwordx2 s[52:53], s[0:1], 88
  s_getreg_b32 s42, hwreg(HW_REG_XCC_ID)
  v_and_b32 v1, 63, v0
  v_lshrrev_b32 v2, 6, v0
  v_and_b32 v3, 15, v1
  v_readfirstlane_b32 s18, v2
  v_lshrrev_b32 v4, 4, v1
  v_lshlrev_b32 v5, 4, v1
  v_add_u32 v6, 0x10000, v5
  s_and_b32 s42, s42, 7
  s_mov_b32 s19, 0
  v_and_b32 v8, 7, v1
  v_lshrrev_b32 v9, 3, v1
  v_mul_u32_u24 v10, 1280, v8
  v_lshlrev_b32 v11, 4, v9
  v_add_u32 v10, v10, v11
  v_mov_b32 v7, 0x80000000
  v_cmp_gt_u32 s[54:55], 2, v9
  v_add_u32 v11, 128, v10
  s_mul_i32 s56, s2, 10240
  v_cndmask_b32 v11, v7, v11, s[54:55]
  s_mul_i32 s57, s18, 160
  s_add_u32 s56, s56, s57
  s_waitcnt lgkmcnt(0)
  s_mov_b32 s36, s4
  s_and_b32 s37, s5, 0xffff
  s_mov_b32 s38, 0x280000
  s_mov_b32 s39, 0x20000
  s_mov_b32 s20, s52
  s_and_b32 s21, s53, 0xffff
  s_mov_b32 s22, 0x2000000
  s_mov_b32 s23, 0x20000
  s_lshl_b32 s57, s42, 7
  s_add_u32 s57, s57, 0x1490000
  v_mov_b32 v168, 0
  buffer_load_dwordx2 v[166:167], v168, s[20:23], s57 offen sc0 sc1
  s_cmp_lg_u32 s18, 0
  s_cbranch_scc1 pr_nocnt0
  v_mov_b32 v169, 163616
  ds_write_b32 v169, v168
pr_nocnt0:
  buffer_load_dwordx4 v[12:15], v10, s[36:39], s56 offen
  buffer_load_dwordx4 v[16:19], v11, s[36:39], s56 offen
  s_mov_b32 s24, s14
  s_and_b32 s25, s15, 0xffff
  s_mov_b32 s26, 0xd80
  s_mov_b32 s27, 0x20000
  s_mov_b32 s28, s46
  s_and_b32 s29, s47, 0xffff
  s_mov_b32 s30, 0x500
  s_mov_b32 s31, 0x20000
  s_mov_b32 s32, s48
  s_and_b32 s33, s49, 0xffff
  s_mov_b32 s34, 0x280000
  s_mov_b32 s35, 0x20000
  s_mov_b32 s96, s50
  s_and_b32 s97, s51, 0xffff
  s_mov_b32 s98, 0x100
  s_mov_b32 s99, 0x20000
  s_cmp_lt_u32 s18, 4
  s_cselect_b32 s43, 1, 0
  s_cmp_lt_u32 s2, 240
  s_cselect_b32 s43, s43, 0
  s_cmp_eq_u32 s43, 0
  s_cbranch_scc1 pr_a_noq
  s_mov_b32 s64, s6
  s_and_b32 s65, s7, 0xffff
  s_mov_b32 s66, 0x258000
  s_mov_b32 s67, 0x20000
  s_mov_b32 s68, s8
  s_and_b32 s69, s9, 0xffff
  s_mov_b32 s70, 0x6400
  s_mov_b32 s71, 0x20000
  s_mul_i32 s60, s2, 5462
  s_lshr_b32 s60, s60, 16
  s_mul_i32 s57, s60, 12
  s_sub_u32 s61, s2, s57
  s_and_b32 s62, s61, 3
  s_lshl_b32 s62, s62, 2
  s_add_u32 s62, s62, s18
  s_lshr_b32 s61, s61, 2
  v_lshrrev_b32 v21, 2, v3
  v_lshlrev_b32 v21, 3, v21
  v_and_b32 v22, 3, v3
  v_add_u32 v21, v21, v22
  v_mul_u32_u24 v20, 3840, v21
  v_lshlrev_b32 v22, 4, v4
  v_add_u32 v20, v20, v22
  s_mul_i32 s63, s61, 1280
  s_mul_i32 s57, s62, 80
  s_add_u32 s63, s63, s57
  s_mul_i32 s57, s60, 122880
  s_add_u32 s63, s63, s57
  s_add_u32 s57, s63, 0
  buffer_load_dwordx4 v[48:51], v20, s[64:67], s57 offen
  s_add_u32 s57, s63, 15360
  buffer_load_dwordx4 v[52:55], v20, s[64:67], s57 offen
  s_add_u32 s57, s63, 40
  buffer_load_dwordx4 v[56:59], v20, s[64:67], s57 offen
  s_add_u32 s57, s63, 15400
  buffer_load_dwordx4 v[60:63], v20, s[64:67], s57 offen
  s_mul_i32 s57, s62, 1600
  v_cmp_gt_u32 vcc, 36, v1
  v_add_u32 v165, 1024, v5
  buffer_load_dwordx4 v[156:159], v5, s[68:71], s57 offen
  v_cndmask_b32 v165, v7, v165, vcc
  buffer_load_dwordx4 v[160:163], v165, s[68:71], s57 offen
  s_mul_i32 s58, s18, 3072
  s_add_u32 s58, s58, 8192
  v_add_u32 v164, s58, v5
  v_mov_b32 v148, 0
  v_mov_b32 v149, 0
  v_mov_b32 v150, 0
  v_mov_b32 v151, 0
  ds_write_b128 v164, v[148:151] offset:0
  ds_write_b128 v164, v[148:151] offset:1024
  ds_write_b128 v164, v[148:151] offset:2048
  s_waitcnt vmcnt(6)
  s_branch pr_b
pr_a_noq:
  s_waitcnt vmcnt(0)
pr_b:
  v_lshlrev_b32 v144, 8, v9
  v_lshlrev_b32 v145, 4, v8
  v_add_u32 v144, v144, v145
  v_add_u32 v145, 2048, v144
  v_cndmask_b32 v145, v7, v145, s[54:55]
  s_lshr_b32 s57, s2, 1
  s_mul_i32 s57, s57, 20480
  s_and_b32 s58, s2, 1
  s_lshl_b32 s58, s58, 7
  s_add_u32 s57, s57, s58
  s_mul_i32 s58, s18, 2560
  s_add_u32 s57, s57, s58
  s_add_u32 s57, s57, 0x800000
  buffer_store_dwordx4 v[12:15], v144, s[20:23], s57 offen sc0 sc1
  buffer_store_dwordx4 v[16:19], v145, s[20:23], s57 offen sc0 sc1
  v_lshlrev_b32 v120, 16, v12
  v_and_b32 v121, 0xffff0000, v12
  v_lshlrev_b32 v122, 16, v13
  v_and_b32 v123, 0xffff0000, v13
  v_lshlrev_b32 v124, 16, v14
  v_and_b32 v125, 0xffff0000, v14
  v_lshlrev_b32 v126, 16, v15
  v_and_b32 v127, 0xffff0000, v15
  v_lshlrev_b32 v128, 16, v16
  v_and_b32 v129, 0xffff0000, v16
  v_lshlrev_b32 v130, 16, v17
  v_and_b32 v131, 0xffff0000, v17
  v_lshlrev_b32 v132, 16, v18
  v_and_b32 v133, 0xffff0000, v18
  v_lshlrev_b32 v134, 16, v19
  v_and_b32 v135, 0xffff0000, v19
  v_pk_add_f32 v[138:139], v[120:121], v[122:123]
  v_pk_add_f32 v[140:141], v[124:125], v[126:127]
  v_pk_add_f32 v[138:139], v[138:139], v[128:129]
  v_pk_add_f32 v[140:141], v[140:141], v[130:131]
  v_pk_add_f32 v[138:139], v[138:139], v[132:133]
  v_pk_add_f32 v[140:141], v[140:141], v[134:135]
  v_pk_add_f32 v[138:139], v[138:139], v[140:141]
  v_add_f32 v136, v138, v139
  s_nop 1
  v_add_f32_dpp v136, v136, v136 row_ror:8 row_mask:0xf bank_mask:0xf
  v_mov_b32 v137, v136
  s_nop 1
  v_permlane16_swap_b32 v137, v136
  s_nop 1
  v_add_f32 v136, v136, v137
  v_mov_b32 v137, v136
  s_nop 1
  v_permlane32_swap_b32 v137, v136
  s_nop 1
  v_add_f32 v136, v136, v137
  v_mul_f32 v136, 0x3c4ccccd, v136
  v_sub_f32 v120, v120, v136
  v_sub_f32 v121, v121, v136
  v_sub_f32 v122, v122, v136
  v_sub_f32 v123, v123, v136
  v_sub_f32 v124, v124, v136
  v_sub_f32 v125, v125, v136
  v_sub_f32 v126, v126, v136
  v_sub_f32 v127, v127, v136
  v_sub_f32 v128, v128, v136
  v_sub_f32 v129, v129, v136
  v_sub_f32 v130, v130, v136
  v_sub_f32 v131, v131, v136
  v_sub_f32 v132, v132, v136
  v_sub_f32 v133, v133, v136
  v_sub_f32 v134, v134, v136
  v_sub_f32 v135, v135, v136
  v_mul_f32 v138, v120, v120
  v_mul_f32 v139, v128, v128
  v_fmac_f32 v138, v121, v121
  v_fmac_f32 v139, v129, v129
  v_fmac_f32 v138, v122, v122
  v_fmac_f32 v139, v130, v130
  v_fmac_f32 v138, v123, v123
  v_fmac_f32 v139, v131, v131
  v_fmac_f32 v138, v124, v124
  v_fmac_f32 v139, v132, v132
  v_fmac_f32 v138, v125, v125
  v_fmac_f32 v139, v133, v133
  v_fmac_f32 v138, v126, v126
  v_fmac_f32 v139, v134, v134
  v_fmac_f32 v138, v127, v127
  v_fmac_f32 v139, v135, v135
  v_cndmask_b32 v139, 0, v139, s[54:55]
  v_add_f32 v138, v138, v139
  s_nop 1
  v_add_f32_dpp v138, v138, v138 row_ror:8 row_mask:0xf bank_mask:0xf
  v_mov_b32 v137, v138
  s_nop 1
  v_permlane16_swap_b32 v137, v138
  s_nop 1
  v_add_f32 v138, v138, v137
  v_mov_b32 v137, v138
  s_nop 1
  v_permlane32_swap_b32 v137, v138
  s_nop 1
  v_add_f32 v138, v138, v137
  v_mov_b32 v139, v138
  v_mov_b32 v138, v136
  v_lshlrev_b32 v144, 6, v8
  s_lshl_b32 s57, s18, 3
  s_add_u32 s57, s57, 4096
  v_add_u32 v144, s57, v144
  s_mov_b64 exec, 0xff
  ds_write_b64 v144, v[138:139]
  s_mov_b64 exec, -1
  s_cmp_lt_u32 s18, 6
  s_cbranch_scc1 pr_nz
  s_sub_u32 s57, s18, 6
  s_lshl_b32 s57, s57, 10
  v_add_u32 v144, s57, v5
  s_mul_i32 s57, s2, 1664
  v_add_u32 v145, s57, v144
  v_cmp_gt_u32 vcc, 1664, v144
  s_nop 1
  v_cndmask_b32 v145, v7, v145, vcc
  v_cmp_gt_u32 vcc, 0x63000, v145
  s_nop 1
  v_cndmask_b32 v145, v7, v145, vcc
  v_mov_b32 v148, 0
  v_mov_b32 v149, 0
  v_mov_b32 v150, 0
  v_mov_b32 v151, 0
  s_mov_b32 s57, 0x1420000
  buffer_store_dwordx4 v[148:151], v145, s[20:23], s57 offen sc0 sc1
pr_nz:
  s_waitcnt lgkmcnt(0)
  s_barrier
  s_cmp_lg_u32 s18, 7
  s_cbranch_scc1 pr_ns
  v_add_u32 v144, 4096, v5
  ds_read_b128 v[152:155], v144
  v_cmp_gt_u32 vcc, 32, v1
  s_lshl_b32 s57, s2, 9
  s_add_u32 s57, s57, 0x1400000
  v_cndmask_b32 v145, v7, v5, vcc
  s_waitcnt lgkmcnt(0)
  buffer_store_dwordx4 v[152:155], v145, s[20:23], s57 offen sc0 sc1
pr_ns:
  s_cmp_eq_u32 s43, 0
  s_cbranch_scc1 pr_d
  s_waitcnt vmcnt(2)
  s_cmp_eq_u32 s61, 2
  s_cbranch_scc1 pr_v_ident
  v_cmp_le_u32 vcc, 50, v1
  v_add_u32 v144, 544, v164
  s_nop 0
  v_cndmask_b32 v145, v164, v144, vcc
  ds_write_b128 v145, v[156:159]
  s_mov_b32 exec_hi, 0xf
  ds_write_b128 v144, v[160:163] offset:1024
  s_mov_b64 exec, -1
  s_branch pr_qkv_go
pr_v_ident:
  s_mul_i32 s58, s18, 3072
  s_add_u32 s58, s58, 8192
  v_and_b32 v144, 31, v1
  v_mul_u32_u24 v145, 42, v144
  v_lshrrev_b32 v146, 5, v1
  v_mul_u32_u24 v146, 1344, v146
  v_add_u32 v145, v145, v146
  v_add_u32 v145, s58, v145
  v_mov_b32 v146, 0x3f80
  s_mov_b32 exec_lo, 0xfffff
  s_mov_b32 exec_hi, 0xfffff
  ds_write_b16 v145, v146
  s_mov_b64 exec, -1
pr_qkv_go:
  s_mul_i32 s58, s18, 3072
  s_add_u32 s58, s58, 8192
  v_lshlrev_b32 v144, 3, v4
  v_lshrrev_b32 v145, 2, v3
  v_add_u32 v144, v144, v145
  v_mul_u32_u24 v144, 40, v144
  v_and_b32 v145, 1, v3
  v_mul_u32_u24 v146, 1344, v145
  v_add_u32 v144, v144, v146
  v_add_u32 v144, s58, v144
  v_bfe_u32 v146, v3, 1, 1
  v_lshlrev_b32 v146, 2, v146
  s_cmp_eq_u32 s61, 1
  s_cselect_b32 s59, -4, 0
  v_add_u32 v146, s59, v146
  s_add_u32 s59, s58, 2688
  v_mov_b32 v147, s59
  s_waitcnt lgkmcnt(0)
  v_add_u32 v148, 0, v146
  v_cmp_gt_u32 vcc, 20, v148
  v_lshlrev_b32 v148, 1, v148
  v_add_u32 v148, v148, v144
  v_cndmask_b32 v148, v147, v148, vcc
  v_cmp_eq_u32 vcc, 0, v145
  s_nop 1
  v_cndmask_b32 v149, v147, v148, vcc
  v_cmp_eq_u32 vcc, 1, v145
  s_nop 1
  v_cndmask_b32 v150, v147, v148, vcc
  ds_read_b64_tr_b16 v[24:25], v149 offset:0
  ds_read_b64_tr_b16 v[26:27], v149 offset:160
  ds_read_b64_tr_b16 v[28:29], v150 offset:0
  ds_read_b64_tr_b16 v[30:31], v150 offset:160
  v_add_u32 v148, 8, v146
  v_cmp_gt_u32 vcc, 20, v148
  v_lshlrev_b32 v148, 1, v148
  v_add_u32 v148, v148, v144
  v_cndmask_b32 v148, v147, v148, vcc
  v_cmp_eq_u32 vcc, 0, v145
  s_nop 1
  v_cndmask_b32 v149, v147, v148, vcc
  v_cmp_eq_u32 vcc, 1, v145
  s_nop 1
  v_cndmask_b32 v150, v147, v148, vcc
  ds_read_b64_tr_b16 v[32:33], v149 offset:0
  ds_read_b64_tr_b16 v[34:35], v149 offset:160
  ds_read_b64_tr_b16 v[36:37], v150 offset:0
  ds_read_b64_tr_b16 v[38:39], v150 offset:160
  v_add_u32 v148, 16, v146
  v_cmp_gt_u32 vcc, 20, v148
  v_lshlrev_b32 v148, 1, v148
  v_add_u32 v148, v148, v144
  v_cndmask_b32 v148, v147, v148, vcc
  v_cmp_eq_u32 vcc, 0, v145
  s_nop 1
  v_cndmask_b32 v149, v147, v148, vcc
  v_cmp_eq_u32 vcc, 1, v145
  s_nop 1
  v_cndmask_b32 v150, v147, v148, vcc
  ds_read_b64_tr_b16 v[40:41], v149 offset:0
  ds_read_b64_tr_b16 v[42:43], v149 offset:160
  ds_read_b64_tr_b16 v[44:45], v150 offset:0
  ds_read_b64_tr_b16 v[46:47], v150 offset:160
  s_waitcnt lgkmcnt(0)
  v_mfma_f32_16x16x32_bf16 v[72:75], v[48:51], v[24:27], 0
  v_mfma_f32_16x16x32_bf16 v[76:79], v[52:55], v[24:27], 0
  v_mfma_f32_16x16x32_bf16 v[80:83], v[48:51], v[32:35], 0
  v_mfma_f32_16x16x32_bf16 v[84:87], v[52:55], v[32:35], 0
  v_mfma_f32_16x16x32_bf16 v[88:91], v[48:51], v[40:43], 0
  v_mfma_f32_16x16x32_bf16 v[92:95], v[52:55], v[40:43], 0
  v_mfma_f32_16x16x32_bf16 v[72:75], v[56:59], v[28:31], v[72:75]
  v_mfma_f32_16x16x32_bf16 v[76:79], v[60:63], v[28:31], v[76:79]
  v_mfma_f32_16x16x32_bf16 v[80:83], v[56:59], v[36:39], v[80:83]
  v_mfma_f32_16x16x32_bf16 v[84:87], v[60:63], v[36:39], v[84:87]
  v_mfma_f32_16x16x32_bf16 v[88:91], v[56:59], v[44:47], v[88:91]
  v_mfma_f32_16x16x32_bf16 v[92:95], v[60:63], v[44:47], v[92:95]
  s_nop 7
  v_lshrrev_b32 v22, 1, v4
  v_lshlrev_b32 v22, 12, v22
  v_and_b32 v23, 1, v4
  v_lshlrev_b32 v23, 9, v23
  v_add_u32 v22, v22, v23
  v_lshlrev_b32 v23, 4, v3
  v_add_u32 v22, v22, v23
  s_mul_i32 s63, s62, 163840
  s_lshl_b32 s57, s60, 13
  s_add_u32 s63, s63, s57
  s_add_u32 s63, s63, 0x0
  s_mul_i32 s59, s61, 20
  s_lshr_b32 s59, s59, 3
  v_cvt_pk_bf16_f32 v120, v72, v73
  v_cvt_pk_bf16_f32 v121, v74, v75
  v_cvt_pk_bf16_f32 v122, v76, v77
  v_cvt_pk_bf16_f32 v123, v78, v79
  s_cmp_eq_u32 s61, 1
  s_cselect_b32 s56, 0xff00ff00, -1
  s_mov_b32 vcc_lo, s56
  s_mov_b32 vcc_hi, s56
  s_nop 1
  v_cndmask_b32 v23, v7, v22, vcc
  s_add_u32 s56, s59, 0
  s_lshr_b32 s57, s56, 1
  s_lshl_b32 s57, s57, 10
  s_and_b32 s56, s56, 1
  s_lshl_b32 s56, s56, 8
  s_add_u32 s57, s57, s56
  s_add_u32 s57, s57, s63
  buffer_store_dwordx4 v[120:123], v23, s[20:23], s57 offen sc0 sc1
  v_lshlrev_b32 v72, 16, v120
  v_and_b32 v73, 0xffff0000, v120
  v_lshlrev_b32 v74, 16, v121
  v_and_b32 v75, 0xffff0000, v121
  v_lshlrev_b32 v76, 16, v122
  v_and_b32 v77, 0xffff0000, v122
  v_lshlrev_b32 v78, 16, v123
  v_and_b32 v79, 0xffff0000, v123
  v_add_f32 v144, v72, v73
  v_add_f32 v144, v144, v74
  v_add_f32 v144, v144, v75
  v_add_f32 v144, v144, v76
  v_add_f32 v144, v144, v77
  v_add_f32 v144, v144, v78
  v_add_f32 v144, v144, v79
  v_mov_b32 v155, v144
  s_nop 1
  v_permlane16_swap_b32 v155, v144
  s_nop 1
  v_add_f32 v144, v144, v155
  v_mov_b32 v155, v144
  s_nop 1
  v_permlane32_swap_b32 v155, v144
  s_nop 1
  v_add_f32 v144, v144, v155
  v_cvt_pk_bf16_f32 v124, v80, v81
  v_cvt_pk_bf16_f32 v125, v82, v83
  v_cvt_pk_bf16_f32 v126, v84, v85
  v_cvt_pk_bf16_f32 v127, v86, v87
  s_add_u32 s56, s59, 1
  s_lshr_b32 s57, s56, 1
  s_lshl_b32 s57, s57, 10
  s_and_b32 s56, s56, 1
  s_lshl_b32 s56, s56, 8
  s_add_u32 s57, s57, s56
  s_add_u32 s57, s57, s63
  buffer_store_dwordx4 v[124:127], v22, s[20:23], s57 offen sc0 sc1
  v_lshlrev_b32 v80, 16, v124
  v_and_b32 v81, 0xffff0000, v124
  v_lshlrev_b32 v82, 16, v125
  v_and_b32 v83, 0xffff0000, v125
  v_lshlrev_b32 v84, 16, v126
  v_and_b32 v85, 0xffff0000, v126
  v_lshlrev_b32 v86, 16, v127
  v_and_b32 v87, 0xffff0000, v127
  v_add_f32 v145, v80, v81
  v_add_f32 v145, v145, v82
  v_add_f32 v145, v145, v83
  v_add_f32 v145, v145, v84
  v_add_f32 v145, v145, v85
  v_add_f32 v145, v145, v86
  v_add_f32 v145, v145, v87
  v_mov_b32 v155, v145
  s_nop 1
  v_permlane16_swap_b32 v155, v145
  s_nop 1
  v_add_f32 v145, v145, v155
  v_mov_b32 v155, v145
  s_nop 1
  v_permlane32_swap_b32 v155, v145
  s_nop 1
  v_add_f32 v145, v145, v155
  v_cvt_pk_bf16_f32 v128, v88, v89
  v_cvt_pk_bf16_f32 v129, v90, v91
  v_cvt_pk_bf16_f32 v130, v92, v93
  v_cvt_pk_bf16_f32 v131, v94, v95
  s_cmp_eq_u32 s61, 0
  s_cselect_b32 s56, 0xff00ff, -1
  s_mov_b32 vcc_lo, s56
  s_mov_b32 vcc_hi, s56
  s_nop 1
  v_cndmask_b32 v23, v7, v22, vcc
  s_add_u32 s56, s59, 2
  s_lshr_b32 s57, s56, 1
  s_lshl_b32 s57, s57, 10
  s_and_b32 s56, s56, 1
  s_lshl_b32 s56, s56, 8
  s_add_u32 s57, s57, s56
  s_add_u32 s57, s57, s63
  buffer_store_dwordx4 v[128:131], v23, s[20:23], s57 offen sc0 sc1
  v_lshlrev_b32 v88, 16, v128
  v_and_b32 v89, 0xffff0000, v128
  v_lshlrev_b32 v90, 16, v129
  v_and_b32 v91, 0xffff0000, v129
  v_lshlrev_b32 v92, 16, v130
  v_and_b32 v93, 0xffff0000, v130
  v_lshlrev_b32 v94, 16, v131
  v_and_b32 v95, 0xffff0000, v131
  v_add_f32 v146, v88, v89
  v_add_f32 v146, v146, v90
  v_add_f32 v146, v146, v91
  v_add_f32 v146, v146, v92
  v_add_f32 v146, v146, v93
  v_add_f32 v146, v146, v94
  v_add_f32 v146, v146, v95
  v_mov_b32 v155, v146
  s_nop 1
  v_permlane16_swap_b32 v155, v146
  s_nop 1
  v_add_f32 v146, v146, v155
  v_mov_b32 v155, v146
  s_nop 1
  v_permlane32_swap_b32 v155, v146
  s_nop 1
  v_add_f32 v146, v146, v155
  v_mov_b32 v147, 0
  v_mov_b32 v148, v144
  v_cmp_eq_u32 vcc, 1, v4
  s_nop 1
  v_cndmask_b32 v148, v148, v145, vcc
  v_cmp_eq_u32 vcc, 2, v4
  s_nop 1
  v_cndmask_b32 v148, v148, v146, vcc
  v_cmp_eq_u32 vcc, 3, v4
  s_nop 1
  v_cndmask_b32 v148, v148, v147, vcc
  v_lshlrev_b32 v149, 2, v1
  s_lshl_b32 s57, s60, 4
  s_add_u32 s57, s57, s62
  s_mul_i32 s57, s57, 3
  s_add_u32 s57, s57, s61
  s_lshl_b32 s57, s57, 8
  s_add_u32 s57, s57, 0x1500000
  buffer_store_dword v148, v149, s[20:23], s57 offen sc0 sc1
pr_d:
  s_cmp_lt_u32 s18, 3
  s_cbranch_scc1 pr_d_none
  s_sub_u32 s56, s18, 4
  s_cmp_eq_u32 s18, 3
  s_cselect_b32 s56, 4, s56
  s_mul_i32 s57, s2, 5
  s_add_u32 s56, s56, s57
  s_cmp_lt_u32 s2, 108
  s_cbranch_scc1 pr_d_w1
  s_cmp_lt_u32 s2, 216
  s_cbranch_scc1 pr_d_w2
  s_mov_b32 s64, s10
  s_and_b32 s65, s11, 0xffff
  s_mov_b32 s66, 0xc8000
  s_mov_b32 s67, 0x20000
  s_sub_u32 s56, s56, 1080
  s_mul_i32 s60, s56, 6554
  s_lshr_b32 s60, s60, 16
  s_mul_i32 s57, s60, 10
  s_sub_u32 s61, s56, s57
  s_lshl_b32 s57, s60, 5
  v_lshrrev_b32 v144, 2, v3
  v_lshlrev_b32 v144, 3, v144
  v_and_b32 v145, 3, v3
  v_add_u32 v144, v144, v145
  v_add_u32 v144, s57, v144
  v_add_u32 v144, 0, v144
  v_mul_u32_u24 v145, 52429, v144
  v_lshrrev_b32 v145, 21, v145
  v_mul_u32_u24 v146, 40, v145
  v_sub_u32 v146, v144, v146
  v_mov_b32 v147, 0
  v_cmp_le_u32 vcc, 16, v146
  s_nop 1
  v_cndmask_b32 v147, v147, 4, vcc
  v_cmp_le_u32 vcc, 32, v146
  s_nop 1
  v_cndmask_b32 v147, v147, -16, vcc
  v_cmp_le_u32 vcc, 36, v146
  s_nop 1
  v_cndmask_b32 v147, v147, 0, vcc
  v_add_u32 v144, v144, v147
  v_mul_u32_u24 v144, 1280, v144
  v_lshlrev_b32 v145, 4, v4
  v_add_u32 v20, v144, v145
  v_lshrrev_b32 v144, 2, v3
  v_lshlrev_b32 v144, 3, v144
  v_and_b32 v145, 3, v3
  v_add_u32 v144, v144, v145
  v_add_u32 v144, s57, v144
  v_add_u32 v144, 4, v144
  v_mul_u32_u24 v145, 52429, v144
  v_lshrrev_b32 v145, 21, v145
  v_mul_u32_u24 v146, 40, v145
  v_sub_u32 v146, v144, v146
  v_mov_b32 v147, 0
  v_cmp_le_u32 vcc, 16, v146
  s_nop 1
  v_cndmask_b32 v147, v147, 4, vcc
  v_cmp_le_u32 vcc, 32, v146
  s_nop 1
  v_cndmask_b32 v147, v147, -16, vcc
  v_cmp_le_u32 vcc, 36, v146
  s_nop 1
  v_cndmask_b32 v147, v147, 0, vcc
  v_add_u32 v144, v144, v147
  v_mul_u32_u24 v144, 1280, v144
  v_lshlrev_b32 v145, 4, v4
  v_add_u32 v21, v144, v145
  s_lshl_b32 s63, s61, 7
  s_add_u32 s57, s63, 0
  buffer_load_dwordx4 v[48:51], v20, s[64:67], s57 offen
  s_add_u32 s57, s63, 0
  buffer_load_dwordx4 v[52:55], v21, s[64:67], s57 offen
  s_add_u32 s57, s63, 64
  buffer_load_dwordx4 v[56:59], v20, s[64:67], s57 offen
  s_add_u32 s57, s63, 64
  buffer_load_dwordx4 v[60:63], v21, s[64:67], s57 offen
  s_branch pr_d_done
pr_d_w2:
  s_mov_b32 s64, s44
  s_and_b32 s65, s45, 0xffff
  s_mov_b32 s66, 0x21c000
  s_mov_b32 s67, 0x20000
  s_sub_u32 s56, s56, 540
  s_mul_i32 s60, s56, 6554
  s_lshr_b32 s60, s60, 16
  s_mul_i32 s57, s60, 10
  s_sub_u32 s61, s56, s57
  v_lshrrev_b32 v21, 2, v3
  v_lshlrev_b32 v21, 3, v21
  v_and_b32 v22, 3, v3
  v_add_u32 v21, v21, v22
  v_mul_u32_u24 v20, 1280, v21
  v_lshlrev_b32 v22, 4, v4
  v_add_u32 v20, v20, v22
  s_mul_i32 s63, s60, 40960
  s_lshl_b32 s57, s61, 7
  s_add_u32 s63, s63, s57
  s_add_u32 s57, s63, 0
  buffer_load_dwordx4 v[48:51], v20, s[64:67], s57 offen
  s_add_u32 s57, s63, 5120
  buffer_load_dwordx4 v[52:55], v20, s[64:67], s57 offen
  s_add_u32 s57, s63, 64
  buffer_load_dwordx4 v[56:59], v20, s[64:67], s57 offen
  s_add_u32 s57, s63, 5184
  buffer_load_dwordx4 v[60:63], v20, s[64:67], s57 offen
  s_branch pr_d_done
pr_d_w1:
  s_mov_b32 s64, s12
  s_and_b32 s65, s13, 0xffff
  s_mov_b32 s66, 0x21c000
  s_mov_b32 s67, 0x20000
  s_mul_i32 s60, s56, 2428
  s_lshr_b32 s60, s60, 16
  s_mul_i32 s57, s60, 27
  s_sub_u32 s61, s56, s57
  v_lshrrev_b32 v21, 2, v3
  v_lshlrev_b32 v21, 3, v21
  v_and_b32 v22, 3, v3
  v_add_u32 v21, v21, v22
  v_mul_u32_u24 v20, 3456, v21
  v_lshlrev_b32 v22, 4, v4
  v_add_u32 v20, v20, v22
  s_mul_i32 s63, s60, 110592
  s_lshl_b32 s57, s61, 7
  s_add_u32 s63, s63, s57
  s_add_u32 s57, s63, 0
  buffer_load_dwordx4 v[48:51], v20, s[64:67], s57 offen
  s_add_u32 s57, s63, 13824
  buffer_load_dwordx4 v[52:55], v20, s[64:67], s57 offen
  s_add_u32 s57, s63, 64
  buffer_load_dwordx4 v[56:59], v20, s[64:67], s57 offen
  s_add_u32 s57, s63, 13888
  buffer_load_dwordx4 v[60:63], v20, s[64:67], s57 offen
pr_d_done:
  v_lshrrev_b32 v144, 3, v3
  v_add_u32 v144, 0, v144
  v_cmp_eq_u32 vcc, v144, v4
  v_and_b32 v145, 1, v3
  v_cmp_eq_u32 s[58:59], 1, v145
  v_mov_b32 v146, 0x3f80
  v_mov_b32 v147, 0x3f800000
  v_cndmask_b32 v145, v146, v147, s[58:59]
  v_cndmask_b32 v145, 0, v145, vcc
  v_bfe_u32 v146, v3, 1, 2
  v_cmp_eq_u32 vcc, 0, v146
  s_nop 1
  v_cndmask_b32 v24, 0, v145, vcc
  v_cmp_eq_u32 vcc, 1, v146
  s_nop 1
  v_cndmask_b32 v25, 0, v145, vcc
  v_cmp_eq_u32 vcc, 2, v146
  s_nop 1
  v_cndmask_b32 v26, 0, v145, vcc
  v_cmp_eq_u32 vcc, 3, v146
  s_nop 1
  v_cndmask_b32 v27, 0, v145, vcc
  v_lshrrev_b32 v144, 3, v3
  v_add_u32 v144, 2, v144
  v_cmp_eq_u32 vcc, v144, v4
  v_and_b32 v145, 1, v3
  v_cmp_eq_u32 s[58:59], 1, v145
  v_mov_b32 v146, 0x3f80
  v_mov_b32 v147, 0x3f800000
  v_cndmask_b32 v145, v146, v147, s[58:59]
  v_cndmask_b32 v145, 0, v145, vcc
  v_bfe_u32 v146, v3, 1, 2
  v_cmp_eq_u32 vcc, 0, v146
  s_nop 1
  v_cndmask_b32 v28, 0, v145, vcc
  v_cmp_eq_u32 vcc, 1, v146
  s_nop 1
  v_cndmask_b32 v29, 0, v145, vcc
  v_cmp_eq_u32 vcc, 2, v146
  s_nop 1
  v_cndmask_b32 v30, 0, v145, vcc
  v_cmp_eq_u32 vcc, 3, v146
  s_nop 1
  v_cndmask_b32 v31, 0, v145, vcc
  s_waitcnt vmcnt(4)
  s_branch pr_e
pr_d_none:
  s_waitcnt vmcnt(0)
pr_e:
  s_barrier
  s_cmp_eq_u32 s18, 0
  s_cbranch_scc1 pr_sync
  s_cmp_lg_u32 s18, 1
  s_cbranch_scc1 pr_noarr
  s_lshr_b32 s57, s2, 3
  s_lshl_b32 s57, s57, 3
  s_lshl_b32 s58, s42, 2
  s_lshl_b32 s58, 1, s58
  v_mov_b32 v20, s57
  v_mov_b32 v21, s58
  s_mov_b64 exec, 1
  buffer_atomic_add v21, v20, s[96:99], 0 offen
  s_mov_b64 exec, -1
pr_noarr:
  s_cmp_ge_u32 s18, 3
  s_cbranch_scc1 pr_f
  s_mul_i32 s57, s2, 38912
  s_add_u32 s57, s57, 0xa80000
  v_subrev_u32 v37, 64, v0
  v_add_u32 v38, 0, v37
  v_cmp_gt_u32 vcc, 608, v38
  v_mul_u32_u24 v38, 64, v38
  s_nop 0
  v_cndmask_b32 v38, v7, v38, vcc
  buffer_load_dword v39, v38, s[20:23], s57 offen
  v_add_u32 v38, 128, v37
  v_cmp_gt_u32 vcc, 608, v38
  v_mul_u32_u24 v38, 64, v38
  s_nop 0
  v_cndmask_b32 v38, v7, v38, vcc
  buffer_load_dword v39, v38, s[20:23], s57 offen
  v_add_u32 v38, 256, v37
  v_cmp_gt_u32 vcc, 608, v38
  v_mul_u32_u24 v38, 64, v38
  s_nop 0
  v_cndmask_b32 v38, v7, v38, vcc
  buffer_load_dword v39, v38, s[20:23], s57 offen
  v_add_u32 v38, 384, v37
  v_cmp_gt_u32 vcc, 608, v38
  v_mul_u32_u24 v38, 64, v38
  s_nop 0
  v_cndmask_b32 v38, v7, v38, vcc
  buffer_load_dword v39, v38, s[20:23], s57 offen
  v_add_u32 v38, 512, v37
  v_cmp_gt_u32 vcc, 608, v38
  v_mul_u32_u24 v38, 64, v38
  s_nop 0
  v_cndmask_b32 v38, v7, v38, vcc
  buffer_load_dword v39, v38, s[20:23], s57 offen
  s_branch pr_b2
pr_f:
  s_cmp_lt_u32 s18, 3
  s_cbranch_scc1 pr_b2
  s_waitcnt vmcnt(0)
  v_mfma_f32_16x16x32_bf16 v[72:75], v[48:51], v[24:27], 0
  v_mfma_f32_16x16x32_bf16 v[80:83], v[48:51], v[28:31], 0
  v_mfma_f32_16x16x32_bf16 v[76:79], v[52:55], v[24:27], 0
  v_mfma_f32_16x16x32_bf16 v[84:87], v[52:55], v[28:31], 0
  v_mfma_f32_16x16x32_bf16 v[88:91], v[56:59], v[24:27], 0
  v_mfma_f32_16x16x32_bf16 v[96:99], v[56:59], v[28:31], 0
  v_mfma_f32_16x16x32_bf16 v[92:95], v[60:63], v[24:27], 0
  v_mfma_f32_16x16x32_bf16 v[100:103], v[60:63], v[28:31], 0
  s_nop 7
  s_cmp_lt_u32 s2, 108
  s_cbranch_scc1 pr_f_w1
  s_cmp_lt_u32 s2, 216
  s_cselect_b32 s62, 54, 20
  s_mov_b32 s63, 0x4c0000
  s_cselect_b32 s63, s63, 0x700000
  v_cvt_pk_bf16_f32 v72, v72, v73
  v_cvt_pk_bf16_f32 v73, v74, v75
  v_cvt_pk_bf16_f32 v74, v76, v77
  v_cvt_pk_bf16_f32 v75, v78, v79
  s_lshl_b32 s58, s61, 2
  s_add_u32 s58, s58, 0
  s_mul_i32 s59, s58, 52429
  s_lshr_b32 s59, s59, 18
  s_mul_i32 s57, s59, 5
  s_sub_u32 s58, s58, s57
  s_mul_i32 s59, s59, s62
  s_add_u32 s59, s59, s60
  s_mul_i32 s59, s59, 5
  s_add_u32 s59, s59, s58
  s_lshl_b32 s59, s59, 10
  s_add_u32 s57, s59, s63
  buffer_store_dwordx4 v[72:75], v5, s[20:23], s57 offen sc0 sc1
  v_cvt_pk_bf16_f32 v80, v80, v81
  v_cvt_pk_bf16_f32 v81, v82, v83
  v_cvt_pk_bf16_f32 v82, v84, v85
  v_cvt_pk_bf16_f32 v83, v86, v87
  s_lshl_b32 s58, s61, 2
  s_add_u32 s58, s58, 1
  s_mul_i32 s59, s58, 52429
  s_lshr_b32 s59, s59, 18
  s_mul_i32 s57, s59, 5
  s_sub_u32 s58, s58, s57
  s_mul_i32 s59, s59, s62
  s_add_u32 s59, s59, s60
  s_mul_i32 s59, s59, 5
  s_add_u32 s59, s59, s58
  s_lshl_b32 s59, s59, 10
  s_add_u32 s57, s59, s63
  buffer_store_dwordx4 v[80:83], v5, s[20:23], s57 offen sc0 sc1
  v_cvt_pk_bf16_f32 v88, v88, v89
  v_cvt_pk_bf16_f32 v89, v90, v91
  v_cvt_pk_bf16_f32 v90, v92, v93
  v_cvt_pk_bf16_f32 v91, v94, v95
  s_lshl_b32 s58, s61, 2
  s_add_u32 s58, s58, 2
  s_mul_i32 s59, s58, 52429
  s_lshr_b32 s59, s59, 18
  s_mul_i32 s57, s59, 5
  s_sub_u32 s58, s58, s57
  s_mul_i32 s59, s59, s62
  s_add_u32 s59, s59, s60
  s_mul_i32 s59, s59, 5
  s_add_u32 s59, s59, s58
  s_lshl_b32 s59, s59, 10
  s_add_u32 s57, s59, s63
  buffer_store_dwordx4 v[88:91], v5, s[20:23], s57 offen sc0 sc1
  v_cvt_pk_bf16_f32 v96, v96, v97
  v_cvt_pk_bf16_f32 v97, v98, v99
  v_cvt_pk_bf16_f32 v98, v100, v101
  v_cvt_pk_bf16_f32 v99, v102, v103
  s_lshl_b32 s58, s61, 2
  s_add_u32 s58, s58, 3
  s_mul_i32 s59, s58, 52429
  s_lshr_b32 s59, s59, 18
  s_mul_i32 s57, s59, 5
  s_sub_u32 s58, s58, s57
  s_mul_i32 s59, s59, s62
  s_add_u32 s59, s59, s60
  s_mul_i32 s59, s59, 5
  s_add_u32 s59, s59, s58
  s_lshl_b32 s59, s59, 10
  s_add_u32 s57, s59, s63
  buffer_store_dwordx4 v[96:99], v5, s[20:23], s57 offen sc0 sc1
  s_branch pr_f_done
pr_f_w1:
  v_add_f32 v144, v72, v73
  v_add_f32 v144, v144, v74
  v_add_f32 v144, v144, v75
  v_add_f32 v144, v144, v76
  v_add_f32 v144, v144, v77
  v_add_f32 v144, v144, v78
  v_add_f32 v144, v144, v79
  v_mov_b32 v155, v144
  s_nop 1
  v_permlane16_swap_b32 v155, v144
  s_nop 1
  v_add_f32 v144, v144, v155
  v_mov_b32 v155, v144
  s_nop 1
  v_permlane32_swap_b32 v155, v144
  s_nop 1
  v_add_f32 v144, v144, v155
  v_cvt_pk_bf16_f32 v72, v72, v73
  v_cvt_pk_bf16_f32 v73, v74, v75
  v_cvt_pk_bf16_f32 v74, v76, v77
  v_cvt_pk_bf16_f32 v75, v78, v79
  s_lshl_b32 s57, s61, 2
  s_add_u32 s57, s57, 0
  s_mul_i32 s58, s57, 9363
  s_lshr_b32 s58, s58, 16
  s_mul_i32 s59, s58, 7
  s_sub_u32 s57, s57, s59
  s_mul_i32 s58, s58, 20
  s_add_u32 s58, s58, s60
  s_mul_i32 s58, s58, 7
  s_add_u32 s57, s57, s58
  s_lshl_b32 s57, s57, 10
  s_add_u32 s57, s57, 0x280000
  buffer_store_dwordx4 v[72:75], v5, s[20:23], s57 offen sc0 sc1
  v_add_f32 v145, v80, v81
  v_add_f32 v145, v145, v82
  v_add_f32 v145, v145, v83
  v_add_f32 v145, v145, v84
  v_add_f32 v145, v145, v85
  v_add_f32 v145, v145, v86
  v_add_f32 v145, v145, v87
  v_mov_b32 v155, v145
  s_nop 1
  v_permlane16_swap_b32 v155, v145
  s_nop 1
  v_add_f32 v145, v145, v155
  v_mov_b32 v155, v145
  s_nop 1
  v_permlane32_swap_b32 v155, v145
  s_nop 1
  v_add_f32 v145, v145, v155
  v_cvt_pk_bf16_f32 v80, v80, v81
  v_cvt_pk_bf16_f32 v81, v82, v83
  v_cvt_pk_bf16_f32 v82, v84, v85
  v_cvt_pk_bf16_f32 v83, v86, v87
  s_lshl_b32 s57, s61, 2
  s_add_u32 s57, s57, 1
  s_mul_i32 s58, s57, 9363
  s_lshr_b32 s58, s58, 16
  s_mul_i32 s59, s58, 7
  s_sub_u32 s57, s57, s59
  s_mul_i32 s58, s58, 20
  s_add_u32 s58, s58, s60
  s_mul_i32 s58, s58, 7
  s_add_u32 s57, s57, s58
  s_lshl_b32 s57, s57, 10
  s_add_u32 s57, s57, 0x280000
  buffer_store_dwordx4 v[80:83], v5, s[20:23], s57 offen sc0 sc1
  v_add_f32 v146, v88, v89
  v_add_f32 v146, v146, v90
  v_add_f32 v146, v146, v91
  v_add_f32 v146, v146, v92
  v_add_f32 v146, v146, v93
  v_add_f32 v146, v146, v94
  v_add_f32 v146, v146, v95
  v_mov_b32 v155, v146
  s_nop 1
  v_permlane16_swap_b32 v155, v146
  s_nop 1
  v_add_f32 v146, v146, v155
  v_mov_b32 v155, v146
  s_nop 1
  v_permlane32_swap_b32 v155, v146
  s_nop 1
  v_add_f32 v146, v146, v155
  v_cvt_pk_bf16_f32 v88, v88, v89
  v_cvt_pk_bf16_f32 v89, v90, v91
  v_cvt_pk_bf16_f32 v90, v92, v93
  v_cvt_pk_bf16_f32 v91, v94, v95
  s_lshl_b32 s57, s61, 2
  s_add_u32 s57, s57, 2
  s_mul_i32 s58, s57, 9363
  s_lshr_b32 s58, s58, 16
  s_mul_i32 s59, s58, 7
  s_sub_u32 s57, s57, s59
  s_mul_i32 s58, s58, 20
  s_add_u32 s58, s58, s60
  s_mul_i32 s58, s58, 7
  s_add_u32 s57, s57, s58
  s_lshl_b32 s57, s57, 10
  s_add_u32 s57, s57, 0x280000
  buffer_store_dwordx4 v[88:91], v5, s[20:23], s57 offen sc0 sc1
  v_add_f32 v147, v96, v97
  v_add_f32 v147, v147, v98
  v_add_f32 v147, v147, v99
  v_add_f32 v147, v147, v100
  v_add_f32 v147, v147, v101
  v_add_f32 v147, v147, v102
  v_add_f32 v147, v147, v103
  v_mov_b32 v155, v147
  s_nop 1
  v_permlane16_swap_b32 v155, v147
  s_nop 1
  v_add_f32 v147, v147, v155
  v_mov_b32 v155, v147
  s_nop 1
  v_permlane32_swap_b32 v155, v147
  s_nop 1
  v_add_f32 v147, v147, v155
  v_cvt_pk_bf16_f32 v96, v96, v97
  v_cvt_pk_bf16_f32 v97, v98, v99
  v_cvt_pk_bf16_f32 v98, v100, v101
  v_cvt_pk_bf16_f32 v99, v102, v103
  s_lshl_b32 s57, s61, 2
  s_add_u32 s57, s57, 3
  s_mul_i32 s58, s57, 9363
  s_lshr_b32 s58, s58, 16
  s_mul_i32 s59, s58, 7
  s_sub_u32 s57, s57, s59
  s_mul_i32 s58, s58, 20
  s_add_u32 s58, s58, s60
  s_mul_i32 s58, s58, 7
  s_add_u32 s57, s57, s58
  s_lshl_b32 s57, s57, 10
  s_add_u32 s57, s57, 0x280000
  buffer_store_dwordx4 v[96:99], v5, s[20:23], s57 offen sc0 sc1
  v_mov_b32 v148, v144
  v_cmp_eq_u32 vcc, 1, v4
  s_nop 1
  v_cndmask_b32 v148, v148, v145, vcc
  v_cmp_eq_u32 vcc, 2, v4
  s_nop 1
  v_cndmask_b32 v148, v148, v146, vcc
  v_cmp_eq_u32 vcc, 3, v4
  s_nop 1
  v_cndmask_b32 v148, v148, v147, vcc
  v_lshlrev_b32 v149, 2, v1
  s_mul_i32 s57, s60, 6912
  s_lshl_b32 s58, s61, 8
  s_add_u32 s57, s57, s58
  s_add_u32 s57, s57, 0x1540000
  buffer_store_dword v148, v149, s[20:23], s57 offen sc0 sc1
pr_f_done:
  s_waitcnt vmcnt(0)
  v_mov_b32 v20, 163616
  v_mov_b32 v21, 1
  s_mov_b64 exec, 1
  ds_add_u32 v20, v21
  s_mov_b64 exec, -1
  s_waitcnt lgkmcnt(0)
  s_branch pr_b2
pr_sync:
  v_readfirstlane_b32 s60, v166
  v_readfirstlane_b32 s61, v167
  s_lshl_b32 s57, s42, 7
  s_add_u32 s57, s57, 0x1490000
  v_mov_b32 v23, 0
  v_and_b32 v20, 31, v1
  v_lshlrev_b32 v20, 3, v20
  s_mov_b32 s58, 0
  s_cmp_lt_u32 s2, 8
  s_cbranch_scc1 pr_scan
pr_gopoll:
  buffer_load_dword v22, v23, s[20:23], s57 offen sc1
  s_waitcnt vmcnt(0)
  v_readfirstlane_b32 s59, v22
  s_add_u32 s58, s58, 1
  s_sub_u32 s59, s59, s60
  s_cmp_lg_u32 s59, 0
  s_cbranch_scc1 pr_go
  s_and_b32 s62, s58, 255
  s_cmp_lg_u32 s62, 0
  s_cbranch_scc1 pr_gopoll
pr_scan:
  buffer_load_dword v21, v20, s[96:99], 0 offen sc0 sc1
  s_waitcnt vmcnt(0)
  v_and_b32 v22, 0x0f0f0f0f, v21
  v_lshrrev_b32 v24, 4, v21
  v_and_b32 v24, 0x0f0f0f0f, v24
  v_add_u32 v22, v22, v24
  v_sad_u8 v22, v22, 0, 0
  s_add_u32 s58, s58, 1
  v_cmp_eq_u32 vcc, 8, v22
  s_cmp_eq_u64 vcc, -1
  s_cbranch_scc1 pr_scan_ok
  s_cmp_ge_u32 s58, 524288
  s_cbranch_scc1 pr_scan_fail
  s_cmp_lt_u32 s2, 8
  s_cbranch_scc1 pr_scan
  s_branch pr_gopoll
pr_scan_fail:
  s_mov_b32 s19, 1
pr_scan_ok:
  v_cmp_eq_u32 vcc, 0x11111111, v21
  s_cmp_eq_u64 vcc, -1
  s_cselect_b32 s59, 1, 2
  s_cmp_lt_u32 s2, 8
  s_cbranch_scc0 pr_go
  s_add_u32 s62, s60, s59
  v_mov_b32 v22, s62
  s_mov_b64 exec, 1
  buffer_store_dword v22, v23, s[20:23], s57 offen
  s_mov_b64 exec, -1
pr_go:
  s_cmp_eq_u32 s59, 1
  s_cbranch_scc1 pr_noinv
  buffer_inv sc1
pr_noinv:
  s_lshl_b32 s62, s42, 5
  s_lshr_b32 s63, s2, 3
  s_add_u32 s62, s62, s63
  s_cmp_eq_u32 s59, 1
  s_cselect_b32 s63, s62, s2
  s_cselect_b32 s62, 1, 0
  s_cmp_lg_u32 s19, 0
  s_cselect_b32 s59, 2, 0
  s_or_b32 s62, s62, s59
  v_mov_b32 v24, s63
  v_mov_b32 v25, s62
  v_mov_b32 v26, s61
  v_mov_b32 v27, s42
  v_mov_b32 v28, 163584
  s_mov_b64 exec, 1
  ds_write_b128 v28, v[24:27]
  s_mov_b64 exec, -1
  s_waitcnt vmcnt(0) lgkmcnt(0)
pr_b2:
  s_barrier
  v_mov_b32 v22, 163584
  ds_read_b128 v[24:27], v22
  s_waitcnt lgkmcnt(0)
  v_readfirstlane_b32 s45, v24
  v_readfirstlane_b32 s46, v25
  v_readfirstlane_b32 s101, v27
  s_nop 3
  s_lshr_b32 s40, s45, 4
  s_and_b32 s41, s45, 15
  s_and_b32 s17, s46, 1
  s_lshr_b32 s19, s46, 1
  s_cmp_lt_u32 s18, 4
  s_cbranch_scc1 c_start
  s_branch p_start
  .p2align 6
c_start:
  v_mov_b32 v21, 0
  v_mov_b32 v22, 163584
  v_and_b32 v24, 31, v1
  v_lshrrev_b32 v25, 5, v1
  v_bfe_u32 v30, v1, 4, 1
  v_mul_u32_u24 v30, 20480, v30
  v_lshlrev_b32 v31, 8, v25
  v_add_u32 v30, v30, v31
  v_lshlrev_b32 v31, 4, v3
  v_add_u32 v7, v30, v31
  s_and_b32 s47, s18, 1
  s_lshl_b32 s46, s47, 10
  v_add_u32 v9, s46, v5
  v_lshlrev_b32 v0, 2, v1
  s_lshl_b32 s56, s40, 8
  s_add_u32 s56, s56, 21504000
  s_mul_i32 s46, s47, 5120
  v_add_u32 v34, s46, v5
  v_add_u32 v35, s46, v6
  s_xor_b32 s46, s47, 1
  s_mul_i32 s46, s46, 109568
  v_add_u32 v2, s46, v5
  s_mul_i32 s46, s18, 5120
  s_add_u32 s46, s46, 114688
  v_add_u32 v27, s46, v5
  s_xor_b32 s46, s18, 1
  s_mul_i32 s46, s46, 5120
  s_add_u32 s46, s46, 114688
  v_add_u32 v28, s46, v5
  v_and_b32 v30, 1, v4
  v_lshlrev_b32 v30, 1, v30
  v_lshrrev_b32 v31, 1, v4
  v_add_u32 v30, v30, v31
  v_lshlrev_b32 v30, 8, v30
  v_lshlrev_b32 v31, 4, v3
  v_add_u32 v23, v30, v31
  v_and_b32 v30, 1, v4
  v_mul_u32_u24 v30, 57344, v30
  v_lshrrev_b32 v32, 1, v4
  v_lshlrev_b32 v32, 8, v32
  v_add_u32 v30, v30, v32
  v_add_u32 v29, v30, v31
  v_lshlrev_b32 v30, 6, v3
  v_mov_b32 v31, 0x80000000
  v_cmp_eq_u32 vcc, 0, v4
  s_nop 1
  v_cndmask_b32 v26, v31, v30, vcc
  s_lshl_b32 s61, s40, 8
  s_lshl_b32 s46, s41, 4
  s_add_u32 s61, s61, s46
  s_lshl_b32 s46, s18, 2
  s_add_u32 s61, s61, s46
  s_add_u32 s61, s61, 21504000
  s_lshl_b32 s46, s40, 3
  s_lshr_b32 s47, s41, 3
  s_lshl_b32 s47, s47, 2
  s_add_u32 s46, s46, s47
  s_add_u32 s46, s46, s18
  s_mul_i32 s46, s46, 20480
  s_and_b32 s47, s41, 7
  s_mul_i32 s47, s47, 160
  s_add_u32 s46, s46, s47
  v_mul_u32_u24 v30, 1280, v3
  v_lshlrev_b32 v31, 3, v4
  v_add_u32 v30, v30, v31
  buffer_load_dwordx2 v[10:11], v30, s[36:39], s46 offen offset:0
  buffer_load_dwordx2 v[12:13], v30, s[36:39], s46 offen offset:32
  buffer_load_dwordx2 v[14:15], v30, s[36:39], s46 offen offset:64
  buffer_load_dwordx2 v[16:17], v30, s[36:39], s46 offen offset:96
  buffer_load_dwordx2 v[18:19], v30, s[36:39], s46 offen offset:128
  v_bfe_u32 v30, v1, 4, 1
  s_lshl_b32 s46, s18, 1
  v_add_u32 v30, s46, v30
  v_cmp_le_u32 vcc, 8, v3
  v_cmp_eq_u32 s[48:49], 2, v30
  s_and_b64 s[48:49], s[48:49], vcc
  v_cmp_le_u32 vcc, 3, v30
  s_or_b64 s[48:49], s[48:49], vcc
  v_cmp_le_u32 vcc, 5, v30
  v_mov_b32 v31, 0
  v_mov_b32 v32, 0
  v_cndmask_b32 v31, v31, 2, s[48:49]
  v_cndmask_b32 v31, v31, 5, vcc
  v_mov_b32 v33, 256
  v_mov_b32 v62, 512
  v_cndmask_b32 v32, v32, v33, s[48:49]
  v_cndmask_b32 v32, v32, v62, vcc
  v_sub_u32 v30, v30, v31
  v_lshlrev_b32 v30, 6, v30
  v_lshlrev_b32 v31, 2, v3
  v_add_u32 v30, v30, v31
  v_add_u32 v30, v30, v32
  v_mul_u32_u24 v31, 12288, v25
  v_add_u32 v30, v30, v31
  s_mul_i32 s46, s41, 768
  s_add_u32 s46, s46, 0x1500000
  buffer_load_dword a32, v30, s[20:23], s46 offen
  s_add_u32 s46, s46, 24576
  buffer_load_dword a33, v30, s[20:23], s46 offen
  s_add_u32 s46, s46, 24576
  buffer_load_dword a34, v30, s[20:23], s46 offen
  s_add_u32 s46, s46, 24576
  buffer_load_dword a35, v30, s[20:23], s46 offen
  s_add_u32 s46, s46, 24576
  buffer_load_dword a36, v30, s[20:23], s46 offen
  s_add_u32 s46, s46, 24576
  buffer_load_dword a37, v30, s[20:23], s46 offen
  s_add_u32 s46, s46, 24576
  buffer_load_dword a38, v30, s[20:23], s46 offen
  s_add_u32 s46, s46, 24576
  buffer_load_dword a39, v30, s[20:23], s46 offen
  s_add_u32 s46, s46, 24576
  buffer_load_dword a40, v30, s[20:23], s46 offen
  s_add_u32 s46, s46, 24576
  buffer_load_dword a41, v30, s[20:23], s46 offen
  v_lshlrev_b32 v30, 2, v1
  v_add_u32 v30, 155648, v30
  s_mov_b32 exec_hi, 0
  s_mov_b32 exec_lo, 0xffffff
  ds_write_b32 v30, v21
  s_mov_b64 exec, -1
  s_waitcnt lgkmcnt(0)
  s_mov_b32 s16, 0
c_layer:
  s_mul_i32 s46, s16, 0
  s_add_u32 s46, s46, 20971520
  s_lshl_b32 s47, s40, 13
  s_add_u32 s46, s46, s47
  s_lshl_b32 s47, s18, 11
  s_add_u32 s46, s46, s47
  v_lshlrev_b32 v30, 6, v24
  v_lshlrev_b32 v31, 5, v25
  v_add_u32 v30, v30, v31
  s_mul_i32 s54, s16, 0
  s_add_u32 s54, s54, 8388608
  s_lshl_b32 s47, s40, 3
  s_lshl_b32 s48, s18, 1
  s_add_u32 s47, s47, s48
  s_mul_i32 s47, s47, 20480
  s_add_u32 s54, s54, s47
  s_lshl_b32 s57, s16, 2
  s_cmp_eq_u32 s57, 0
  s_cbranch_scc1 c_g1_ok2
  s_cmp_lg_u32 s18, 0
  s_cbranch_scc1 c_g1_ok2
  s_mov_b32 s58, 0
  v_mov_b32 v32, 0
c_g1_poll:
  buffer_load_dword v32, v0, s[20:23], s56 offen sc1
  s_waitcnt vmcnt(8)
  v_cmp_le_u32 vcc, s57, v32
  s_add_u32 s58, s58, 1
  s_cmp_eq_u64 vcc, -1
  s_cbranch_scc1 c_g1_ok
  s_cmp_lg_u32 s19, 0
  s_cbranch_scc1 c_g1_ok
  s_cmp_lt_u32 s58, 1048576
  s_cbranch_scc1 c_g1_poll
  s_mov_b32 s19, 1
c_g1_ok:
  s_cmp_lg_u32 s17, 0
  s_cbranch_scc1 c_g1_ok2
  s_waitcnt vmcnt(0)
  buffer_inv sc1
  s_waitcnt vmcnt(0)
c_g1_ok2:
  s_barrier
  buffer_load_dwordx4 v[116:119], v7, s[20:23], s54 offen offset:0 sc1
  buffer_load_dwordx4 v[120:123], v7, s[20:23], s54 offen offset:512 sc1
  buffer_load_dwordx4 v[124:127], v7, s[20:23], s54 offen offset:1024 sc1
  buffer_load_dwordx4 v[128:131], v7, s[20:23], s54 offen offset:1536 sc1
  buffer_load_dwordx4 v[132:135], v7, s[20:23], s54 offen offset:2048 sc1
  buffer_load_dwordx4 v[136:139], v7, s[20:23], s54 offen offset:2560 sc1
  buffer_load_dwordx4 v[140:143], v7, s[20:23], s54 offen offset:3072 sc1
  buffer_load_dwordx4 v[144:147], v7, s[20:23], s54 offen offset:3584 sc1
  ds_read_b128 a[0:3], v5 offset:0
  ds_read_b128 a[4:7], v5 offset:1024
  ds_read_b128 a[8:11], v5 offset:2048
  ds_read_b128 a[12:15], v5 offset:3072
  buffer_load_dwordx4 v[104:107], v30, s[20:23], s46 offen offset:0 sc1
  buffer_load_dwordx4 v[108:111], v30, s[20:23], s46 offen offset:16 sc1
  s_waitcnt vmcnt(9) lgkmcnt(3)
  v_mfma_f32_32x32x16_bf16 v[40:55], a[0:3], v[116:119], 0
  ds_read_b128 a[16:19], v5 offset:4096
  ds_read_b128 a[20:23], v5 offset:5120
  s_waitcnt lgkmcnt(4)
  v_mfma_f32_32x32x16_bf16 v[56:71], a[4:7], v[116:119], 0
  ds_read_b128 a[24:27], v5 offset:6144
  s_waitcnt lgkmcnt(4)
  v_mfma_f32_32x32x16_bf16 v[72:87], a[8:11], v[116:119], 0
  ds_read_b128 a[28:31], v5 offset:7168
  s_waitcnt lgkmcnt(4)
  v_mfma_f32_32x32x16_bf16 v[88:103], a[12:15], v[116:119], 0
  s_add_u32 s54, s54, 4096
  buffer_load_dwordx4 v[148:151], v7, s[20:23], s54 offen offset:0 sc1
  s_waitcnt vmcnt(9) lgkmcnt(3)
  v_mfma_f32_32x32x16_bf16 v[40:55], a[16:19], v[120:123], v[40:55]
  s_barrier
  ds_read_b128 a[0:3], v5 offset:8192
  ds_read_b128 a[4:7], v5 offset:9216
  s_waitcnt lgkmcnt(4)
  v_mfma_f32_32x32x16_bf16 v[56:71], a[20:23], v[120:123], v[56:71]
  ds_read_b128 a[8:11], v5 offset:10240
  s_waitcnt lgkmcnt(4)
  v_mfma_f32_32x32x16_bf16 v[72:87], a[24:27], v[120:123], v[72:87]
  ds_read_b128 a[12:15], v5 offset:11264
  s_waitcnt lgkmcnt(4)
  v_mfma_f32_32x32x16_bf16 v[88:103], a[28:31], v[120:123], v[88:103]
  buffer_load_dwordx4 v[152:155], v7, s[20:23], s54 offen offset:512 sc1
  s_waitcnt vmcnt(9) lgkmcnt(3)
  v_mfma_f32_32x32x16_bf16 v[40:55], a[0:3], v[124:127], v[40:55]
  ds_read_b128 a[16:19], v5 offset:12288
  ds_read_b128 a[20:23], v5 offset:13312
  s_waitcnt lgkmcnt(4)
  v_mfma_f32_32x32x16_bf16 v[56:71], a[4:7], v[124:127], v[56:71]
  ds_read_b128 a[24:27], v5 offset:14336
  s_waitcnt lgkmcnt(4)
  v_mfma_f32_32x32x16_bf16 v[72:87], a[8:11], v[124:127], v[72:87]
  ds_read_b128 a[28:31], v5 offset:15360
  s_waitcnt lgkmcnt(4)
  v_mfma_f32_32x32x16_bf16 v[88:103], a[12:15], v[124:127], v[88:103]
  buffer_load_dwordx4 v[156:159], v7, s[20:23], s54 offen offset:1024 sc1
  s_waitcnt vmcnt(9) lgkmcnt(3)
  v_mfma_f32_32x32x16_bf16 v[40:55], a[16:19], v[128:131], v[40:55]
  s_barrier
  ds_read_b128 a[0:3], v5 offset:16384
  ds_read_b128 a[4:7], v5 offset:17408
  s_waitcnt lgkmcnt(4)
  v_mfma_f32_32x32x16_bf16 v[56:71], a[20:23], v[128:131], v[56:71]
  ds_read_b128 a[8:11], v5 offset:18432
  s_waitcnt lgkmcnt(4)
  v_mfma_f32_32x32x16_bf16 v[72:87], a[24:27], v[128:131], v[72:87]
  ds_read_b128 a[12:15], v5 offset:19456
  s_waitcnt lgkmcnt(4)
  v_mfma_f32_32x32x16_bf16 v[88:103], a[28:31], v[128:131], v[88:103]
  buffer_load_dwordx4 v[160:163], v7, s[20:23], s54 offen offset:1536 sc1
  s_cmp_lg_u32 s16, 0
  s_cbranch_scc1 g1_nocsq
  v_accvgpr_read_b32 v31, a32
  v_accvgpr_read_b32 v32, a33
  s_nop 0
  v_add_f32 v31, v31, v32
  v_accvgpr_read_b32 v32, a34
  s_nop 0
  v_add_f32 v31, v31, v32
  v_accvgpr_read_b32 v32, a35
  s_nop 0
  v_add_f32 v31, v31, v32
  v_accvgpr_read_b32 v32, a36
  s_nop 0
  v_add_f32 v31, v31, v32
  v_accvgpr_read_b32 v32, a37
  s_nop 0
  v_add_f32 v31, v31, v32
  v_accvgpr_read_b32 v32, a38
  s_nop 0
  v_add_f32 v31, v31, v32
  v_accvgpr_read_b32 v32, a39
  s_nop 0
  v_add_f32 v31, v31, v32
  v_accvgpr_read_b32 v32, a40
  s_nop 0
  v_add_f32 v31, v31, v32
  v_accvgpr_read_b32 v32, a41
  s_nop 0
  v_add_f32 v31, v31, v32
  v_mov_b32 v32, v31
  s_nop 1
  v_permlane32_swap_b32 v32, v31
  s_nop 1
  v_add_f32 v31, v31, v32
  s_lshl_b32 s48, s18, 7
  s_add_u32 s48, s48, 162560
  v_lshlrev_b32 v33, 2, v24
  v_add_u32 v33, s48, v33
  s_mov_b32 exec_hi, 0
  ds_write_b32 v33, v31
  s_mov_b64 exec, -1
  s_waitcnt lgkmcnt(0)
g1_nocsq:
  s_waitcnt vmcnt(9) lgkmcnt(3)
  v_mfma_f32_32x32x16_bf16 v[40:55], a[0:3], v[132:135], v[40:55]
  ds_read_b128 a[16:19], v5 offset:20480
  ds_read_b128 a[20:23], v5 offset:21504
  s_waitcnt lgkmcnt(4)
  v_mfma_f32_32x32x16_bf16 v[56:71], a[4:7], v[132:135], v[56:71]
  ds_read_b128 a[24:27], v5 offset:22528
  s_waitcnt lgkmcnt(4)
  v_mfma_f32_32x32x16_bf16 v[72:87], a[8:11], v[132:135], v[72:87]
  ds_read_b128 a[28:31], v5 offset:23552
  s_waitcnt lgkmcnt(4)
  v_mfma_f32_32x32x16_bf16 v[88:103], a[12:15], v[132:135], v[88:103]
  buffer_load_dwordx4 v[164:167], v7, s[20:23], s54 offen offset:2048 sc1
  s_waitcnt vmcnt(9) lgkmcnt(3)
  v_mfma_f32_32x32x16_bf16 v[40:55], a[16:19], v[136:139], v[40:55]
  s_barrier
  ds_read_b128 a[0:3], v5 offset:24576
  ds_read_b128 a[4:7], v5 offset:25600
  s_waitcnt lgkmcnt(4)
  v_mfma_f32_32x32x16_bf16 v[56:71], a[20:23], v[136:139], v[56:71]
  ds_read_b128 a[8:11], v5 offset:26624
  s_waitcnt lgkmcnt(4)
  v_mfma_f32_32x32x16_bf16 v[72:87], a[24:27], v[136:139], v[72:87]
  ds_read_b128 a[12:15], v5 offset:27648
  s_waitcnt lgkmcnt(4)
  v_mfma_f32_32x32x16_bf16 v[88:103], a[28:31], v[136:139], v[88:103]
  buffer_load_dwordx4 v[168:171], v7, s[20:23], s54 offen offset:2560 sc1
  s_waitcnt vmcnt(9) lgkmcnt(3)
  v_mfma_f32_32x32x16_bf16 v[40:55], a[0:3], v[140:143], v[40:55]
  ds_read_b128 a[16:19], v5 offset:28672
  ds_read_b128 a[20:23], v5 offset:29696
  s_waitcnt lgkmcnt(4)
  v_mfma_f32_32x32x16_bf16 v[56:71], a[4:7], v[140:143], v[56:71]
  ds_read_b128 a[24:27], v5 offset:30720
  s_waitcnt lgkmcnt(4)
  v_mfma_f32_32x32x16_bf16 v[72:87], a[8:11], v[140:143], v[72:87]
  ds_read_b128 a[28:31], v5 offset:31744
  s_waitcnt lgkmcnt(4)
  v_mfma_f32_32x32x16_bf16 v[88:103], a[12:15], v[140:143], v[88:103]
  buffer_load_dwordx4 v[172:175], v7, s[20:23], s54 offen offset:3072 sc1
  s_waitcnt vmcnt(9) lgkmcnt(3)
  v_mfma_f32_32x32x16_bf16 v[40:55], a[16:19], v[144:147], v[40:55]
  s_barrier
  ds_read_b128 a[0:3], v5 offset:32768
  ds_read_b128 a[4:7], v5 offset:33792
  s_waitcnt lgkmcnt(4)
  v_mfma_f32_32x32x16_bf16 v[56:71], a[20:23], v[144:147], v[56:71]
  ds_read_b128 a[8:11], v5 offset:34816
  s_waitcnt lgkmcnt(4)
  v_mfma_f32_32x32x16_bf16 v[72:87], a[24:27], v[144:147], v[72:87]
  ds_read_b128 a[12:15], v5 offset:35840
  s_waitcnt lgkmcnt(4)
  v_mfma_f32_32x32x16_bf16 v[88:103], a[28:31], v[144:147], v[88:103]
  buffer_load_dwordx4 v[176:179], v7, s[20:23], s54 offen offset:3584 sc1
  s_waitcnt vmcnt(7) lgkmcnt(3)
  v_mfma_f32_32x32x16_bf16 v[40:55], a[0:3], v[148:151], v[40:55]
  ds_read_b128 a[16:19], v5 offset:36864
  ds_read_b128 a[20:23], v5 offset:37888
  s_waitcnt lgkmcnt(4)
  v_mfma_f32_32x32x16_bf16 v[56:71], a[4:7], v[148:151], v[56:71]
  ds_read_b128 a[24:27], v5 offset:38912
  s_waitcnt lgkmcnt(4)
  v_mfma_f32_32x32x16_bf16 v[72:87], a[8:11], v[148:151], v[72:87]
  ds_read_b128 a[28:31], v5 offset:39936
  s_waitcnt lgkmcnt(4)
  v_mfma_f32_32x32x16_bf16 v[88:103], a[12:15], v[148:151], v[88:103]
  s_add_u32 s54, s54, 4096
  buffer_load_dwordx4 v[180:183], v7, s[20:23], s54 offen offset:0 sc1
  s_waitcnt vmcnt(7) lgkmcnt(3)
  v_mfma_f32_32x32x16_bf16 v[40:55], a[16:19], v[152:155], v[40:55]
  s_barrier
  ds_read_b128 a[0:3], v5 offset:40960
  ds_read_b128 a[4:7], v5 offset:41984
  s_waitcnt lgkmcnt(4)
  v_mfma_f32_32x32x16_bf16 v[56:71], a[20:23], v[152:155], v[56:71]
  ds_read_b128 a[8:11], v5 offset:43008
  s_waitcnt lgkmcnt(4)
  v_mfma_f32_32x32x16_bf16 v[72:87], a[24:27], v[152:155], v[72:87]
  ds_read_b128 a[12:15], v5 offset:44032
  s_waitcnt lgkmcnt(4)
  v_mfma_f32_32x32x16_bf16 v[88:103], a[28:31], v[152:155], v[88:103]
  buffer_load_dwordx4 v[116:119], v7, s[20:23], s54 offen offset:512 sc1
  s_waitcnt vmcnt(7) lgkmcnt(3)
  v_mfma_f32_32x32x16_bf16 v[40:55], a[0:3], v[156:159], v[40:55]
  ds_read_b128 a[16:19], v5 offset:45056
  ds_read_b128 a[20:23], v5 offset:46080
  s_waitcnt lgkmcnt(4)
  v_mfma_f32_32x32x16_bf16 v[56:71], a[4:7], v[156:159], v[56:71]
  ds_read_b128 a[24:27], v5 offset:47104
  s_waitcnt lgkmcnt(4)
  v_mfma_f32_32x32x16_bf16 v[72:87], a[8:11], v[156:159], v[72:87]
  ds_read_b128 a[28:31], v5 offset:48128
  s_waitcnt lgkmcnt(4)
  v_mfma_f32_32x32x16_bf16 v[88:103], a[12:15], v[156:159], v[88:103]
  buffer_load_dwordx4 v[120:123], v7, s[20:23], s54 offen offset:1024 sc1
  s_waitcnt vmcnt(7) lgkmcnt(3)
  v_mfma_f32_32x32x16_bf16 v[40:55], a[16:19], v[160:163], v[40:55]
  s_barrier
  ds_read_b128 a[0:3], v5 offset:49152
  ds_read_b128 a[4:7], v5 offset:50176
  s_waitcnt lgkmcnt(4)
  v_mfma_f32_32x32x16_bf16 v[56:71], a[20:23], v[160:163], v[56:71]
  ds_read_b128 a[8:11], v5 offset:51200
  s_waitcnt lgkmcnt(4)
  v_mfma_f32_32x32x16_bf16 v[72:87], a[24:27], v[160:163], v[72:87]
  ds_read_b128 a[12:15], v5 offset:52224
  s_waitcnt lgkmcnt(4)
  v_mfma_f32_32x32x16_bf16 v[88:103], a[28:31], v[160:163], v[88:103]
  buffer_load_dwordx4 v[124:127], v7, s[20:23], s54 offen offset:1536 sc1
  s_waitcnt vmcnt(7) lgkmcnt(3)
  v_mfma_f32_32x32x16_bf16 v[40:55], a[0:3], v[164:167], v[40:55]
  ds_read_b128 a[16:19], v5 offset:53248
  ds_read_b128 a[20:23], v5 offset:54272
  v_add_f32 v112, v104, v106
  v_add_f32 v112, v112, v108
  s_waitcnt lgkmcnt(4)
  v_mfma_f32_32x32x16_bf16 v[56:71], a[4:7], v[164:167], v[56:71]
  ds_read_b128 a[24:27], v5 offset:55296
  v_add_f32 v112, v112, v110
  v_mov_b32 v113, v112
  s_waitcnt lgkmcnt(4)
  v_mfma_f32_32x32x16_bf16 v[72:87], a[8:11], v[164:167], v[72:87]
  ds_read_b128 a[28:31], v5 offset:56320
  s_nop 1
  v_permlane32_swap_b32 v113, v112
  s_waitcnt lgkmcnt(4)
  v_mfma_f32_32x32x16_bf16 v[88:103], a[12:15], v[164:167], v[88:103]
  buffer_load_dwordx4 v[128:131], v7, s[20:23], s54 offen offset:2048 sc1
  s_nop 1
  v_add_f32 v112, v112, v113
  s_waitcnt vmcnt(7) lgkmcnt(3)
  v_mfma_f32_32x32x16_bf16 v[40:55], a[16:19], v[168:171], v[40:55]
  s_barrier
  ds_read_b128 a[0:3], v5 offset:57344
  ds_read_b128 a[4:7], v5 offset:58368
  v_mul_f32 v112, 0x3e000000, v112
  v_add_f32 v114, v105, v107
  s_waitcnt lgkmcnt(4)
  v_mfma_f32_32x32x16_bf16 v[56:71], a[20:23], v[168:171], v[56:71]
  ds_read_b128 a[8:11], v5 offset:59392
  v_add_f32 v114, v114, v109
  v_add_f32 v114, v114, v111
  s_waitcnt lgkmcnt(4)
  v_mfma_f32_32x32x16_bf16 v[72:87], a[24:27], v[168:171], v[72:87]
  ds_read_b128 a[12:15], v5 offset:60416
  v_mov_b32 v115, 0
  v_sub_f32 v104, v104, v112
  s_waitcnt lgkmcnt(4)
  v_mfma_f32_32x32x16_bf16 v[88:103], a[28:31], v[168:171], v[88:103]
  buffer_load_dwordx4 v[132:135], v7, s[20:23], s54 offen offset:2560 sc1
  v_fmac_f32 v115, v104, v104
  v_sub_f32 v106, v106, v112
  s_waitcnt vmcnt(7) lgkmcnt(3)
  v_mfma_f32_32x32x16_bf16 v[40:55], a[0:3], v[172:175], v[40:55]
  ds_read_b128 a[16:19], v5 offset:61440
  ds_read_b128 a[20:23], v5 offset:62464
  v_fmac_f32 v115, v106, v106
  v_sub_f32 v108, v108, v112
  s_waitcnt lgkmcnt(4)
  v_mfma_f32_32x32x16_bf16 v[56:71], a[4:7], v[172:175], v[56:71]
  ds_read_b128 a[24:27], v5 offset:63488
  v_fmac_f32 v115, v108, v108
  v_sub_f32 v110, v110, v112
  s_waitcnt lgkmcnt(4)
  v_mfma_f32_32x32x16_bf16 v[72:87], a[8:11], v[172:175], v[72:87]
  ds_read_b128 a[28:31], v5 offset:64512
  v_fmac_f32 v115, v110, v110
  v_fmamk_f32 v114, v115, 0x42a00000, v114
  s_waitcnt lgkmcnt(4)
  v_mfma_f32_32x32x16_bf16 v[88:103], a[12:15], v[172:175], v[88:103]
  buffer_load_dwordx4 v[136:139], v7, s[20:23], s54 offen offset:3072 sc1
  v_mov_b32 v113, v114
  s_nop 1
  s_waitcnt vmcnt(7) lgkmcnt(3)
  v_mfma_f32_32x32x16_bf16 v[40:55], a[16:19], v[176:179], v[40:55]
  s_barrier
  ds_read_b128 a[0:3], v6 offset:0
  ds_read_b128 a[4:7], v6 offset:1024
  v_permlane32_swap_b32 v113, v114
  s_nop 1
  s_waitcnt lgkmcnt(4)
  v_mfma_f32_32x32x16_bf16 v[56:71], a[20:23], v[176:179], v[56:71]
  ds_read_b128 a[8:11], v6 offset:2048
  v_add_f32 v114, v114, v113
  v_mul_f32 v114, 0x3acccccd, v114
  s_waitcnt lgkmcnt(4)
  v_mfma_f32_32x32x16_bf16 v[72:87], a[24:27], v[176:179], v[72:87]
  ds_read_b128 a[12:15], v6 offset:3072
  v_add_f32 v115, 0x3727c5ac, v114
  v_rsq_f32 v36, v115
  s_waitcnt lgkmcnt(4)
  v_mfma_f32_32x32x16_bf16 v[88:103], a[28:31], v[176:179], v[88:103]
  buffer_load_dwordx4 v[140:143], v7, s[20:23], s54 offen offset:3584 sc1
  s_nop 0
  v_mul_f32 v38, -1.0, v112
  s_waitcnt vmcnt(7) lgkmcnt(3)
  v_mfma_f32_32x32x16_bf16 v[40:55], a[0:3], v[180:183], v[40:55]
  ds_read_b128 a[16:19], v6 offset:4096
  ds_read_b128 a[20:23], v6 offset:5120
  v_mul_f32 v37, 0x3fb8aa3b, v36
  s_waitcnt lgkmcnt(4)
  v_mfma_f32_32x32x16_bf16 v[56:71], a[4:7], v[180:183], v[56:71]
  ds_read_b128 a[24:27], v6 offset:6144
  s_waitcnt lgkmcnt(4)
  v_mfma_f32_32x32x16_bf16 v[72:87], a[8:11], v[180:183], v[72:87]
  ds_read_b128 a[28:31], v6 offset:7168
  s_waitcnt lgkmcnt(4)
  v_mfma_f32_32x32x16_bf16 v[88:103], a[12:15], v[180:183], v[88:103]
  s_add_u32 s54, s54, 4096
  buffer_load_dwordx4 v[144:147], v7, s[20:23], s54 offen offset:0 sc1
  s_waitcnt vmcnt(7) lgkmcnt(3)
  v_mfma_f32_32x32x16_bf16 v[40:55], a[16:19], v[116:119], v[40:55]
  s_barrier
  ds_read_b128 a[0:3], v6 offset:8192
  ds_read_b128 a[4:7], v6 offset:9216
  s_waitcnt lgkmcnt(4)
  v_mfma_f32_32x32x16_bf16 v[56:71], a[20:23], v[116:119], v[56:71]
  ds_read_b128 a[8:11], v6 offset:10240
  s_waitcnt lgkmcnt(4)
  v_mfma_f32_32x32x16_bf16 v[72:87], a[24:27], v[116:119], v[72:87]
  ds_read_b128 a[12:15], v6 offset:11264
  s_waitcnt lgkmcnt(4)
  v_mfma_f32_32x32x16_bf16 v[88:103], a[28:31], v[116:119], v[88:103]
  buffer_load_dwordx4 v[148:151], v7, s[20:23], s54 offen offset:512 sc1
  s_waitcnt vmcnt(7) lgkmcnt(3)
  v_mfma_f32_32x32x16_bf16 v[40:55], a[0:3], v[120:123], v[40:55]
  ds_read_b128 a[16:19], v6 offset:12288
  ds_read_b128 a[20:23], v6 offset:13312
  s_waitcnt lgkmcnt(4)
  v_mfma_f32_32x32x16_bf16 v[56:71], a[4:7], v[120:123], v[56:71]
  ds_read_b128 a[24:27], v6 offset:14336
  s_waitcnt lgkmcnt(4)
  v_mfma_f32_32x32x16_bf16 v[72:87], a[8:11], v[120:123], v[72:87]
  ds_read_b128 a[28:31], v6 offset:15360
  s_waitcnt lgkmcnt(4)
  v_mfma_f32_32x32x16_bf16 v[88:103], a[12:15], v[120:123], v[88:103]
  buffer_load_dwordx4 v[152:155], v7, s[20:23], s54 offen offset:1024 sc1
  s_waitcnt vmcnt(7) lgkmcnt(3)
  v_mfma_f32_32x32x16_bf16 v[40:55], a[16:19], v[124:127], v[40:55]
  s_barrier
  ds_read_b128 a[0:3], v6 offset:16384
  ds_read_b128 a[4:7], v6 offset:17408
  s_waitcnt lgkmcnt(4)
  v_mfma_f32_32x32x16_bf16 v[56:71], a[20:23], v[124:127], v[56:71]
  ds_read_b128 a[8:11], v6 offset:18432
  s_waitcnt lgkmcnt(4)
  v_mfma_f32_32x32x16_bf16 v[72:87], a[24:27], v[124:127], v[72:87]
  ds_read_b128 a[12:15], v6 offset:19456
  s_waitcnt lgkmcnt(4)
  v_mfma_f32_32x32x16_bf16 v[88:103], a[28:31], v[124:127], v[88:103]
  buffer_load_dwordx4 v[156:159], v7, s[20:23], s54 offen offset:1536 sc1
  s_waitcnt vmcnt(7) lgkmcnt(3)
  v_mfma_f32_32x32x16_bf16 v[40:55], a[0:3], v[128:131], v[40:55]
  ds_read_b128 a[16:19], v6 offset:20480
  ds_read_b128 a[20:23], v6 offset:21504
  s_waitcnt lgkmcnt(4)
  v_mfma_f32_32x32x16_bf16 v[56:71], a[4:7], v[128:131], v[56:71]
  ds_read_b128 a[24:27], v6 offset:22528
  s_waitcnt lgkmcnt(4)
  v_mfma_f32_32x32x16_bf16 v[72:87], a[8:11], v[128:131], v[72:87]
  ds_read_b128 a[28:31], v6 offset:23552
  s_waitcnt lgkmcnt(4)
  v_mfma_f32_32x32x16_bf16 v[88:103], a[12:15], v[128:131], v[88:103]
  buffer_load_dwordx4 v[160:163], v7, s[20:23], s54 offen offset:2048 sc1
  s_waitcnt vmcnt(7) lgkmcnt(3)
  v_mfma_f32_32x32x16_bf16 v[40:55], a[16:19], v[132:135], v[40:55]
  s_barrier
  ds_read_b128 a[0:3], v6 offset:24576
  ds_read_b128 a[4:7], v6 offset:25600
  s_waitcnt lgkmcnt(4)
  v_mfma_f32_32x32x16_bf16 v[56:71], a[20:23], v[132:135], v[56:71]
  ds_read_b128 a[8:11], v6 offset:26624
  s_waitcnt lgkmcnt(4)
  v_mfma_f32_32x32x16_bf16 v[72:87], a[24:27], v[132:135], v[72:87]
  ds_read_b128 a[12:15], v6 offset:27648
  s_waitcnt lgkmcnt(4)
  v_mfma_f32_32x32x16_bf16 v[88:103], a[28:31], v[132:135], v[88:103]
  buffer_load_dwordx4 v[164:167], v7, s[20:23], s54 offen offset:2560 sc1
  s_waitcnt vmcnt(7) lgkmcnt(3)
  v_mfma_f32_32x32x16_bf16 v[40:55], a[0:3], v[136:139], v[40:55]
  ds_read_b128 a[16:19], v6 offset:28672
  ds_read_b128 a[20:23], v6 offset:29696
  s_waitcnt lgkmcnt(4)
  v_mfma_f32_32x32x16_bf16 v[56:71], a[4:7], v[136:139], v[56:71]
  ds_read_b128 a[24:27], v6 offset:30720
  s_waitcnt lgkmcnt(4)
  v_mfma_f32_32x32x16_bf16 v[72:87], a[8:11], v[136:139], v[72:87]
  ds_read_b128 a[28:31], v6 offset:31744
  s_waitcnt lgkmcnt(4)
  v_mfma_f32_32x32x16_bf16 v[88:103], a[12:15], v[136:139], v[88:103]
  buffer_load_dwordx4 v[168:171], v7, s[20:23], s54 offen offset:3072 sc1
  s_waitcnt vmcnt(7) lgkmcnt(3)
  v_mfma_f32_32x32x16_bf16 v[40:55], a[16:19], v[140:143], v[40:55]
  s_barrier
  ds_read_b128 a[0:3], v6 offset:32768
  ds_read_b128 a[4:7], v6 offset:33792
  s_waitcnt lgkmcnt(4)
  v_mfma_f32_32x32x16_bf16 v[56:71], a[20:23], v[140:143], v[56:71]
  ds_read_b128 a[8:11], v6 offset:34816
  s_waitcnt lgkmcnt(4)
  v_mfma_f32_32x32x16_bf16 v[72:87], a[24:27], v[140:143], v[72:87]
  ds_read_b128 a[12:15], v6 offset:35840
  s_waitcnt lgkmcnt(4)
  v_mfma_f32_32x32x16_bf16 v[88:103], a[28:31], v[140:143], v[88:103]
  buffer_load_dwordx4 v[172:175], v7, s[20:23], s54 offen offset:3584 sc1
  s_waitcnt vmcnt(7) lgkmcnt(3)
  v_mfma_f32_32x32x16_bf16 v[40:55], a[0:3], v[144:147], v[40:55]
  ds_read_b128 a[16:19], v6 offset:36864
  ds_read_b128 a[20:23], v6 offset:37888
  s_waitcnt lgkmcnt(4)
  v_mfma_f32_32x32x16_bf16 v[56:71], a[4:7], v[144:147], v[56:71]
  ds_read_b128 a[24:27], v6 offset:38912
  s_waitcnt lgkmcnt(4)
  v_mfma_f32_32x32x16_bf16 v[72:87], a[8:11], v[144:147], v[72:87]
  ds_read_b128 a[28:31], v6 offset:39936
  s_waitcnt lgkmcnt(4)
  v_mfma_f32_32x32x16_bf16 v[88:103], a[12:15], v[144:147], v[88:103]
  s_add_u32 s54, s54, 4096
  buffer_load_dwordx4 v[176:179], v7, s[20:23], s54 offen offset:0 sc1
  s_waitcnt vmcnt(7) lgkmcnt(3)
  v_mfma_f32_32x32x16_bf16 v[40:55], a[16:19], v[148:151], v[40:55]
  s_barrier
  ds_read_b128 a[0:3], v6 offset:40960
  ds_read_b128 a[4:7], v6 offset:41984
  s_waitcnt lgkmcnt(4)
  v_mfma_f32_32x32x16_bf16 v[56:71], a[20:23], v[148:151], v[56:71]
  ds_read_b128 a[8:11], v6 offset:43008
  s_waitcnt lgkmcnt(4)
  v_mfma_f32_32x32x16_bf16 v[72:87], a[24:27], v[148:151], v[72:87]
  ds_read_b128 a[12:15], v6 offset:44032
  s_waitcnt lgkmcnt(4)
  v_mfma_f32_32x32x16_bf16 v[88:103], a[28:31], v[148:151], v[88:103]
  buffer_load_dwordx4 v[180:183], v7, s[20:23], s54 offen offset:512 sc1
  s_waitcnt vmcnt(7) lgkmcnt(3)
  v_mfma_f32_32x32x16_bf16 v[40:55], a[0:3], v[152:155], v[40:55]
  ds_read_b128 a[16:19], v6 offset:45056
  ds_read_b128 a[20:23], v6 offset:46080
  s_waitcnt lgkmcnt(4)
  v_mfma_f32_32x32x16_bf16 v[56:71], a[4:7], v[152:155], v[56:71]
  ds_read_b128 a[24:27], v6 offset:47104
  s_waitcnt lgkmcnt(4)
  v_mfma_f32_32x32x16_bf16 v[72:87], a[8:11], v[152:155], v[72:87]
  ds_read_b128 a[28:31], v6 offset:48128
  s_waitcnt lgkmcnt(4)
  v_mfma_f32_32x32x16_bf16 v[88:103], a[12:15], v[152:155], v[88:103]
  buffer_load_dwordx4 v[116:119], v7, s[20:23], s54 offen offset:1024 sc1
  s_waitcnt vmcnt(7) lgkmcnt(3)
  v_mfma_f32_32x32x16_bf16 v[40:55], a[16:19], v[156:159], v[40:55]
  s_barrier
  ds_read_b128 a[0:3], v5 offset:0
  ds_read_b128 a[4:7], v5 offset:1024
  s_waitcnt lgkmcnt(4)
  v_mfma_f32_32x32x16_bf16 v[56:71], a[20:23], v[156:159], v[56:71]
  ds_read_b128 a[8:11], v5 offset:2048
  s_waitcnt lgkmcnt(4)
  v_mfma_f32_32x32x16_bf16 v[72:87], a[24:27], v[156:159], v[72:87]
  ds_read_b128 a[12:15], v5 offset:3072
  s_waitcnt lgkmcnt(4)
  v_mfma_f32_32x32x16_bf16 v[88:103], a[28:31], v[156:159], v[88:103]
  buffer_load_dwordx4 v[120:123], v7, s[20:23], s54 offen offset:1536 sc1
  s_waitcnt vmcnt(7) lgkmcnt(3)
  v_mfma_f32_32x32x16_bf16 v[40:55], a[0:3], v[160:163], v[40:55]
  ds_read_b128 a[16:19], v5 offset:4096
  ds_read_b128 a[20:23], v5 offset:5120
  s_waitcnt lgkmcnt(4)
  v_mfma_f32_32x32x16_bf16 v[56:71], a[4:7], v[160:163], v[56:71]
  ds_read_b128 a[24:27], v5 offset:6144
  s_waitcnt lgkmcnt(4)
  v_mfma_f32_32x32x16_bf16 v[72:87], a[8:11], v[160:163], v[72:87]
  ds_read_b128 a[28:31], v5 offset:7168
  s_waitcnt lgkmcnt(4)
  v_mfma_f32_32x32x16_bf16 v[88:103], a[12:15], v[160:163], v[88:103]
  buffer_load_dwordx4 v[124:127], v7, s[20:23], s54 offen offset:2048 sc1
  s_waitcnt vmcnt(7) lgkmcnt(3)
  v_mfma_f32_32x32x16_bf16 v[40:55], a[16:19], v[164:167], v[40:55]
  s_barrier
  ds_read_b128 a[0:3], v5 offset:8192
  ds_read_b128 a[4:7], v5 offset:9216
  s_waitcnt lgkmcnt(4)
  v_mfma_f32_32x32x16_bf16 v[56:71], a[20:23], v[164:167], v[56:71]
  ds_read_b128 a[8:11], v5 offset:10240
  s_waitcnt lgkmcnt(4)
  v_mfma_f32_32x32x16_bf16 v[72:87], a[24:27], v[164:167], v[72:87]
  ds_read_b128 a[12:15], v5 offset:11264
  s_waitcnt lgkmcnt(4)
  v_mfma_f32_32x32x16_bf16 v[88:103], a[28:31], v[164:167], v[88:103]
  buffer_load_dwordx4 v[128:131], v7, s[20:23], s54 offen offset:2560 sc1
  s_waitcnt vmcnt(7) lgkmcnt(3)
  v_mfma_f32_32x32x16_bf16 v[40:55], a[0:3], v[168:171], v[40:55]
  ds_read_b128 a[16:19], v5 offset:12288
  ds_read_b128 a[20:23], v5 offset:13312
  s_waitcnt lgkmcnt(4)
  v_mfma_f32_32x32x16_bf16 v[56:71], a[4:7], v[168:171], v[56:71]
  ds_read_b128 a[24:27], v5 offset:14336
  s_waitcnt lgkmcnt(4)
  v_mfma_f32_32x32x16_bf16 v[72:87], a[8:11], v[168:171], v[72:87]
  ds_read_b128 a[28:31], v5 offset:15360
  s_waitcnt lgkmcnt(4)
  v_mfma_f32_32x32x16_bf16 v[88:103], a[12:15], v[168:171], v[88:103]
  buffer_load_dwordx4 v[132:135], v7, s[20:23], s54 offen offset:3072 sc1
  s_waitcnt vmcnt(7) lgkmcnt(3)
  v_mfma_f32_32x32x16_bf16 v[40:55], a[16:19], v[172:175], v[40:55]
  s_barrier
  ds_read_b128 a[0:3], v5 offset:16384
  ds_read_b128 a[4:7], v5 offset:17408
  s_waitcnt lgkmcnt(4)
  v_mfma_f32_32x32x16_bf16 v[56:71], a[20:23], v[172:175], v[56:71]
  ds_read_b128 a[8:11], v5 offset:18432
  s_waitcnt lgkmcnt(4)
  v_mfma_f32_32x32x16_bf16 v[72:87], a[24:27], v[172:175], v[72:87]
  ds_read_b128 a[12:15], v5 offset:19456
  s_waitcnt lgkmcnt(4)
  v_mfma_f32_32x32x16_bf16 v[88:103], a[28:31], v[172:175], v[88:103]
  buffer_load_dwordx4 v[136:139], v7, s[20:23], s54 offen offset:3584 sc1
  s_waitcnt vmcnt(7) lgkmcnt(3)
  v_mfma_f32_32x32x16_bf16 v[40:55], a[0:3], v[176:179], v[40:55]
  ds_read_b128 a[16:19], v5 offset:20480
  ds_read_b128 a[20:23], v5 offset:21504
  s_waitcnt lgkmcnt(4)
  v_mfma_f32_32x32x16_bf16 v[56:71], a[4:7], v[176:179], v[56:71]
  ds_read_b128 a[24:27], v5 offset:22528
  s_waitcnt lgkmcnt(4)
  v_mfma_f32_32x32x16_bf16 v[72:87], a[8:11], v[176:179], v[72:87]
  ds_read_b128 a[28:31], v5 offset:23552
  s_waitcnt lgkmcnt(4)
  v_mfma_f32_32x32x16_bf16 v[88:103], a[12:15], v[176:179], v[88:103]
  s_waitcnt vmcnt(6) lgkmcnt(3)
  v_mfma_f32_32x32x16_bf16 v[40:55], a[16:19], v[180:183], v[40:55]
  s_barrier
  ds_read_b128 a[0:3], v5 offset:24576
  ds_read_b128 a[4:7], v5 offset:25600
  s_waitcnt lgkmcnt(4)
  v_mfma_f32_32x32x16_bf16 v[56:71], a[20:23], v[180:183], v[56:71]
  ds_read_b128 a[8:11], v5 offset:26624
  s_waitcnt lgkmcnt(4)
  v_mfma_f32_32x32x16_bf16 v[72:87], a[24:27], v[180:183], v[72:87]
  ds_read_b128 a[12:15], v5 offset:27648
  s_waitcnt lgkmcnt(4)
  v_mfma_f32_32x32x16_bf16 v[88:103], a[28:31], v[180:183], v[88:103]
  s_waitcnt vmcnt(5) lgkmcnt(3)
  v_mfma_f32_32x32x16_bf16 v[40:55], a[0:3], v[116:119], v[40:55]
  ds_read_b128 a[16:19], v5 offset:28672
  ds_read_b128 a[20:23], v5 offset:29696
  s_waitcnt lgkmcnt(4)
  v_mfma_f32_32x32x16_bf16 v[56:71], a[4:7], v[116:119], v[56:71]
  ds_read_b128 a[24:27], v5 offset:30720
  s_waitcnt lgkmcnt(4)
  v_mfma_f32_32x32x16_bf16 v[72:87], a[8:11], v[116:119], v[72:87]
  ds_read_b128 a[28:31], v5 offset:31744
  s_waitcnt lgkmcnt(4)
  v_mfma_f32_32x32x16_bf16 v[88:103], a[12:15], v[116:119], v[88:103]
  s_waitcnt vmcnt(4) lgkmcnt(3)
  v_mfma_f32_32x32x16_bf16 v[40:55], a[16:19], v[120:123], v[40:55]
  s_barrier
  ds_read_b128 a[0:3], v5 offset:32768
  ds_read_b128 a[4:7], v5 offset:33792
  s_waitcnt lgkmcnt(4)
  v_mfma_f32_32x32x16_bf16 v[56:71], a[20:23], v[120:123], v[56:71]
  ds_read_b128 a[8:11], v5 offset:34816
  s_waitcnt lgkmcnt(4)
  v_mfma_f32_32x32x16_bf16 v[72:87], a[24:27], v[120:123], v[72:87]
  ds_read_b128 a[12:15], v5 offset:35840
  s_waitcnt lgkmcnt(4)
  v_mfma_f32_32x32x16_bf16 v[88:103], a[28:31], v[120:123], v[88:103]
  s_waitcnt vmcnt(3) lgkmcnt(3)
  v_mfma_f32_32x32x16_bf16 v[40:55], a[0:3], v[124:127], v[40:55]
  ds_read_b128 a[16:19], v5 offset:36864
  ds_read_b128 a[20:23], v5 offset:37888
  s_waitcnt lgkmcnt(4)
  v_mfma_f32_32x32x16_bf16 v[56:71], a[4:7], v[124:127], v[56:71]
  ds_read_b128 a[24:27], v5 offset:38912
  s_waitcnt lgkmcnt(4)
  v_mfma_f32_32x32x16_bf16 v[72:87], a[8:11], v[124:127], v[72:87]
  ds_read_b128 a[28:31], v5 offset:39936
  s_waitcnt lgkmcnt(4)
  v_mfma_f32_32x32x16_bf16 v[88:103], a[12:15], v[124:127], v[88:103]
  s_waitcnt vmcnt(2) lgkmcnt(3)
  v_mfma_f32_32x32x16_bf16 v[40:55], a[16:19], v[128:131], v[40:55]
  s_barrier
  ds_read_b128 a[0:3], v5 offset:40960
  ds_read_b128 a[4:7], v5 offset:41984
  s_waitcnt lgkmcnt(4)
  v_mfma_f32_32x32x16_bf16 v[56:71], a[20:23], v[128:131], v[56:71]
  ds_read_b128 a[8:11], v5 offset:43008
  s_waitcnt lgkmcnt(4)
  v_mfma_f32_32x32x16_bf16 v[72:87], a[24:27], v[128:131], v[72:87]
  ds_read_b128 a[12:15], v5 offset:44032
  s_waitcnt lgkmcnt(4)
  v_mfma_f32_32x32x16_bf16 v[88:103], a[28:31], v[128:131], v[88:103]
  s_waitcnt vmcnt(1) lgkmcnt(3)
  v_mfma_f32_32x32x16_bf16 v[40:55], a[0:3], v[132:135], v[40:55]
  ds_read_b128 a[16:19], v5 offset:45056
  ds_read_b128 a[20:23], v5 offset:46080
  s_waitcnt lgkmcnt(4)
  v_mfma_f32_32x32x16_bf16 v[56:71], a[4:7], v[132:135], v[56:71]
  ds_read_b128 a[24:27], v5 offset:47104
  s_waitcnt lgkmcnt(4)
  v_mfma_f32_32x32x16_bf16 v[72:87], a[8:11], v[132:135], v[72:87]
  ds_read_b128 a[28:31], v5 offset:48128
  s_waitcnt lgkmcnt(4)
  v_mfma_f32_32x32x16_bf16 v[88:103], a[12:15], v[132:135], v[88:103]
  s_waitcnt vmcnt(0) lgkmcnt(3)
  v_mfma_f32_32x32x16_bf16 v[40:55], a[16:19], v[136:139], v[40:55]
  s_waitcnt lgkmcnt(2)
  v_mfma_f32_32x32x16_bf16 v[56:71], a[20:23], v[136:139], v[56:71]
  s_waitcnt lgkmcnt(1)
  v_mfma_f32_32x32x16_bf16 v[72:87], a[24:27], v[136:139], v[72:87]
  s_waitcnt lgkmcnt(0)
  v_mfma_f32_32x32x16_bf16 v[88:103], a[28:31], v[136:139], v[88:103]
  s_barrier
  v_lshlrev_b32 v30, 4, v25
  v_add_u32 v30, 162560, v30
  ds_read_b128 v[136:139], v30 offset:128
  ds_read_b128 v[140:143], v30 offset:160
  ds_read_b128 v[144:147], v30 offset:192
  ds_read_b128 v[148:151], v30 offset:224
  ds_read_b128 v[152:155], v30 offset:256
  ds_read_b128 v[156:159], v30 offset:288
  ds_read_b128 v[160:163], v30 offset:320
  ds_read_b128 v[164:167], v30 offset:352
  ds_read_b128 v[168:171], v30 offset:384
  ds_read_b128 v[172:175], v30 offset:416
  ds_read_b128 v[176:179], v30 offset:448
  ds_read_b128 v[120:123], v30 offset:0
  ds_read_b128 v[124:127], v30 offset:32
  ds_read_b128 v[128:131], v30 offset:64
  ds_read_b128 v[132:135], v30 offset:96
  s_waitcnt lgkmcnt(11)
  v_pk_fma_f32 v[56:57], v[136:137], v[38:39], v[56:57] op_sel_hi:[1,0,1]
  v_pk_fma_f32 v[58:59], v[138:139], v[38:39], v[58:59] op_sel_hi:[1,0,1]
  v_pk_fma_f32 v[60:61], v[140:141], v[38:39], v[60:61] op_sel_hi:[1,0,1]
  v_pk_fma_f32 v[62:63], v[142:143], v[38:39], v[62:63] op_sel_hi:[1,0,1]
  v_pk_fma_f32 v[64:65], v[144:145], v[38:39], v[64:65] op_sel_hi:[1,0,1]
  v_pk_fma_f32 v[66:67], v[146:147], v[38:39], v[66:67] op_sel_hi:[1,0,1]
  v_pk_fma_f32 v[68:69], v[148:149], v[38:39], v[68:69] op_sel_hi:[1,0,1]
  v_pk_fma_f32 v[70:71], v[150:151], v[38:39], v[70:71] op_sel_hi:[1,0,1]
  s_waitcnt lgkmcnt(7)
  v_pk_fma_f32 v[72:73], v[152:153], v[38:39], v[72:73] op_sel_hi:[1,0,1]
  v_pk_fma_f32 v[74:75], v[154:155], v[38:39], v[74:75] op_sel_hi:[1,0,1]
  v_pk_fma_f32 v[76:77], v[156:157], v[38:39], v[76:77] op_sel_hi:[1,0,1]
  v_pk_fma_f32 v[78:79], v[158:159], v[38:39], v[78:79] op_sel_hi:[1,0,1]
  v_pk_fma_f32 v[80:81], v[160:161], v[38:39], v[80:81] op_sel_hi:[1,0,1]
  v_pk_fma_f32 v[82:83], v[162:163], v[38:39], v[82:83] op_sel_hi:[1,0,1]
  v_pk_fma_f32 v[84:85], v[164:165], v[38:39], v[84:85] op_sel_hi:[1,0,1]
  v_pk_fma_f32 v[86:87], v[166:167], v[38:39], v[86:87] op_sel_hi:[1,0,1]
  s_waitcnt lgkmcnt(4)
  v_pk_fma_f32 v[88:89], v[168:169], v[38:39], v[88:89] op_sel_hi:[1,0,1]
  v_pk_fma_f32 v[90:91], v[170:171], v[38:39], v[90:91] op_sel_hi:[1,0,1]
  v_pk_fma_f32 v[92:93], v[172:173], v[38:39], v[92:93] op_sel_hi:[1,0,1]
  v_pk_fma_f32 v[94:95], v[174:175], v[38:39], v[94:95] op_sel_hi:[1,0,1]
  v_pk_fma_f32 v[96:97], v[176:177], v[38:39], v[96:97] op_sel_hi:[1,0,1]
  v_pk_fma_f32 v[98:99], v[178:179], v[38:39], v[98:99] op_sel_hi:[1,0,1]
  s_waitcnt lgkmcnt(0)
  v_pk_fma_f32 v[40:41], v[120:121], v[38:39], v[40:41] op_sel_hi:[1,0,1]
  v_pk_fma_f32 v[42:43], v[122:123], v[38:39], v[42:43] op_sel_hi:[1,0,1]
  v_pk_fma_f32 v[44:45], v[124:125], v[38:39], v[44:45] op_sel_hi:[1,0,1]
  v_pk_fma_f32 v[46:47], v[126:127], v[38:39], v[46:47] op_sel_hi:[1,0,1]
  v_pk_fma_f32 v[48:49], v[128:129], v[38:39], v[48:49] op_sel_hi:[1,0,1]
  v_pk_fma_f32 v[50:51], v[130:131], v[38:39], v[50:51] op_sel_hi:[1,0,1]
  v_pk_fma_f32 v[52:53], v[132:133], v[38:39], v[52:53] op_sel_hi:[1,0,1]
  v_pk_fma_f32 v[54:55], v[134:135], v[38:39], v[54:55] op_sel_hi:[1,0,1]
  v_max3_f32 v160, v60, v61, v62
  v_min3_f32 v161, v60, v61, v62
  v_max3_f32 v160, v160, v63, v64
  v_min3_f32 v161, v161, v63, v64
  v_max3_f32 v160, v160, v65, v66
  v_min3_f32 v161, v161, v65, v66
  v_max3_f32 v160, v160, v67, v68
  v_min3_f32 v161, v161, v67, v68
  v_max3_f32 v160, v160, v69, v70
  v_min3_f32 v161, v161, v69, v70
  v_max3_f32 v160, v160, v71, v72
  v_min3_f32 v161, v161, v71, v72
  v_max3_f32 v160, v160, v73, v74
  v_min3_f32 v161, v161, v73, v74
  v_max3_f32 v160, v160, v75, v76
  v_min3_f32 v161, v161, v75, v76
  v_max3_f32 v160, v160, v77, v78
  v_min3_f32 v161, v161, v77, v78
  v_max_f32 v160, v160, v79
  v_min_f32 v161, v161, v79
  v_mul_f32_e64 v160, -v37, v160
  v_mul_f32 v161, v37, v161
  v_fma_f32 v104, v60, v37, v160
  v_fma_f32 v60, v60, -v37, v161
  v_fma_f32 v105, v61, v37, v160
  v_fma_f32 v61, v61, -v37, v161
  v_fma_f32 v106, v62, v37, v160
  v_fma_f32 v62, v62, -v37, v161
  v_fma_f32 v107, v63, v37, v160
  v_fma_f32 v63, v63, -v37, v161
  v_fma_f32 v108, v64, v37, v160
  v_fma_f32 v64, v64, -v37, v161
  v_fma_f32 v109, v65, v37, v160
  v_fma_f32 v65, v65, -v37, v161
  v_fma_f32 v110, v66, v37, v160
  v_fma_f32 v66, v66, -v37, v161
  v_fma_f32 v111, v67, v37, v160
  v_fma_f32 v67, v67, -v37, v161
  v_fma_f32 v112, v68, v37, v160
  v_fma_f32 v68, v68, -v37, v161
  v_fma_f32 v113, v69, v37, v160
  v_fma_f32 v69, v69, -v37, v161
  v_fma_f32 v114, v70, v37, v160
  v_fma_f32 v70, v70, -v37, v161
  v_fma_f32 v115, v71, v37, v160
  v_fma_f32 v71, v71, -v37, v161
  v_fma_f32 v116, v72, v37, v160
  v_fma_f32 v72, v72, -v37, v161
  v_fma_f32 v117, v73, v37, v160
  v_fma_f32 v73, v73, -v37, v161
  v_fma_f32 v118, v74, v37, v160
  v_fma_f32 v74, v74, -v37, v161
  v_fma_f32 v119, v75, v37, v160
  v_fma_f32 v75, v75, -v37, v161
  v_fma_f32 v120, v76, v37, v160
  v_fma_f32 v76, v76, -v37, v161
  v_fma_f32 v121, v77, v37, v160
  v_fma_f32 v77, v77, -v37, v161
  v_fma_f32 v122, v78, v37, v160
  v_fma_f32 v78, v78, -v37, v161
  v_fma_f32 v123, v79, v37, v160
  v_fma_f32 v79, v79, -v37, v161
  v_exp_f32 v104, v104
  v_exp_f32 v60, v60
  v_exp_f32 v105, v105
  v_exp_f32 v61, v61
  v_exp_f32 v106, v106
  v_exp_f32 v62, v62
  v_exp_f32 v107, v107
  v_exp_f32 v63, v63
  v_exp_f32 v108, v108
  v_exp_f32 v64, v64
  v_exp_f32 v109, v109
  v_exp_f32 v65, v65
  v_exp_f32 v110, v110
  v_exp_f32 v66, v66
  v_exp_f32 v111, v111
  v_exp_f32 v67, v67
  v_exp_f32 v112, v112
  v_exp_f32 v68, v68
  v_exp_f32 v113, v113
  v_exp_f32 v69, v69
  v_exp_f32 v114, v114
  v_exp_f32 v70, v70
  v_exp_f32 v115, v115
  v_exp_f32 v71, v71
  v_exp_f32 v116, v116
  v_exp_f32 v72, v72
  v_exp_f32 v117, v117
  v_exp_f32 v73, v73
  v_exp_f32 v118, v118
  v_exp_f32 v74, v74
  v_exp_f32 v119, v119
  v_exp_f32 v75, v75
  v_exp_f32 v120, v120
  v_exp_f32 v76, v76
  v_exp_f32 v121, v121
  v_exp_f32 v77, v77
  v_exp_f32 v122, v122
  v_exp_f32 v78, v78
  v_exp_f32 v123, v123
  v_exp_f32 v79, v79
  v_pk_add_f32 v[162:163], v[104:105], v[106:107]
  v_pk_add_f32 v[164:165], v[60:61], v[62:63]
  v_pk_add_f32 v[162:163], v[162:163], v[108:109]
  v_pk_add_f32 v[164:165], v[164:165], v[64:65]
  v_pk_add_f32 v[162:163], v[162:163], v[110:111]
  v_pk_add_f32 v[164:165], v[164:165], v[66:67]
  v_pk_add_f32 v[162:163], v[162:163], v[112:113]
  v_pk_add_f32 v[164:165], v[164:165], v[68:69]
  v_pk_add_f32 v[162:163], v[162:163], v[114:115]
  v_pk_add_f32 v[164:165], v[164:165], v[70:71]
  v_pk_add_f32 v[162:163], v[162:163], v[116:117]
  v_pk_add_f32 v[164:165], v[164:165], v[72:73]
  v_pk_add_f32 v[162:163], v[162:163], v[118:119]
  v_pk_add_f32 v[164:165], v[164:165], v[74:75]
  v_pk_add_f32 v[162:163], v[162:163], v[120:121]
  v_pk_add_f32 v[164:165], v[164:165], v[76:77]
  v_pk_add_f32 v[162:163], v[162:163], v[122:123]
  v_pk_add_f32 v[164:165], v[164:165], v[78:79]
  v_add_f32 v162, v162, v163
  v_add_f32 v164, v164, v165
  v_rcp_f32 v162, v162
  v_rcp_f32 v164, v164
  s_nop 0
  v_pk_mul_f32 v[104:105], v[104:105], v[162:163] op_sel_hi:[1,0]
  v_pk_mul_f32 v[60:61], v[60:61], v[164:165] op_sel_hi:[1,0]
  v_pk_mul_f32 v[106:107], v[106:107], v[162:163] op_sel_hi:[1,0]
  v_pk_mul_f32 v[62:63], v[62:63], v[164:165] op_sel_hi:[1,0]
  v_pk_mul_f32 v[108:109], v[108:109], v[162:163] op_sel_hi:[1,0]
  v_pk_mul_f32 v[64:65], v[64:65], v[164:165] op_sel_hi:[1,0]
  v_pk_mul_f32 v[110:111], v[110:111], v[162:163] op_sel_hi:[1,0]
  v_pk_mul_f32 v[66:67], v[66:67], v[164:165] op_sel_hi:[1,0]
  v_pk_mul_f32 v[112:113], v[112:113], v[162:163] op_sel_hi:[1,0]
  v_pk_mul_f32 v[68:69], v[68:69], v[164:165] op_sel_hi:[1,0]
  v_pk_mul_f32 v[114:115], v[114:115], v[162:163] op_sel_hi:[1,0]
  v_pk_mul_f32 v[70:71], v[70:71], v[164:165] op_sel_hi:[1,0]
  v_pk_mul_f32 v[116:117], v[116:117], v[162:163] op_sel_hi:[1,0]
  v_pk_mul_f32 v[72:73], v[72:73], v[164:165] op_sel_hi:[1,0]
  v_pk_mul_f32 v[118:119], v[118:119], v[162:163] op_sel_hi:[1,0]
  v_pk_mul_f32 v[74:75], v[74:75], v[164:165] op_sel_hi:[1,0]
  v_pk_mul_f32 v[120:121], v[120:121], v[162:163] op_sel_hi:[1,0]
  v_pk_mul_f32 v[76:77], v[76:77], v[164:165] op_sel_hi:[1,0]
  v_pk_mul_f32 v[122:123], v[122:123], v[162:163] op_sel_hi:[1,0]
  v_pk_mul_f32 v[78:79], v[78:79], v[164:165] op_sel_hi:[1,0]
  v_cvt_pk_bf16_f32 v124, v104, v105
  v_cvt_pk_bf16_f32 v125, v106, v107
  v_cvt_pk_bf16_f32 v126, v108, v109
  v_cvt_pk_bf16_f32 v127, v110, 0
  v_cvt_pk_bf16_f32 v128, v111, v112
  v_cvt_pk_bf16_f32 v129, v113, v114
  v_cvt_pk_bf16_f32 v130, v115, v116
  v_cvt_pk_bf16_f32 v131, v117, 0
  v_cvt_pk_bf16_f32 v132, v118, v119
  v_cvt_pk_bf16_f32 v133, v120, v121
  v_cvt_pk_bf16_f32 v134, v122, v123
  v_cvt_pk_bf16_f32 v135, v60, 0
  v_cvt_pk_bf16_f32 v136, v61, v62
  v_cvt_pk_bf16_f32 v137, v63, v64
  v_cvt_pk_bf16_f32 v138, v65, v66
  v_cvt_pk_bf16_f32 v139, v67, 0
  v_cvt_pk_bf16_f32 v140, v68, v69
  v_cvt_pk_bf16_f32 v141, v70, v71
  v_cvt_pk_bf16_f32 v142, v72, v73
  v_cvt_pk_bf16_f32 v143, v74, 0
  v_cvt_pk_bf16_f32 v144, v75, v76
  v_cvt_pk_bf16_f32 v145, v77, v78
  v_cvt_pk_bf16_f32 v146, v79, 0
  v_mov_b32 v147, 0
  v_pk_mul_f32 v[80:81], v[80:81], v[36:37] op_sel_hi:[1,0]
  v_pk_mul_f32 v[82:83], v[82:83], v[36:37] op_sel_hi:[1,0]
  v_pk_mul_f32 v[84:85], v[84:85], v[36:37] op_sel_hi:[1,0]
  v_pk_mul_f32 v[86:87], v[86:87], v[36:37] op_sel_hi:[1,0]
  v_pk_mul_f32 v[88:89], v[88:89], v[36:37] op_sel_hi:[1,0]
  v_pk_mul_f32 v[90:91], v[90:91], v[36:37] op_sel_hi:[1,0]
  v_pk_mul_f32 v[92:93], v[92:93], v[36:37] op_sel_hi:[1,0]
  v_pk_mul_f32 v[94:95], v[94:95], v[36:37] op_sel_hi:[1,0]
  v_pk_mul_f32 v[96:97], v[96:97], v[36:37] op_sel_hi:[1,0]
  v_pk_mul_f32 v[98:99], v[98:99], v[36:37] op_sel_hi:[1,0]
  v_cvt_pk_bf16_f32 v148, v80, v81
  v_cvt_pk_bf16_f32 v149, v82, v83
  v_cvt_pk_bf16_f32 v150, v84, v85
  v_cvt_pk_bf16_f32 v151, v86, v87
  v_cvt_pk_bf16_f32 v152, v88, v89
  v_cvt_pk_bf16_f32 v153, v90, v91
  v_cvt_pk_bf16_f32 v154, v92, v93
  v_cvt_pk_bf16_f32 v155, v94, v95
  v_cvt_pk_bf16_f32 v156, v96, v97
  v_cvt_pk_bf16_f32 v157, v98, v99
  v_mov_b32 v158, 0x3f80
  v_mov_b32 v159, 0
  s_lshl_b32 s46, s18, 5
  v_lshlrev_b32 v30, 7, v25
  v_add_u32 v30, v30, v24
  v_add_u32 v30, s46, v30
  v_mul_u32_u24 v30, 144, v30
  v_add_u32 v30, 114688, v30
  ds_write_b128 v30, v[124:127] offset:0
  ds_write_b128 v30, v[128:131] offset:16
  ds_write_b128 v30, v[132:135] offset:32
  ds_write_b128 v30, v[136:139] offset:48
  ds_write_b128 v30, v[140:143] offset:64
  ds_write_b128 v30, v[144:147] offset:80
  ds_write_b128 v30, v[148:151] offset:96
  ds_write_b128 v30, v[152:155] offset:112
  ds_write_b128 v30, v[156:159] offset:128
  s_waitcnt lgkmcnt(0)
  s_barrier
  s_lshr_b32 s46, s18, 1
  s_lshl_b32 s46, s46, 7
  v_lshlrev_b32 v30, 3, v4
  v_lshrrev_b32 v31, 2, v3
  v_add_u32 v30, v30, v31
  v_add_u32 v30, s46, v30
  v_mul_u32_u24 v30, 144, v30
  v_and_b32 v31, 3, v3
  v_lshlrev_b32 v31, 3, v31
  v_add_u32 v30, v30, v31
  v_add_u32 v30, 114688, v30
  s_and_b32 s47, s18, 1
  s_lshl_b32 s48, s47, 5
  v_add_u32 v31, s48, v30
  ds_read_b64_tr_b16 v[104:105], v31 offset:96
  ds_read_b64_tr_b16 v[106:107], v31 offset:672
  ds_read_b64_tr_b16 v[120:121], v30 offset:0
  ds_read_b64_tr_b16 v[122:123], v30 offset:576
  ds_read_b64_tr_b16 v[124:125], v30 offset:32
  ds_read_b64_tr_b16 v[126:127], v30 offset:608
  ds_read_b64_tr_b16 v[128:129], v30 offset:64
  ds_read_b64_tr_b16 v[130:131], v30 offset:640
  ds_read_b64_tr_b16 v[108:109], v31 offset:4704
  ds_read_b64_tr_b16 v[110:111], v31 offset:5280
  ds_read_b64_tr_b16 v[132:133], v30 offset:4608
  ds_read_b64_tr_b16 v[134:135], v30 offset:5184
  ds_read_b64_tr_b16 v[136:137], v30 offset:4640
  ds_read_b64_tr_b16 v[138:139], v30 offset:5216
  ds_read_b64_tr_b16 v[140:141], v30 offset:4672
  ds_read_b64_tr_b16 v[142:143], v30 offset:5248
  s_waitcnt lgkmcnt(8)
  v_mfma_f32_16x16x32_bf16 v[168:171], v[104:107], v[120:123], 0
  v_mfma_f32_16x16x32_bf16 v[172:175], v[104:107], v[124:127], 0
  v_mfma_f32_16x16x32_bf16 v[176:179], v[104:107], v[128:131], 0
  ds_read_b64_tr_b16 v[112:113], v31 offset:9312
  ds_read_b64_tr_b16 v[114:115], v31 offset:9888
  ds_read_b64_tr_b16 v[144:145], v30 offset:9216
  ds_read_b64_tr_b16 v[146:147], v30 offset:9792
  ds_read_b64_tr_b16 v[148:149], v30 offset:9248
  ds_read_b64_tr_b16 v[150:151], v30 offset:9824
  ds_read_b64_tr_b16 v[152:153], v30 offset:9280
  ds_read_b64_tr_b16 v[154:155], v30 offset:9856
  s_waitcnt lgkmcnt(8)
  v_mfma_f32_16x16x32_bf16 v[168:171], v[108:111], v[132:135], v[168:171]
  v_mfma_f32_16x16x32_bf16 v[172:175], v[108:111], v[136:139], v[172:175]
  v_mfma_f32_16x16x32_bf16 v[176:179], v[108:111], v[140:143], v[176:179]
  ds_read_b64_tr_b16 v[116:117], v31 offset:13920
  ds_read_b64_tr_b16 v[118:119], v31 offset:14496
  ds_read_b64_tr_b16 v[156:157], v30 offset:13824
  ds_read_b64_tr_b16 v[158:159], v30 offset:14400
  ds_read_b64_tr_b16 v[160:161], v30 offset:13856
  ds_read_b64_tr_b16 v[162:163], v30 offset:14432
  ds_read_b64_tr_b16 v[164:165], v30 offset:13888
  ds_read_b64_tr_b16 v[166:167], v30 offset:14464
  s_waitcnt lgkmcnt(8)
  v_mfma_f32_16x16x32_bf16 v[168:171], v[112:115], v[144:147], v[168:171]
  v_mfma_f32_16x16x32_bf16 v[172:175], v[112:115], v[148:151], v[172:175]
  v_mfma_f32_16x16x32_bf16 v[176:179], v[112:115], v[152:155], v[176:179]
  s_waitcnt lgkmcnt(0)
  v_mfma_f32_16x16x32_bf16 v[168:171], v[116:119], v[156:159], v[168:171]
  v_mfma_f32_16x16x32_bf16 v[172:175], v[116:119], v[160:163], v[172:175]
  v_mfma_f32_16x16x32_bf16 v[176:179], v[116:119], v[164:167], v[176:179]
  s_lshl_b32 s46, s41, 1
  s_lshr_b32 s48, s18, 1
  s_add_u32 s46, s46, s48
  s_mul_i32 s46, s46, 6144
  s_mul_i32 s48, s47, 3072
  s_add_u32 s46, s46, s48
  s_mul_i32 s48, s16, 196608
  s_add_u32 s46, s46, s48
  s_add_u32 s46, s46, 21102592
  v_mul_u32_u24 v30, 768, v4
  v_lshlrev_b32 v31, 2, v3
  v_add_u32 v30, v30, v31
  s_mov_b32 exec_lo, 0x80808080
  s_mov_b32 exec_hi, 0x80808080
  s_nop 3
  v_mov_b32 v168, 1.0
  v_mov_b32 v169, 1.0
  v_mov_b32 v170, 1.0
  v_mov_b32 v171, 1.0
  v_mov_b32 v172, 1.0
  v_mov_b32 v173, 1.0
  v_mov_b32 v174, 1.0
  v_mov_b32 v175, 1.0
  v_mov_b32 v176, 1.0
  v_mov_b32 v177, 1.0
  v_mov_b32 v178, 1.0
  v_mov_b32 v179, 1.0
  s_mov_b64 exec, -1
  s_cmp_eq_u32 s47, 1
  s_cbranch_scc1 g1_at1
  buffer_atomic_add_f32 v168, v30, s[20:23], s46 offen offset:0
  buffer_atomic_add_f32 v169, v30, s[20:23], s46 offen offset:192
  buffer_atomic_add_f32 v170, v30, s[20:23], s46 offen offset:384
  buffer_atomic_add_f32 v171, v30, s[20:23], s46 offen offset:576
  buffer_atomic_add_f32 v172, v30, s[20:23], s46 offen offset:64
  buffer_atomic_add_f32 v173, v30, s[20:23], s46 offen offset:256
  buffer_atomic_add_f32 v174, v30, s[20:23], s46 offen offset:448
  buffer_atomic_add_f32 v175, v30, s[20:23], s46 offen offset:640
  buffer_atomic_add_f32 v176, v30, s[20:23], s46 offen offset:128
  buffer_atomic_add_f32 v177, v30, s[20:23], s46 offen offset:320
  buffer_atomic_add_f32 v178, v30, s[20:23], s46 offen offset:512
  buffer_atomic_add_f32 v179, v30, s[20:23], s46 offen offset:704
  s_branch g1_atdone
g1_at1:
  s_mov_b32 exec_lo, 0xffffffff
  s_mov_b32 exec_hi, 0
  buffer_atomic_add_f32 v168, v30, s[20:23], s46 offen offset:0
  s_mov_b32 exec_lo, 0xffff
  s_mov_b32 exec_hi, 0
  buffer_atomic_add_f32 v169, v30, s[20:23], s46 offen offset:192
  s_mov_b32 exec_lo, 0xffff
  s_mov_b32 exec_hi, 0
  buffer_atomic_add_f32 v170, v30, s[20:23], s46 offen offset:384
  s_mov_b32 exec_lo, 0xffff
  s_mov_b32 exec_hi, 0
  buffer_atomic_add_f32 v171, v30, s[20:23], s46 offen offset:576
  s_mov_b32 exec_lo, 0xffffffff
  s_mov_b32 exec_hi, 0
  buffer_atomic_add_f32 v172, v30, s[20:23], s46 offen offset:64
  s_mov_b32 exec_lo, 0xffff
  s_mov_b32 exec_hi, 0
  buffer_atomic_add_f32 v173, v30, s[20:23], s46 offen offset:256
  s_mov_b32 exec_lo, 0xffff
  s_mov_b32 exec_hi, 0
  buffer_atomic_add_f32 v174, v30, s[20:23], s46 offen offset:448
  s_mov_b32 exec_lo, 0xffff
  s_mov_b32 exec_hi, 0
  buffer_atomic_add_f32 v175, v30, s[20:23], s46 offen offset:640
  s_mov_b32 exec_lo, 0xffffffff
  s_mov_b32 exec_hi, 0
  buffer_atomic_add_f32 v176, v30, s[20:23], s46 offen offset:128
  s_mov_b32 exec_lo, 0xffff
  s_mov_b32 exec_hi, 0
  buffer_atomic_add_f32 v177, v30, s[20:23], s46 offen offset:320
  s_mov_b32 exec_lo, 0xffff
  s_mov_b32 exec_hi, 0
  buffer_atomic_add_f32 v178, v30, s[20:23], s46 offen offset:512
  s_mov_b32 exec_lo, 0xffff
  s_mov_b32 exec_hi, 0
  buffer_atomic_add_f32 v179, v30, s[20:23], s46 offen offset:704
g1_atdone:
  s_mov_b64 exec, -1
  s_barrier
  v_max3_f32 v160, v40, v41, v42
  v_min3_f32 v161, v40, v41, v42
  v_max3_f32 v160, v160, v43, v44
  v_min3_f32 v161, v161, v43, v44
  v_max3_f32 v160, v160, v45, v46
  v_min3_f32 v161, v161, v45, v46
  v_max3_f32 v160, v160, v47, v48
  v_min3_f32 v161, v161, v47, v48
  v_max3_f32 v160, v160, v49, v50
  v_min3_f32 v161, v161, v49, v50
  v_max3_f32 v160, v160, v51, v52
  v_min3_f32 v161, v161, v51, v52
  v_max3_f32 v160, v160, v53, v54
  v_min3_f32 v161, v161, v53, v54
  v_max3_f32 v160, v160, v55, v56
  v_min3_f32 v161, v161, v55, v56
  v_max3_f32 v160, v160, v57, v58
  v_min3_f32 v161, v161, v57, v58
  v_max_f32 v160, v160, v59
  v_min_f32 v161, v161, v59
  v_mul_f32_e64 v160, -v37, v160
  v_mul_f32 v161, v37, v161
  v_fma_f32 v104, v40, v37, v160
  v_fma_f32 v40, v40, -v37, v161
  v_fma_f32 v105, v41, v37, v160
  v_fma_f32 v41, v41, -v37, v161
  v_fma_f32 v106, v42, v37, v160
  v_fma_f32 v42, v42, -v37, v161
  v_fma_f32 v107, v43, v37, v160
  v_fma_f32 v43, v43, -v37, v161
  v_fma_f32 v108, v44, v37, v160
  v_fma_f32 v44, v44, -v37, v161
  v_fma_f32 v109, v45, v37, v160
  v_fma_f32 v45, v45, -v37, v161
  v_fma_f32 v110, v46, v37, v160
  v_fma_f32 v46, v46, -v37, v161
  v_fma_f32 v111, v47, v37, v160
  v_fma_f32 v47, v47, -v37, v161
  v_fma_f32 v112, v48, v37, v160
  v_fma_f32 v48, v48, -v37, v161
  v_fma_f32 v113, v49, v37, v160
  v_fma_f32 v49, v49, -v37, v161
  v_fma_f32 v114, v50, v37, v160
  v_fma_f32 v50, v50, -v37, v161
  v_fma_f32 v115, v51, v37, v160
  v_fma_f32 v51, v51, -v37, v161
  v_fma_f32 v116, v52, v37, v160
  v_fma_f32 v52, v52, -v37, v161
  v_fma_f32 v117, v53, v37, v160
  v_fma_f32 v53, v53, -v37, v161
  v_fma_f32 v118, v54, v37, v160
  v_fma_f32 v54, v54, -v37, v161
  v_fma_f32 v119, v55, v37, v160
  v_fma_f32 v55, v55, -v37, v161
  v_fma_f32 v120, v56, v37, v160
  v_fma_f32 v56, v56, -v37, v161
  v_fma_f32 v121, v57, v37, v160
  v_fma_f32 v57, v57, -v37, v161
  v_fma_f32 v122, v58, v37, v160
  v_fma_f32 v58, v58, -v37, v161
  v_fma_f32 v123, v59, v37, v160
  v_fma_f32 v59, v59, -v37, v161
  v_exp_f32 v104, v104
  v_exp_f32 v40, v40
  v_exp_f32 v105, v105
  v_exp_f32 v41, v41
  v_exp_f32 v106, v106
  v_exp_f32 v42, v42
  v_exp_f32 v107, v107
  v_exp_f32 v43, v43
  v_exp_f32 v108, v108
  v_exp_f32 v44, v44
  v_exp_f32 v109, v109
  v_exp_f32 v45, v45
  v_exp_f32 v110, v110
  v_exp_f32 v46, v46
  v_exp_f32 v111, v111
  v_exp_f32 v47, v47
  v_exp_f32 v112, v112
  v_exp_f32 v48, v48
  v_exp_f32 v113, v113
  v_exp_f32 v49, v49
  v_exp_f32 v114, v114
  v_exp_f32 v50, v50
  v_exp_f32 v115, v115
  v_exp_f32 v51, v51
  v_exp_f32 v116, v116
  v_exp_f32 v52, v52
  v_exp_f32 v117, v117
  v_exp_f32 v53, v53
  v_exp_f32 v118, v118
  v_exp_f32 v54, v54
  v_exp_f32 v119, v119
  v_exp_f32 v55, v55
  v_exp_f32 v120, v120
  v_exp_f32 v56, v56
  v_exp_f32 v121, v121
  v_exp_f32 v57, v57
  v_exp_f32 v122, v122
  v_exp_f32 v58, v58
  v_exp_f32 v123, v123
  v_exp_f32 v59, v59
  v_pk_add_f32 v[162:163], v[104:105], v[106:107]
  v_pk_add_f32 v[164:165], v[40:41], v[42:43]
  v_pk_add_f32 v[162:163], v[162:163], v[108:109]
  v_pk_add_f32 v[164:165], v[164:165], v[44:45]
  v_pk_add_f32 v[162:163], v[162:163], v[110:111]
  v_pk_add_f32 v[164:165], v[164:165], v[46:47]
  v_pk_add_f32 v[162:163], v[162:163], v[112:113]
  v_pk_add_f32 v[164:165], v[164:165], v[48:49]
  v_pk_add_f32 v[162:163], v[162:163], v[114:115]
  v_pk_add_f32 v[164:165], v[164:165], v[50:51]
  v_pk_add_f32 v[162:163], v[162:163], v[116:117]
  v_pk_add_f32 v[164:165], v[164:165], v[52:53]
  v_pk_add_f32 v[162:163], v[162:163], v[118:119]
  v_pk_add_f32 v[164:165], v[164:165], v[54:55]
  v_pk_add_f32 v[162:163], v[162:163], v[120:121]
  v_pk_add_f32 v[164:165], v[164:165], v[56:57]
  v_pk_add_f32 v[162:163], v[162:163], v[122:123]
  v_pk_add_f32 v[164:165], v[164:165], v[58:59]
  v_add_f32 v162, v162, v163
  v_add_f32 v164, v164, v165
  v_rcp_f32 v162, v162
  v_rcp_f32 v164, v164
  s_nop 0
  v_pk_mul_f32 v[104:105], v[104:105], v[162:163] op_sel_hi:[1,0]
  v_pk_mul_f32 v[40:41], v[40:41], v[164:165] op_sel_hi:[1,0]
  v_pk_mul_f32 v[106:107], v[106:107], v[162:163] op_sel_hi:[1,0]
  v_pk_mul_f32 v[42:43], v[42:43], v[164:165] op_sel_hi:[1,0]
  v_pk_mul_f32 v[108:109], v[108:109], v[162:163] op_sel_hi:[1,0]
  v_pk_mul_f32 v[44:45], v[44:45], v[164:165] op_sel_hi:[1,0]
  v_pk_mul_f32 v[110:111], v[110:111], v[162:163] op_sel_hi:[1,0]
  v_pk_mul_f32 v[46:47], v[46:47], v[164:165] op_sel_hi:[1,0]
  v_pk_mul_f32 v[112:113], v[112:113], v[162:163] op_sel_hi:[1,0]
  v_pk_mul_f32 v[48:49], v[48:49], v[164:165] op_sel_hi:[1,0]
  v_pk_mul_f32 v[114:115], v[114:115], v[162:163] op_sel_hi:[1,0]
  v_pk_mul_f32 v[50:51], v[50:51], v[164:165] op_sel_hi:[1,0]
  v_pk_mul_f32 v[116:117], v[116:117], v[162:163] op_sel_hi:[1,0]
  v_pk_mul_f32 v[52:53], v[52:53], v[164:165] op_sel_hi:[1,0]
  v_pk_mul_f32 v[118:119], v[118:119], v[162:163] op_sel_hi:[1,0]
  v_pk_mul_f32 v[54:55], v[54:55], v[164:165] op_sel_hi:[1,0]
  v_pk_mul_f32 v[120:121], v[120:121], v[162:163] op_sel_hi:[1,0]
  v_pk_mul_f32 v[56:57], v[56:57], v[164:165] op_sel_hi:[1,0]
  v_pk_mul_f32 v[122:123], v[122:123], v[162:163] op_sel_hi:[1,0]
  v_pk_mul_f32 v[58:59], v[58:59], v[164:165] op_sel_hi:[1,0]
  v_cvt_pk_bf16_f32 v124, v104, v105
  v_cvt_pk_bf16_f32 v125, v106, v107
  v_cvt_pk_bf16_f32 v126, v108, v109
  v_cvt_pk_bf16_f32 v127, v110, 0
  v_cvt_pk_bf16_f32 v128, v111, v112
  v_cvt_pk_bf16_f32 v129, v113, v114
  v_cvt_pk_bf16_f32 v130, v115, v116
  v_cvt_pk_bf16_f32 v131, v117, 0
  v_cvt_pk_bf16_f32 v132, v118, v119
  v_cvt_pk_bf16_f32 v133, v120, v121
  v_cvt_pk_bf16_f32 v134, v122, v123
  v_cvt_pk_bf16_f32 v135, v40, 0
  v_cvt_pk_bf16_f32 v136, v41, v42
  v_cvt_pk_bf16_f32 v137, v43, v44
  v_cvt_pk_bf16_f32 v138, v45, v46
  v_cvt_pk_bf16_f32 v139, v47, 0
  v_cvt_pk_bf16_f32 v140, v48, v49
  v_cvt_pk_bf16_f32 v141, v50, v51
  v_cvt_pk_bf16_f32 v142, v52, v53
  v_cvt_pk_bf16_f32 v143, v54, 0
  v_cvt_pk_bf16_f32 v144, v55, v56
  v_cvt_pk_bf16_f32 v145, v57, v58
  v_cvt_pk_bf16_f32 v146, v59, 0
  v_mov_b32 v147, 0
  s_cmp_lg_u32 s16, 0
  s_cbranch_scc1 g1_nocs1
  s_mul_i32 s46, s18, 112
  v_lshlrev_b32 v31, 2, v24
  v_add_u32 v31, s46, v31
  v_mul_u32_u24 v32, 6912, v25
  v_add_u32 v32, v32, v31
  s_mul_i32 s46, s41, 448
  s_add_u32 s46, s46, 0x1540000
  buffer_load_dword v40, v32, s[20:23], s46 offen
  s_add_u32 s46, s46, 13824
  buffer_load_dword v41, v32, s[20:23], s46 offen
  s_add_u32 s46, s46, 13824
  buffer_load_dword v42, v32, s[20:23], s46 offen
  s_add_u32 s46, s46, 13824
  buffer_load_dword v43, v32, s[20:23], s46 offen
  s_add_u32 s46, s46, 13824
  buffer_load_dword v44, v32, s[20:23], s46 offen
  s_add_u32 s46, s46, 13824
  buffer_load_dword v45, v32, s[20:23], s46 offen
  s_add_u32 s46, s46, 13824
  buffer_load_dword v46, v32, s[20:23], s46 offen
  s_add_u32 s46, s46, 13824
  buffer_load_dword v47, v32, s[20:23], s46 offen
  s_add_u32 s46, s46, 13824
  buffer_load_dword v48, v32, s[20:23], s46 offen
  s_add_u32 s46, s46, 13824
  buffer_load_dword v49, v32, s[20:23], s46 offen
  v_add_u32 v31, 163072, v31
  s_waitcnt vmcnt(0)
  v_add_f32 v40, v40, v41
  v_add_f32 v40, v40, v42
  v_add_f32 v40, v40, v43
  v_add_f32 v40, v40, v44
  v_add_f32 v40, v40, v45
  v_add_f32 v40, v40, v46
  v_add_f32 v40, v40, v47
  v_add_f32 v40, v40, v48
  v_add_f32 v40, v40, v49
  v_mov_b32 v50, v40
  s_nop 1
  v_permlane32_swap_b32 v50, v40
  s_nop 1
  v_add_f32 v40, v40, v50
  s_mov_b32 exec_hi, 0
  s_mov_b32 exec_lo, 0xfffffff
  ds_write_b32 v31, v40
  s_mov_b64 exec, -1
  s_waitcnt lgkmcnt(0)
g1_nocs1:
  v_bfe_u32 v30, v24, 2, 1
  v_and_b32 v31, 3, v24
  v_lshrrev_b32 v32, 3, v24
  v_lshlrev_b32 v32, 2, v32
  v_add_u32 v31, v31, v32
  v_mul_u32_u24 v32, 21, v30
  v_add_u32 v32, v32, v31
  v_mul_u32_u24 v32, 96, v32
  v_add_u32 v32, 151616, v32
  v_add_u32 v33, 1536, v32
  v_mov_b32 v38, 155648
  v_cmp_eq_u32 vcc, v30, v25
  v_cmp_ge_u32 s[48:49], 4, v31
  s_nop 1
  v_cndmask_b32 v32, v38, v32, vcc
  s_and_b64 vcc, vcc, s[48:49]
  s_nop 1
  v_cndmask_b32 v33, v38, v33, vcc
  s_barrier
  ds_read_b128 a[0:3], v32 offset:0
  ds_read_b128 a[4:7], v32 offset:16
  ds_read_b128 a[8:11], v32 offset:32
  ds_read_b128 a[12:15], v32 offset:48
  ds_read_b128 a[16:19], v32 offset:64
  ds_read_b128 a[20:23], v32 offset:80
  ds_read_b128 a[24:27], v33 offset:0
  ds_read_b128 a[28:31], v33 offset:16
  ds_read_b128 a[32:35], v33 offset:32
  ds_read_b128 a[36:39], v33 offset:48
  ds_read_b128 a[40:43], v33 offset:64
  ds_read_b128 a[44:47], v33 offset:80
  s_waitcnt lgkmcnt(11)
  v_mfma_f32_32x32x16_bf16 v[60:75], a[0:3], v[124:127], 0
  s_waitcnt lgkmcnt(10)
  v_mfma_f32_32x32x16_bf16 v[60:75], a[4:7], v[128:131], v[60:75]
  s_waitcnt lgkmcnt(9)
  v_mfma_f32_32x32x16_bf16 v[60:75], a[8:11], v[132:135], v[60:75]
  s_waitcnt lgkmcnt(8)
  v_mfma_f32_32x32x16_bf16 v[60:75], a[12:15], v[136:139], v[60:75]
  s_waitcnt lgkmcnt(7)
  v_mfma_f32_32x32x16_bf16 v[60:75], a[16:19], v[140:143], v[60:75]
  s_waitcnt lgkmcnt(6)
  v_mfma_f32_32x32x16_bf16 v[60:75], a[20:23], v[144:147], v[60:75]
  s_waitcnt lgkmcnt(5)
  v_mfma_f32_32x32x16_bf16 v[76:91], a[24:27], v[124:127], 0
  s_waitcnt lgkmcnt(4)
  v_mfma_f32_32x32x16_bf16 v[76:91], a[28:31], v[128:131], v[76:91]
  s_waitcnt lgkmcnt(3)
  v_mfma_f32_32x32x16_bf16 v[76:91], a[32:35], v[132:135], v[76:91]
  s_waitcnt lgkmcnt(2)
  v_mfma_f32_32x32x16_bf16 v[76:91], a[36:39], v[136:139], v[76:91]
  s_waitcnt lgkmcnt(1)
  v_mfma_f32_32x32x16_bf16 v[76:91], a[40:43], v[140:143], v[76:91]
  s_waitcnt lgkmcnt(0)
  v_mfma_f32_32x32x16_bf16 v[76:91], a[44:47], v[144:147], v[76:91]
  s_nop 11
  v_add_f32 v30, 0x358637bd, v80
  v_rcp_f32 v32, v30
  s_nop 0
  v_pk_mul_f32 v[60:61], v[60:61], v[32:33] op_sel_hi:[1,0]
  v_pk_mul_f32 v[62:63], v[62:63], v[32:33] op_sel_hi:[1,0]
  v_pk_mul_f32 v[64:65], v[64:65], v[32:33] op_sel_hi:[1,0]
  v_pk_mul_f32 v[66:67], v[66:67], v[32:33] op_sel_hi:[1,0]
  v_pk_mul_f32 v[68:69], v[68:69], v[32:33] op_sel_hi:[1,0]
  v_pk_mul_f32 v[70:71], v[70:71], v[32:33] op_sel_hi:[1,0]
  v_pk_mul_f32 v[72:73], v[72:73], v[32:33] op_sel_hi:[1,0]
  v_pk_mul_f32 v[74:75], v[74:75], v[32:33] op_sel_hi:[1,0]
  v_pk_mul_f32 v[76:77], v[76:77], v[32:33] op_sel_hi:[1,0]
  v_pk_mul_f32 v[78:79], v[78:79], v[32:33] op_sel_hi:[1,0]
  v_cvt_pk_bf16_f32 v144, v60, v61
  v_cvt_pk_bf16_f32 v145, v62, v63
  v_cvt_pk_bf16_f32 v146, v64, v65
  v_cvt_pk_bf16_f32 v147, v66, v67
  v_cvt_pk_bf16_f32 v148, v68, v69
  v_cvt_pk_bf16_f32 v149, v70, v71
  v_cvt_pk_bf16_f32 v150, v72, v73
  v_cvt_pk_bf16_f32 v151, v74, v75
  v_cvt_pk_bf16_f32 v152, v76, v77
  v_cvt_pk_bf16_f32 v153, v78, v79
  v_bfe_u32 v30, v1, 4, 1
  v_mul_u32_u24 v30, 20480, v30
  v_lshlrev_b32 v31, 4, v3
  v_add_u32 v30, v30, v31
  v_lshlrev_b32 v31, 9, v25
  v_add_u32 v31, v31, v30
  v_lshlrev_b32 v32, 3, v25
  v_add_u32 v32, v32, v30
  s_lshl_b32 s46, s40, 3
  s_lshl_b32 s47, s18, 1
  s_add_u32 s46, s46, s47
  s_mul_i32 s46, s46, 20480
  s_mul_i32 s47, s41, 1280
  s_add_u32 s46, s46, s47
  s_mul_i32 s47, s16, 0
  s_add_u32 s46, s46, s47
  s_add_u32 s46, s46, 11010048
  buffer_store_dwordx4 v[144:147], v31, s[20:23], s46 offen
  buffer_store_dwordx4 v[148:151], v31, s[20:23], s46 offen offset:256
  buffer_store_dwordx2 v[152:153], v32, s[20:23], s46 offen offset:1024
  s_lshl_b32 s47, s16, 2
  s_add_u32 s47, s47, 1
  s_waitcnt vmcnt(0)
  v_mov_b32 v30, s47
  s_mov_b64 exec, 1
  s_cmp_lg_u32 s17, 0
  s_cbranch_scc1 g1_pub_fast
  buffer_wbl2 sc1
  s_waitcnt vmcnt(0)
  buffer_store_dword v30, v21, s[20:23], s61 offen sc0 sc1
  s_branch g1_pub_done
g1_pub_fast:
  buffer_store_dword v30, v21, s[20:23], s61 offen
g1_pub_done:
  s_mov_b64 exec, -1
  s_barrier
  s_mul_i32 s44, s16, 0
  s_add_u32 s44, s44, 11010048
  s_lshl_b32 s46, s40, 3
  s_lshr_b32 s47, s41, 3
  s_lshl_b32 s47, s47, 2
  s_add_u32 s46, s46, s47
  s_xor_b32 s47, s18, 0
  s_add_u32 s47, s47, s46
  s_mul_i32 s47, s47, 20480
  s_add_u32 s54, s44, s47
  s_xor_b32 s47, s18, 1
  s_add_u32 s47, s47, s46
  s_mul_i32 s47, s47, 20480
  s_add_u32 s55, s44, s47
  s_lshl_b32 s57, s16, 2
  s_add_u32 s57, s57, 1
  s_cmp_eq_u32 s57, 0
  s_cbranch_scc1 c_g2_ok2
  s_cmp_lg_u32 s18, 0
  s_cbranch_scc1 c_g2_ok2
  s_mov_b32 s58, 0
  v_mov_b32 v32, 0
c_g2_poll:
  buffer_load_dword v32, v0, s[20:23], s56 offen sc1
  s_waitcnt vmcnt(8)
  v_cmp_le_u32 vcc, s57, v32
  s_add_u32 s58, s58, 1
  s_cmp_eq_u64 vcc, -1
  s_cbranch_scc1 c_g2_ok
  s_cmp_lg_u32 s19, 0
  s_cbranch_scc1 c_g2_ok
  s_cmp_lt_u32 s58, 1048576
  s_cbranch_scc1 c_g2_poll
  s_mov_b32 s19, 1
c_g2_ok:
  s_cmp_lg_u32 s17, 0
  s_cbranch_scc1 c_g2_ok2
  s_waitcnt vmcnt(0)
  buffer_inv sc1
  s_waitcnt vmcnt(0)
c_g2_ok2:
  s_barrier
  buffer_load_dwordx4 v[80:83], v9, s[20:23], s54 offen offset:0 sc1
  buffer_load_dwordx4 v[84:87], v9, s[20:23], s55 offen offset:0 sc1
  buffer_load_dwordx4 v[88:91], v9, s[20:23], s54 offen offset:2048 sc1
  buffer_load_dwordx4 v[92:95], v9, s[20:23], s55 offen offset:2048 sc1
  s_add_u32 s54, s54, 4096
  s_add_u32 s55, s55, 4096
  buffer_load_dwordx4 v[96:99], v9, s[20:23], s54 offen offset:0 sc1
  buffer_load_dwordx4 v[100:103], v9, s[20:23], s55 offen offset:0 sc1
  buffer_load_dwordx4 v[104:107], v9, s[20:23], s54 offen offset:2048 sc1
  buffer_load_dwordx4 v[108:111], v9, s[20:23], s55 offen offset:2048 sc1
  ds_read_b128 a[0:3], v34 offset:49152
  ds_read_b128 a[4:7], v34 offset:50176
  ds_read_b128 a[8:11], v34 offset:51200
  ds_read_b128 a[12:15], v34 offset:52224
  ds_read_b128 a[16:19], v34 offset:53248
  s_waitcnt vmcnt(7) lgkmcnt(4)
  v_mfma_f32_16x16x32_bf16 v[40:43], a[0:3], v[80:83], 0
  s_barrier
  ds_read_b128 a[20:23], v34 offset:59392
  s_waitcnt vmcnt(6)
  v_mfma_f32_16x16x32_bf16 v[44:47], a[0:3], v[84:87], 0
  ds_read_b128 a[24:27], v34 offset:60416
  s_waitcnt lgkmcnt(5)
  v_mfma_f32_16x16x32_bf16 v[48:51], a[4:7], v[80:83], 0
  ds_read_b128 a[28:31], v34 offset:61440
  v_mfma_f32_16x16x32_bf16 v[52:55], a[4:7], v[84:87], 0
  ds_read_b128 a[32:35], v34 offset:62464
  s_waitcnt lgkmcnt(6)
  v_mfma_f32_16x16x32_bf16 v[56:59], a[8:11], v[80:83], 0
  ds_read_b128 a[36:39], v34 offset:63488
  v_mfma_f32_16x16x32_bf16 v[60:63], a[8:11], v[84:87], 0
  s_waitcnt lgkmcnt(6)
  v_mfma_f32_16x16x32_bf16 v[64:67], a[12:15], v[80:83], 0
  s_add_u32 s54, s54, 4096
  s_add_u32 s55, s55, 4096
  buffer_load_dwordx4 v[112:115], v9, s[20:23], s54 offen offset:0 sc1
  v_mfma_f32_16x16x32_bf16 v[68:71], a[12:15], v[84:87], 0
  s_waitcnt lgkmcnt(5)
  v_mfma_f32_16x16x32_bf16 v[72:75], a[16:19], v[80:83], 0
  buffer_load_dwordx4 v[116:119], v9, s[20:23], s55 offen offset:0 sc1
  v_mfma_f32_16x16x32_bf16 v[76:79], a[16:19], v[84:87], 0
  s_waitcnt vmcnt(7) lgkmcnt(4)
  v_mfma_f32_16x16x32_bf16 v[40:43], a[20:23], v[88:91], v[40:43]
  s_barrier
  ds_read_b128 a[0:3], v35 offset:4096
  s_waitcnt vmcnt(6)
  v_mfma_f32_16x16x32_bf16 v[44:47], a[20:23], v[92:95], v[44:47]
  ds_read_b128 a[4:7], v35 offset:5120
  s_waitcnt lgkmcnt(5)
  v_mfma_f32_16x16x32_bf16 v[48:51], a[24:27], v[88:91], v[48:51]
  ds_read_b128 a[8:11], v35 offset:6144
  v_mfma_f32_16x16x32_bf16 v[52:55], a[24:27], v[92:95], v[52:55]
  ds_read_b128 a[12:15], v35 offset:7168
  s_waitcnt lgkmcnt(6)
  v_mfma_f32_16x16x32_bf16 v[56:59], a[28:31], v[88:91], v[56:59]
  ds_read_b128 a[16:19], v35 offset:8192
  v_mfma_f32_16x16x32_bf16 v[60:63], a[28:31], v[92:95], v[60:63]
  s_waitcnt lgkmcnt(6)
  v_mfma_f32_16x16x32_bf16 v[64:67], a[32:35], v[88:91], v[64:67]
  buffer_load_dwordx4 v[132:135], v9, s[20:23], s54 offen offset:2048 sc1
  v_mfma_f32_16x16x32_bf16 v[68:71], a[32:35], v[92:95], v[68:71]
  s_waitcnt lgkmcnt(5)
  v_mfma_f32_16x16x32_bf16 v[72:75], a[36:39], v[88:91], v[72:75]
  buffer_load_dwordx4 v[136:139], v9, s[20:23], s55 offen offset:2048 sc1
  v_mfma_f32_16x16x32_bf16 v[76:79], a[36:39], v[92:95], v[76:79]
  s_waitcnt vmcnt(7) lgkmcnt(4)
  v_mfma_f32_16x16x32_bf16 v[40:43], a[0:3], v[96:99], v[40:43]
  s_barrier
  ds_read_b128 a[20:23], v35 offset:14336
  s_waitcnt vmcnt(6)
  v_mfma_f32_16x16x32_bf16 v[44:47], a[0:3], v[100:103], v[44:47]
  ds_read_b128 a[24:27], v35 offset:15360
  s_waitcnt lgkmcnt(5)
  v_mfma_f32_16x16x32_bf16 v[48:51], a[4:7], v[96:99], v[48:51]
  ds_read_b128 a[28:31], v35 offset:16384
  v_mfma_f32_16x16x32_bf16 v[52:55], a[4:7], v[100:103], v[52:55]
  ds_read_b128 a[32:35], v35 offset:17408
  s_waitcnt lgkmcnt(6)
  v_mfma_f32_16x16x32_bf16 v[56:59], a[8:11], v[96:99], v[56:59]
  ds_read_b128 a[36:39], v35 offset:18432
  v_mfma_f32_16x16x32_bf16 v[60:63], a[8:11], v[100:103], v[60:63]
  s_waitcnt lgkmcnt(6)
  v_mfma_f32_16x16x32_bf16 v[64:67], a[12:15], v[96:99], v[64:67]
  s_add_u32 s54, s54, 4096
  s_add_u32 s55, s55, 4096
  buffer_load_dwordx4 v[140:143], v9, s[20:23], s54 offen offset:0 sc1
  v_mfma_f32_16x16x32_bf16 v[68:71], a[12:15], v[100:103], v[68:71]
  s_waitcnt lgkmcnt(5)
  v_mfma_f32_16x16x32_bf16 v[72:75], a[16:19], v[96:99], v[72:75]
  buffer_load_dwordx4 v[144:147], v9, s[20:23], s55 offen offset:0 sc1
  v_mfma_f32_16x16x32_bf16 v[76:79], a[16:19], v[100:103], v[76:79]
  s_waitcnt vmcnt(7) lgkmcnt(4)
  v_mfma_f32_16x16x32_bf16 v[40:43], a[20:23], v[104:107], v[40:43]
  s_barrier
  ds_read_b128 a[0:3], v35 offset:24576
  s_waitcnt vmcnt(6)
  v_mfma_f32_16x16x32_bf16 v[44:47], a[20:23], v[108:111], v[44:47]
  ds_read_b128 a[4:7], v35 offset:25600
  s_waitcnt lgkmcnt(5)
  v_mfma_f32_16x16x32_bf16 v[48:51], a[24:27], v[104:107], v[48:51]
  ds_read_b128 a[8:11], v35 offset:26624
  v_mfma_f32_16x16x32_bf16 v[52:55], a[24:27], v[108:111], v[52:55]
  ds_read_b128 a[12:15], v35 offset:27648
  s_waitcnt lgkmcnt(6)
  v_mfma_f32_16x16x32_bf16 v[56:59], a[28:31], v[104:107], v[56:59]
  ds_read_b128 a[16:19], v35 offset:28672
  v_mfma_f32_16x16x32_bf16 v[60:63], a[28:31], v[108:111], v[60:63]
  s_waitcnt lgkmcnt(6)
  v_mfma_f32_16x16x32_bf16 v[64:67], a[32:35], v[104:107], v[64:67]
  buffer_load_dwordx4 v[148:151], v9, s[20:23], s54 offen offset:2048 sc1
  v_mfma_f32_16x16x32_bf16 v[68:71], a[32:35], v[108:111], v[68:71]
  s_waitcnt lgkmcnt(5)
  v_mfma_f32_16x16x32_bf16 v[72:75], a[36:39], v[104:107], v[72:75]
  buffer_load_dwordx4 v[152:155], v9, s[20:23], s55 offen offset:2048 sc1
  v_mfma_f32_16x16x32_bf16 v[76:79], a[36:39], v[108:111], v[76:79]
  s_waitcnt vmcnt(7) lgkmcnt(4)
  v_mfma_f32_16x16x32_bf16 v[40:43], a[0:3], v[112:115], v[40:43]
  s_barrier
  ds_read_b128 a[20:23], v35 offset:34816
  s_waitcnt vmcnt(6)
  v_mfma_f32_16x16x32_bf16 v[44:47], a[0:3], v[116:119], v[44:47]
  ds_read_b128 a[24:27], v35 offset:35840
  s_waitcnt lgkmcnt(5)
  v_mfma_f32_16x16x32_bf16 v[48:51], a[4:7], v[112:115], v[48:51]
  ds_read_b128 a[28:31], v35 offset:36864
  v_mfma_f32_16x16x32_bf16 v[52:55], a[4:7], v[116:119], v[52:55]
  ds_read_b128 a[32:35], v35 offset:37888
  s_waitcnt lgkmcnt(6)
  v_mfma_f32_16x16x32_bf16 v[56:59], a[8:11], v[112:115], v[56:59]
  ds_read_b128 a[36:39], v35 offset:38912
  v_mfma_f32_16x16x32_bf16 v[60:63], a[8:11], v[116:119], v[60:63]
  s_waitcnt lgkmcnt(6)
  v_mfma_f32_16x16x32_bf16 v[64:67], a[12:15], v[112:115], v[64:67]
  s_add_u32 s54, s54, 4096
  s_add_u32 s55, s55, 4096
  buffer_load_dwordx4 v[156:159], v9, s[20:23], s54 offen offset:0 sc1
  v_mfma_f32_16x16x32_bf16 v[68:71], a[12:15], v[116:119], v[68:71]
  s_waitcnt lgkmcnt(5)
  v_mfma_f32_16x16x32_bf16 v[72:75], a[16:19], v[112:115], v[72:75]
  buffer_load_dwordx4 v[160:163], v9, s[20:23], s55 offen offset:0 sc1
  v_mfma_f32_16x16x32_bf16 v[76:79], a[16:19], v[116:119], v[76:79]
  s_waitcnt vmcnt(7) lgkmcnt(4)
  v_mfma_f32_16x16x32_bf16 v[40:43], a[20:23], v[132:135], v[40:43]
  s_barrier
  ds_read_b128 a[0:3], v2 offset:1024
  s_waitcnt vmcnt(6)
  v_mfma_f32_16x16x32_bf16 v[44:47], a[20:23], v[136:139], v[44:47]
  ds_read_b128 a[4:7], v2 offset:2048
  s_waitcnt lgkmcnt(5)
  v_mfma_f32_16x16x32_bf16 v[48:51], a[24:27], v[132:135], v[48:51]
  ds_read_b128 a[8:11], v2 offset:3072
  v_mfma_f32_16x16x32_bf16 v[52:55], a[24:27], v[136:139], v[52:55]
  ds_read_b128 a[12:15], v2 offset:4096
  s_waitcnt lgkmcnt(6)
  v_mfma_f32_16x16x32_bf16 v[56:59], a[28:31], v[132:135], v[56:59]
  ds_read_b128 a[16:19], v34 offset:0
  v_mfma_f32_16x16x32_bf16 v[60:63], a[28:31], v[136:139], v[60:63]
  s_waitcnt lgkmcnt(6)
  v_mfma_f32_16x16x32_bf16 v[64:67], a[32:35], v[132:135], v[64:67]
  buffer_load_dwordx4 v[164:167], v9, s[20:23], s54 offen offset:2048 sc1
  v_mfma_f32_16x16x32_bf16 v[68:71], a[32:35], v[136:139], v[68:71]
  s_waitcnt lgkmcnt(5)
  v_mfma_f32_16x16x32_bf16 v[72:75], a[36:39], v[132:135], v[72:75]
  buffer_load_dwordx4 v[168:171], v9, s[20:23], s55 offen offset:2048 sc1
  v_mfma_f32_16x16x32_bf16 v[76:79], a[36:39], v[136:139], v[76:79]
  s_waitcnt vmcnt(7) lgkmcnt(4)
  v_mfma_f32_16x16x32_bf16 v[40:43], a[0:3], v[140:143], v[40:43]
  s_barrier
  ds_read_b128 a[20:23], v34 offset:6144
  s_waitcnt vmcnt(6)
  v_mfma_f32_16x16x32_bf16 v[44:47], a[0:3], v[144:147], v[44:47]
  ds_read_b128 a[24:27], v34 offset:7168
  s_waitcnt lgkmcnt(5)
  v_mfma_f32_16x16x32_bf16 v[48:51], a[4:7], v[140:143], v[48:51]
  ds_read_b128 a[28:31], v34 offset:8192
  v_mfma_f32_16x16x32_bf16 v[52:55], a[4:7], v[144:147], v[52:55]
  ds_read_b128 a[32:35], v34 offset:9216
  s_waitcnt lgkmcnt(6)
  v_mfma_f32_16x16x32_bf16 v[56:59], a[8:11], v[140:143], v[56:59]
  ds_read_b128 a[36:39], v34 offset:10240
  v_mfma_f32_16x16x32_bf16 v[60:63], a[8:11], v[144:147], v[60:63]
  s_waitcnt lgkmcnt(6)
  v_mfma_f32_16x16x32_bf16 v[64:67], a[12:15], v[140:143], v[64:67]
  v_mfma_f32_16x16x32_bf16 v[68:71], a[12:15], v[144:147], v[68:71]
  s_waitcnt lgkmcnt(5)
  v_mfma_f32_16x16x32_bf16 v[72:75], a[16:19], v[140:143], v[72:75]
  v_mfma_f32_16x16x32_bf16 v[76:79], a[16:19], v[144:147], v[76:79]
  s_waitcnt vmcnt(5) lgkmcnt(4)
  v_mfma_f32_16x16x32_bf16 v[40:43], a[20:23], v[148:151], v[40:43]
  s_barrier
  ds_read_b128 a[0:3], v34 offset:16384
  s_waitcnt vmcnt(4)
  v_mfma_f32_16x16x32_bf16 v[44:47], a[20:23], v[152:155], v[44:47]
  ds_read_b128 a[4:7], v34 offset:17408
  s_waitcnt lgkmcnt(5)
  v_mfma_f32_16x16x32_bf16 v[48:51], a[24:27], v[148:151], v[48:51]
  ds_read_b128 a[8:11], v34 offset:18432
  v_mfma_f32_16x16x32_bf16 v[52:55], a[24:27], v[152:155], v[52:55]
  ds_read_b128 a[12:15], v34 offset:19456
  s_waitcnt lgkmcnt(6)
  v_mfma_f32_16x16x32_bf16 v[56:59], a[28:31], v[148:151], v[56:59]
  ds_read_b128 a[16:19], v34 offset:20480
  v_mfma_f32_16x16x32_bf16 v[60:63], a[28:31], v[152:155], v[60:63]
  s_waitcnt lgkmcnt(6)
  v_mfma_f32_16x16x32_bf16 v[64:67], a[32:35], v[148:151], v[64:67]
  v_mfma_f32_16x16x32_bf16 v[68:71], a[32:35], v[152:155], v[68:71]
  s_waitcnt lgkmcnt(5)
  v_mfma_f32_16x16x32_bf16 v[72:75], a[36:39], v[148:151], v[72:75]
  v_mfma_f32_16x16x32_bf16 v[76:79], a[36:39], v[152:155], v[76:79]
  s_waitcnt vmcnt(3) lgkmcnt(4)
  v_mfma_f32_16x16x32_bf16 v[40:43], a[0:3], v[156:159], v[40:43]
  s_barrier
  ds_read_b128 a[20:23], v34 offset:26624
  s_waitcnt vmcnt(2)
  v_mfma_f32_16x16x32_bf16 v[44:47], a[0:3], v[160:163], v[44:47]
  ds_read_b128 a[24:27], v34 offset:27648
  s_waitcnt lgkmcnt(5)
  v_mfma_f32_16x16x32_bf16 v[48:51], a[4:7], v[156:159], v[48:51]
  ds_read_b128 a[28:31], v34 offset:28672
  v_mfma_f32_16x16x32_bf16 v[52:55], a[4:7], v[160:163], v[52:55]
  ds_read_b128 a[32:35], v34 offset:29696
  s_waitcnt lgkmcnt(6)
  v_mfma_f32_16x16x32_bf16 v[56:59], a[8:11], v[156:159], v[56:59]
  ds_read_b128 a[36:39], v34 offset:30720
  v_mfma_f32_16x16x32_bf16 v[60:63], a[8:11], v[160:163], v[60:63]
  s_waitcnt lgkmcnt(6)
  v_mfma_f32_16x16x32_bf16 v[64:67], a[12:15], v[156:159], v[64:67]
  v_mfma_f32_16x16x32_bf16 v[68:71], a[12:15], v[160:163], v[68:71]
  s_waitcnt lgkmcnt(5)
  v_mfma_f32_16x16x32_bf16 v[72:75], a[16:19], v[156:159], v[72:75]
  v_mfma_f32_16x16x32_bf16 v[76:79], a[16:19], v[160:163], v[76:79]
  s_waitcnt vmcnt(1) lgkmcnt(4)
  v_mfma_f32_16x16x32_bf16 v[40:43], a[20:23], v[164:167], v[40:43]
  s_waitcnt vmcnt(0)
  v_mfma_f32_16x16x32_bf16 v[44:47], a[20:23], v[168:171], v[44:47]
  s_waitcnt lgkmcnt(3)
  v_mfma_f32_16x16x32_bf16 v[48:51], a[24:27], v[164:167], v[48:51]
  v_mfma_f32_16x16x32_bf16 v[52:55], a[24:27], v[168:171], v[52:55]
  s_waitcnt lgkmcnt(2)
  v_mfma_f32_16x16x32_bf16 v[56:59], a[28:31], v[164:167], v[56:59]
  v_mfma_f32_16x16x32_bf16 v[60:63], a[28:31], v[168:171], v[60:63]
  s_waitcnt lgkmcnt(1)
  v_mfma_f32_16x16x32_bf16 v[64:67], a[32:35], v[164:167], v[64:67]
  v_mfma_f32_16x16x32_bf16 v[68:71], a[32:35], v[168:171], v[68:71]
  s_waitcnt lgkmcnt(0)
  v_mfma_f32_16x16x32_bf16 v[72:75], a[36:39], v[164:167], v[72:75]
  v_mfma_f32_16x16x32_bf16 v[76:79], a[36:39], v[168:171], v[76:79]
  s_barrier
  s_nop 7
  ds_write_b128 v27, v[44:47] offset:0
  ds_write_b128 v27, v[52:55] offset:1024
  ds_write_b128 v27, v[60:63] offset:2048
  ds_write_b128 v27, v[68:71] offset:3072
  ds_write_b128 v27, v[76:79] offset:4096
  s_waitcnt lgkmcnt(0)
  s_barrier
  ds_read_b128 v[80:83], v28 offset:0
  ds_read_b128 v[84:87], v28 offset:1024
  ds_read_b128 v[88:91], v28 offset:2048
  ds_read_b128 v[92:95], v28 offset:3072
  ds_read_b128 v[96:99], v28 offset:4096
  s_waitcnt lgkmcnt(4)
  v_pk_add_f32 v[100:101], v[40:41], v[80:81]
  v_lshlrev_b32 v30, 16, v10
  v_and_b32 v31, 0xffff0000, v10
  v_pk_add_f32 v[100:101], v[100:101], v[30:31]
  v_pk_add_f32 v[102:103], v[42:43], v[82:83]
  v_lshlrev_b32 v30, 16, v11
  v_and_b32 v31, 0xffff0000, v11
  v_pk_add_f32 v[102:103], v[102:103], v[30:31]
  s_waitcnt lgkmcnt(3)
  v_pk_add_f32 v[104:105], v[48:49], v[84:85]
  v_lshlrev_b32 v30, 16, v12
  v_and_b32 v31, 0xffff0000, v12
  v_pk_add_f32 v[104:105], v[104:105], v[30:31]
  v_pk_add_f32 v[106:107], v[50:51], v[86:87]
  v_lshlrev_b32 v30, 16, v13
  v_and_b32 v31, 0xffff0000, v13
  v_pk_add_f32 v[106:107], v[106:107], v[30:31]
  s_waitcnt lgkmcnt(2)
  v_pk_add_f32 v[108:109], v[56:57], v[88:89]
  v_lshlrev_b32 v30, 16, v14
  v_and_b32 v31, 0xffff0000, v14
  v_pk_add_f32 v[108:109], v[108:109], v[30:31]
  v_pk_add_f32 v[110:111], v[58:59], v[90:91]
  v_lshlrev_b32 v30, 16, v15
  v_and_b32 v31, 0xffff0000, v15
  v_pk_add_f32 v[110:111], v[110:111], v[30:31]
  s_waitcnt lgkmcnt(1)
  v_pk_add_f32 v[112:113], v[64:65], v[92:93]
  v_lshlrev_b32 v30, 16, v16
  v_and_b32 v31, 0xffff0000, v16
  v_pk_add_f32 v[112:113], v[112:113], v[30:31]
  v_pk_add_f32 v[114:115], v[66:67], v[94:95]
  v_lshlrev_b32 v30, 16, v17
  v_and_b32 v31, 0xffff0000, v17
  v_pk_add_f32 v[114:115], v[114:115], v[30:31]
  s_waitcnt lgkmcnt(0)
  v_pk_add_f32 v[116:117], v[72:73], v[96:97]
  v_lshlrev_b32 v30, 16, v18
  v_and_b32 v31, 0xffff0000, v18
  v_pk_add_f32 v[116:117], v[116:117], v[30:31]
  v_pk_add_f32 v[118:119], v[74:75], v[98:99]
  v_lshlrev_b32 v30, 16, v19
  v_and_b32 v31, 0xffff0000, v19
  v_pk_add_f32 v[118:119], v[118:119], v[30:31]
  v_cvt_pk_bf16_f32 v10, v100, v101
  v_cvt_pk_bf16_f32 v11, v102, v103
  v_cvt_pk_bf16_f32 v12, v104, v105
  v_cvt_pk_bf16_f32 v13, v106, v107
  v_cvt_pk_bf16_f32 v14, v108, v109
  v_cvt_pk_bf16_f32 v15, v110, v111
  v_cvt_pk_bf16_f32 v16, v112, v113
  v_cvt_pk_bf16_f32 v17, v114, v115
  v_cvt_pk_bf16_f32 v18, v116, v117
  v_cvt_pk_bf16_f32 v19, v118, v119
  v_mov_b32 v80, v10
  v_mov_b32 v81, v11
  v_mov_b32 v82, v12
  v_mov_b32 v83, v13
  v_mov_b32 v84, v14
  v_mov_b32 v85, v15
  v_mov_b32 v86, v16
  v_mov_b32 v87, v17
  s_nop 1
  v_permlane16_swap_b32 v80, v82
  v_permlane16_swap_b32 v81, v83
  v_permlane16_swap_b32 v84, v86
  v_permlane16_swap_b32 v85, v87
  s_lshl_b32 s46, s40, 3
  s_lshr_b32 s47, s41, 3
  s_lshl_b32 s47, s47, 2
  s_add_u32 s46, s46, s47
  s_add_u32 s46, s46, s18
  s_and_b32 s47, s41, 7
  s_mul_i32 s48, s46, 20480
  s_mul_i32 s49, s47, 2560
  s_add_u32 s48, s48, s49
  s_mul_i32 s49, s16, 0
  s_add_u32 s48, s48, s49
  s_add_u32 s48, s48, 8388608
  s_nop 0
  buffer_store_dwordx4 v[80:83], v23, s[20:23], s48 offen offset:0
  buffer_store_dwordx4 v[84:87], v23, s[20:23], s48 offen offset:1024
  v_lshrrev_b32 v30, 1, v4
  v_lshlrev_b32 v30, 8, v30
  v_lshlrev_b32 v31, 4, v3
  v_add_u32 v30, v30, v31
  v_and_b32 v31, 1, v4
  v_lshlrev_b32 v31, 3, v31
  v_add_u32 v30, v30, v31
  buffer_store_dwordx2 v[18:19], v30, s[20:23], s48 offen offset:2048
  s_lshl_b32 s48, s46, 10
  s_lshl_b32 s49, s47, 3
  s_add_u32 s48, s48, s49
  s_mul_i32 s49, s16, 0
  s_add_u32 s48, s48, s49
  s_add_u32 s48, s48, 20971520
  v_lshlrev_b32 v100, 16, v10
  v_and_b32 v101, 0xffff0000, v10
  v_lshlrev_b32 v102, 16, v11
  v_and_b32 v103, 0xffff0000, v11
  v_lshlrev_b32 v104, 16, v12
  v_and_b32 v105, 0xffff0000, v12
  v_lshlrev_b32 v106, 16, v13
  v_and_b32 v107, 0xffff0000, v13
  v_lshlrev_b32 v108, 16, v14
  v_and_b32 v109, 0xffff0000, v14
  v_lshlrev_b32 v110, 16, v15
  v_and_b32 v111, 0xffff0000, v15
  v_lshlrev_b32 v112, 16, v16
  v_and_b32 v113, 0xffff0000, v16
  v_lshlrev_b32 v114, 16, v17
  v_and_b32 v115, 0xffff0000, v17
  v_lshlrev_b32 v116, 16, v18
  v_and_b32 v117, 0xffff0000, v18
  v_lshlrev_b32 v118, 16, v19
  v_and_b32 v119, 0xffff0000, v19
  v_pk_add_f32 v[132:133], v[100:101], v[102:103]
  v_pk_add_f32 v[134:135], v[104:105], v[106:107]
  v_pk_add_f32 v[132:133], v[132:133], v[108:109]
  v_pk_add_f32 v[134:135], v[134:135], v[110:111]
  v_pk_add_f32 v[132:133], v[132:133], v[112:113]
  v_pk_add_f32 v[134:135], v[134:135], v[114:115]
  v_pk_add_f32 v[132:133], v[132:133], v[116:117]
  v_pk_add_f32 v[134:135], v[134:135], v[118:119]
  v_pk_add_f32 v[132:133], v[132:133], v[134:135]
  v_add_f32 v130, v132, v133
  v_mov_b32 v131, v130
  s_nop 1
  v_permlane16_swap_b32 v131, v130
  s_nop 1
  v_add_f32 v130, v130, v131
  v_mov_b32 v131, v130
  s_nop 1
  v_permlane32_swap_b32 v131, v130
  s_nop 1
  v_add_f32 v130, v130, v131
  v_mul_f32 v130, 0x3c4ccccd, v130
  v_sub_f32 v100, v100, v130
  v_mul_f32 v132, v100, v100
  v_sub_f32 v101, v101, v130
  v_mul_f32 v133, v101, v101
  v_sub_f32 v102, v102, v130
  v_fmac_f32 v132, v102, v102
  v_sub_f32 v103, v103, v130
  v_fmac_f32 v133, v103, v103
  v_sub_f32 v104, v104, v130
  v_fmac_f32 v132, v104, v104
  v_sub_f32 v105, v105, v130
  v_fmac_f32 v133, v105, v105
  v_sub_f32 v106, v106, v130
  v_fmac_f32 v132, v106, v106
  v_sub_f32 v107, v107, v130
  v_fmac_f32 v133, v107, v107
  v_sub_f32 v108, v108, v130
  v_fmac_f32 v132, v108, v108
  v_sub_f32 v109, v109, v130
  v_fmac_f32 v133, v109, v109
  v_sub_f32 v110, v110, v130
  v_fmac_f32 v132, v110, v110
  v_sub_f32 v111, v111, v130
  v_fmac_f32 v133, v111, v111
  v_sub_f32 v112, v112, v130
  v_fmac_f32 v132, v112, v112
  v_sub_f32 v113, v113, v130
  v_fmac_f32 v133, v113, v113
  v_sub_f32 v114, v114, v130
  v_fmac_f32 v132, v114, v114
  v_sub_f32 v115, v115, v130
  v_fmac_f32 v133, v115, v115
  v_sub_f32 v116, v116, v130
  v_fmac_f32 v132, v116, v116
  v_sub_f32 v117, v117, v130
  v_fmac_f32 v133, v117, v117
  v_sub_f32 v118, v118, v130
  v_fmac_f32 v132, v118, v118
  v_sub_f32 v119, v119, v130
  v_fmac_f32 v133, v119, v119
  v_add_f32 v132, v132, v133
  v_mov_b32 v131, v132
  s_nop 1
  v_permlane16_swap_b32 v131, v132
  s_nop 1
  v_add_f32 v132, v132, v131
  v_mov_b32 v131, v132
  s_nop 1
  v_permlane32_swap_b32 v131, v132
  s_nop 1
  v_add_f32 v132, v132, v131
  v_mov_b32 v133, v132
  v_mov_b32 v132, v130
  buffer_store_dwordx2 v[132:133], v26, s[20:23], s48 offen
  s_lshl_b32 s47, s16, 2
  s_add_u32 s47, s47, 2
  s_waitcnt vmcnt(0)
  v_mov_b32 v30, s47
  s_mov_b64 exec, 1
  s_cmp_lg_u32 s17, 0
  s_cbranch_scc1 g2_pub_fast
  buffer_wbl2 sc1
  s_waitcnt vmcnt(0)
  buffer_store_dword v30, v21, s[20:23], s61 offen sc0 sc1
  s_branch g2_pub_done
g2_pub_fast:
  buffer_store_dword v30, v21, s[20:23], s61 offen
g2_pub_done:
  s_mov_b64 exec, -1
  s_barrier
  s_mul_i32 s46, s16, 0
  s_add_u32 s46, s46, 20971520
  s_lshl_b32 s47, s40, 13
  s_add_u32 s46, s46, s47
  s_lshl_b32 s47, s18, 11
  s_add_u32 s46, s46, s47
  v_lshlrev_b32 v30, 6, v3
  v_lshlrev_b32 v31, 4, v4
  v_add_u32 v30, v30, v31
  v_lshlrev_b32 v31, 3, v4
  s_mul_i32 s47, s41, 224
  s_mul_i32 s54, s16, 0
  s_add_u32 s54, s54, 8388608
  s_lshl_b32 s48, s40, 3
  s_lshl_b32 s49, s18, 1
  s_add_u32 s48, s48, s49
  s_mul_i32 s48, s48, 20480
  s_add_u32 s54, s54, s48
  s_add_u32 s55, s54, 20480
  s_lshl_b32 s57, s16, 2
  s_add_u32 s57, s57, 2
  s_cmp_eq_u32 s57, 0
  s_cbranch_scc1 c_g3_ok2
  s_cmp_lg_u32 s18, 0
  s_cbranch_scc1 c_g3_ok2
  s_mov_b32 s58, 0
  v_mov_b32 v32, 0
c_g3_poll:
  buffer_load_dword v32, v0, s[20:23], s56 offen sc1
  s_waitcnt vmcnt(8)
  v_cmp_le_u32 vcc, s57, v32
  s_add_u32 s58, s58, 1
  s_cmp_eq_u64 vcc, -1
  s_cbranch_scc1 c_g3_ok
  s_cmp_lg_u32 s19, 0
  s_cbranch_scc1 c_g3_ok
  s_cmp_lt_u32 s58, 1048576
  s_cbranch_scc1 c_g3_poll
  s_mov_b32 s19, 1
c_g3_ok:
  s_cmp_lg_u32 s17, 0
  s_cbranch_scc1 c_g3_ok2
  s_waitcnt vmcnt(0)
  buffer_inv sc1
  s_waitcnt vmcnt(0)
c_g3_ok2:
  s_barrier
  buffer_load_dwordx4 v[124:127], v5, s[20:23], s54 offen offset:0 sc1
  buffer_load_dwordx4 v[128:131], v5, s[20:23], s55 offen offset:0 sc1
  buffer_load_dwordx4 v[132:135], v5, s[20:23], s54 offen offset:1024 sc1
  buffer_load_dwordx4 v[136:139], v5, s[20:23], s55 offen offset:1024 sc1
  buffer_load_dwordx4 v[140:143], v5, s[20:23], s54 offen offset:2048 sc1
  buffer_load_dwordx4 v[144:147], v5, s[20:23], s55 offen offset:2048 sc1
  buffer_load_dwordx4 v[148:151], v5, s[20:23], s54 offen offset:3072 sc1
  buffer_load_dwordx4 v[152:155], v5, s[20:23], s55 offen offset:3072 sc1
  ds_read_b128 a[0:3], v5 offset:36864
  ds_read_b128 a[4:7], v5 offset:37888
  ds_read_b128 a[8:11], v5 offset:38912
  ds_read_b128 a[12:15], v5 offset:39936
  ds_read_b128 a[16:19], v5 offset:40960
  ds_read_b128 a[20:23], v5 offset:41984
  ds_read_b128 a[24:27], v5 offset:43008
  buffer_load_dwordx4 v[96:99], v30, s[20:23], s46 offen offset:0 sc1
  buffer_load_dwordx4 v[100:103], v30, s[20:23], s46 offen offset:1024 sc1
  buffer_load_dwordx2 v[104:105], v31, s[24:27], s47 offen offset:0
  buffer_load_dwordx2 v[106:107], v31, s[24:27], s47 offen offset:32
  buffer_load_dwordx2 v[108:109], v31, s[24:27], s47 offen offset:64
  buffer_load_dwordx2 v[110:111], v31, s[24:27], s47 offen offset:96
  buffer_load_dwordx2 v[112:113], v31, s[24:27], s47 offen offset:128
  buffer_load_dwordx2 v[114:115], v31, s[24:27], s47 offen offset:160
  buffer_load_dwordx2 v[116:117], v31, s[24:27], s47 offen offset:192
  s_waitcnt vmcnt(16) lgkmcnt(6)
  v_mfma_f32_16x16x32_bf16 v[40:43], a[0:3], v[124:127], 0
  s_barrier
  ds_read_b128 a[28:31], v5 offset:44032
  s_waitcnt vmcnt(15)
  v_mfma_f32_16x16x32_bf16 v[44:47], a[0:3], v[128:131], 0
  ds_read_b128 a[32:35], v5 offset:45056
  s_waitcnt lgkmcnt(7)
  v_mfma_f32_16x16x32_bf16 v[48:51], a[4:7], v[124:127], 0
  ds_read_b128 a[36:39], v5 offset:46080
  v_mfma_f32_16x16x32_bf16 v[52:55], a[4:7], v[128:131], 0
  ds_read_b128 a[40:43], v5 offset:47104
  s_waitcnt lgkmcnt(8)
  v_mfma_f32_16x16x32_bf16 v[56:59], a[8:11], v[124:127], 0
  ds_read_b128 a[44:47], v5 offset:48128
  v_mfma_f32_16x16x32_bf16 v[60:63], a[8:11], v[128:131], 0
  ds_read_b128 a[48:51], v5 offset:49152
  s_waitcnt lgkmcnt(9)
  v_mfma_f32_16x16x32_bf16 v[64:67], a[12:15], v[124:127], 0
  ds_read_b128 a[52:55], v5 offset:50176
  v_mfma_f32_16x16x32_bf16 v[68:71], a[12:15], v[128:131], 0
  s_waitcnt lgkmcnt(9)
  v_mfma_f32_16x16x32_bf16 v[72:75], a[16:19], v[124:127], 0
  v_mfma_f32_16x16x32_bf16 v[76:79], a[16:19], v[128:131], 0
  s_add_u32 s54, s54, 4096
  s_add_u32 s55, s55, 4096
  buffer_load_dwordx4 v[156:159], v5, s[20:23], s54 offen offset:0 sc1
  s_waitcnt lgkmcnt(8)
  v_mfma_f32_16x16x32_bf16 v[80:83], a[20:23], v[124:127], 0
  v_mfma_f32_16x16x32_bf16 v[84:87], a[20:23], v[128:131], 0
  buffer_load_dwordx4 v[160:163], v5, s[20:23], s55 offen offset:0 sc1
  s_waitcnt lgkmcnt(7)
  v_mfma_f32_16x16x32_bf16 v[88:91], a[24:27], v[124:127], 0
  v_mfma_f32_16x16x32_bf16 v[92:95], a[24:27], v[128:131], 0
  s_waitcnt vmcnt(16) lgkmcnt(6)
  v_mfma_f32_16x16x32_bf16 v[40:43], a[28:31], v[132:135], v[40:43]
  s_barrier
  ds_read_b128 a[0:3], v5 offset:51200
  s_waitcnt vmcnt(15)
  v_mfma_f32_16x16x32_bf16 v[44:47], a[28:31], v[136:139], v[44:47]
  ds_read_b128 a[4:7], v5 offset:52224
  s_waitcnt lgkmcnt(7)
  v_mfma_f32_16x16x32_bf16 v[48:51], a[32:35], v[132:135], v[48:51]
  ds_read_b128 a[8:11], v5 offset:53248
  v_mfma_f32_16x16x32_bf16 v[52:55], a[32:35], v[136:139], v[52:55]
  ds_read_b128 a[12:15], v5 offset:54272
  s_waitcnt lgkmcnt(8)
  v_mfma_f32_16x16x32_bf16 v[56:59], a[36:39], v[132:135], v[56:59]
  ds_read_b128 a[16:19], v5 offset:55296
  v_mfma_f32_16x16x32_bf16 v[60:63], a[36:39], v[136:139], v[60:63]
  ds_read_b128 a[20:23], v5 offset:56320
  s_waitcnt lgkmcnt(9)
  v_mfma_f32_16x16x32_bf16 v[64:67], a[40:43], v[132:135], v[64:67]
  ds_read_b128 a[24:27], v5 offset:57344
  v_mfma_f32_16x16x32_bf16 v[68:71], a[40:43], v[136:139], v[68:71]
  s_waitcnt lgkmcnt(9)
  v_mfma_f32_16x16x32_bf16 v[72:75], a[44:47], v[132:135], v[72:75]
  v_mfma_f32_16x16x32_bf16 v[76:79], a[44:47], v[136:139], v[76:79]
  buffer_load_dwordx4 v[164:167], v5, s[20:23], s54 offen offset:1024 sc1
  s_waitcnt lgkmcnt(8)
  v_mfma_f32_16x16x32_bf16 v[80:83], a[48:51], v[132:135], v[80:83]
  v_mfma_f32_16x16x32_bf16 v[84:87], a[48:51], v[136:139], v[84:87]
  buffer_load_dwordx4 v[168:171], v5, s[20:23], s55 offen offset:1024 sc1
  s_waitcnt lgkmcnt(7)
  v_mfma_f32_16x16x32_bf16 v[88:91], a[52:55], v[132:135], v[88:91]
  v_mfma_f32_16x16x32_bf16 v[92:95], a[52:55], v[136:139], v[92:95]
  s_waitcnt vmcnt(16) lgkmcnt(6)
  v_mfma_f32_16x16x32_bf16 v[40:43], a[0:3], v[140:143], v[40:43]
  s_barrier
  ds_read_b128 a[28:31], v5 offset:58368
  s_waitcnt vmcnt(15)
  v_mfma_f32_16x16x32_bf16 v[44:47], a[0:3], v[144:147], v[44:47]
  ds_read_b128 a[32:35], v5 offset:59392
  s_waitcnt lgkmcnt(7)
  v_mfma_f32_16x16x32_bf16 v[48:51], a[4:7], v[140:143], v[48:51]
  ds_read_b128 a[36:39], v5 offset:60416
  v_mfma_f32_16x16x32_bf16 v[52:55], a[4:7], v[144:147], v[52:55]
  ds_read_b128 a[40:43], v5 offset:61440
  s_waitcnt lgkmcnt(8)
  v_mfma_f32_16x16x32_bf16 v[56:59], a[8:11], v[140:143], v[56:59]
  ds_read_b128 a[44:47], v5 offset:62464
  v_mfma_f32_16x16x32_bf16 v[60:63], a[8:11], v[144:147], v[60:63]
  ds_read_b128 a[48:51], v5 offset:63488
  s_waitcnt lgkmcnt(9)
  v_mfma_f32_16x16x32_bf16 v[64:67], a[12:15], v[140:143], v[64:67]
  ds_read_b128 a[52:55], v5 offset:64512
  v_mfma_f32_16x16x32_bf16 v[68:71], a[12:15], v[144:147], v[68:71]
  s_waitcnt lgkmcnt(9)
  v_mfma_f32_16x16x32_bf16 v[72:75], a[16:19], v[140:143], v[72:75]
  v_mfma_f32_16x16x32_bf16 v[76:79], a[16:19], v[144:147], v[76:79]
  buffer_load_dwordx4 v[172:175], v5, s[20:23], s54 offen offset:2048 sc1
  s_waitcnt lgkmcnt(8)
  v_mfma_f32_16x16x32_bf16 v[80:83], a[20:23], v[140:143], v[80:83]
  v_mfma_f32_16x16x32_bf16 v[84:87], a[20:23], v[144:147], v[84:87]
  buffer_load_dwordx4 v[176:179], v5, s[20:23], s55 offen offset:2048 sc1
  s_waitcnt lgkmcnt(7)
  v_mfma_f32_16x16x32_bf16 v[88:91], a[24:27], v[140:143], v[88:91]
  v_mfma_f32_16x16x32_bf16 v[92:95], a[24:27], v[144:147], v[92:95]
  s_waitcnt vmcnt(16) lgkmcnt(6)
  v_mfma_f32_16x16x32_bf16 v[40:43], a[28:31], v[148:151], v[40:43]
  s_barrier
  ds_read_b128 a[0:3], v6 offset:0
  s_waitcnt vmcnt(15)
  v_mfma_f32_16x16x32_bf16 v[44:47], a[28:31], v[152:155], v[44:47]
  ds_read_b128 a[4:7], v6 offset:1024
  s_waitcnt lgkmcnt(7)
  v_mfma_f32_16x16x32_bf16 v[48:51], a[32:35], v[148:151], v[48:51]
  ds_read_b128 a[8:11], v6 offset:2048
  v_mfma_f32_16x16x32_bf16 v[52:55], a[32:35], v[152:155], v[52:55]
  ds_read_b128 a[12:15], v6 offset:3072
  s_waitcnt lgkmcnt(8)
  v_mfma_f32_16x16x32_bf16 v[56:59], a[36:39], v[148:151], v[56:59]
  ds_read_b128 a[16:19], v6 offset:4096
  v_mfma_f32_16x16x32_bf16 v[60:63], a[36:39], v[152:155], v[60:63]
  ds_read_b128 a[20:23], v6 offset:5120
  s_waitcnt lgkmcnt(9)
  v_mfma_f32_16x16x32_bf16 v[64:67], a[40:43], v[148:151], v[64:67]
  ds_read_b128 a[24:27], v6 offset:6144
  v_mfma_f32_16x16x32_bf16 v[68:71], a[40:43], v[152:155], v[68:71]
  s_waitcnt lgkmcnt(9)
  v_mfma_f32_16x16x32_bf16 v[72:75], a[44:47], v[148:151], v[72:75]
  v_mfma_f32_16x16x32_bf16 v[76:79], a[44:47], v[152:155], v[76:79]
  buffer_load_dwordx4 v[180:183], v5, s[20:23], s54 offen offset:3072 sc1
  s_waitcnt lgkmcnt(8)
  v_mfma_f32_16x16x32_bf16 v[80:83], a[48:51], v[148:151], v[80:83]
  v_mfma_f32_16x16x32_bf16 v[84:87], a[48:51], v[152:155], v[84:87]
  buffer_load_dwordx4 a[56:59], v5, s[20:23], s55 offen offset:3072 sc1
  s_waitcnt lgkmcnt(7)
  v_mfma_f32_16x16x32_bf16 v[88:91], a[52:55], v[148:151], v[88:91]
  v_mfma_f32_16x16x32_bf16 v[92:95], a[52:55], v[152:155], v[92:95]
  s_waitcnt vmcnt(7) lgkmcnt(6)
  v_mfma_f32_16x16x32_bf16 v[40:43], a[0:3], v[156:159], v[40:43]
  s_barrier
  ds_read_b128 a[28:31], v6 offset:7168
  s_waitcnt vmcnt(6)
  v_mfma_f32_16x16x32_bf16 v[44:47], a[0:3], v[160:163], v[44:47]
  ds_read_b128 a[32:35], v6 offset:8192
  s_waitcnt lgkmcnt(7)
  v_mfma_f32_16x16x32_bf16 v[48:51], a[4:7], v[156:159], v[48:51]
  ds_read_b128 a[36:39], v6 offset:9216
  v_mfma_f32_16x16x32_bf16 v[52:55], a[4:7], v[160:163], v[52:55]
  ds_read_b128 a[40:43], v6 offset:10240
  s_waitcnt lgkmcnt(8)
  v_mfma_f32_16x16x32_bf16 v[56:59], a[8:11], v[156:159], v[56:59]
  ds_read_b128 a[44:47], v6 offset:11264
  v_mfma_f32_16x16x32_bf16 v[60:63], a[8:11], v[160:163], v[60:63]
  ds_read_b128 a[48:51], v6 offset:12288
  s_waitcnt lgkmcnt(9)
  v_mfma_f32_16x16x32_bf16 v[64:67], a[12:15], v[156:159], v[64:67]
  ds_read_b128 a[52:55], v6 offset:13312
  v_mfma_f32_16x16x32_bf16 v[68:71], a[12:15], v[160:163], v[68:71]
  s_waitcnt lgkmcnt(9)
  v_mfma_f32_16x16x32_bf16 v[72:75], a[16:19], v[156:159], v[72:75]
  v_mfma_f32_16x16x32_bf16 v[76:79], a[16:19], v[160:163], v[76:79]
  s_add_u32 s54, s54, 4096
  s_add_u32 s55, s55, 4096
  buffer_load_dwordx4 a[60:63], v5, s[20:23], s54 offen offset:0 sc1
  s_waitcnt lgkmcnt(8)
  v_mfma_f32_16x16x32_bf16 v[80:83], a[20:23], v[156:159], v[80:83]
  v_mfma_f32_16x16x32_bf16 v[84:87], a[20:23], v[160:163], v[84:87]
  buffer_load_dwordx4 a[64:67], v5, s[20:23], s55 offen offset:0 sc1
  s_waitcnt lgkmcnt(7)
  v_mfma_f32_16x16x32_bf16 v[88:91], a[24:27], v[156:159], v[88:91]
  v_mfma_f32_16x16x32_bf16 v[92:95], a[24:27], v[160:163], v[92:95]
  s_waitcnt vmcnt(7) lgkmcnt(6)
  v_mfma_f32_16x16x32_bf16 v[40:43], a[28:31], v[164:167], v[40:43]
  s_barrier
  ds_read_b128 a[0:3], v6 offset:14336
  s_waitcnt vmcnt(6)
  v_mfma_f32_16x16x32_bf16 v[44:47], a[28:31], v[168:171], v[44:47]
  ds_read_b128 a[4:7], v6 offset:15360
  s_waitcnt lgkmcnt(7)
  v_mfma_f32_16x16x32_bf16 v[48:51], a[32:35], v[164:167], v[48:51]
  ds_read_b128 a[8:11], v6 offset:16384
  v_mfma_f32_16x16x32_bf16 v[52:55], a[32:35], v[168:171], v[52:55]
  ds_read_b128 a[12:15], v6 offset:17408
  s_waitcnt lgkmcnt(8)
  v_mfma_f32_16x16x32_bf16 v[56:59], a[36:39], v[164:167], v[56:59]
  ds_read_b128 a[16:19], v6 offset:18432
  v_mfma_f32_16x16x32_bf16 v[60:63], a[36:39], v[168:171], v[60:63]
  ds_read_b128 a[20:23], v6 offset:19456
  s_waitcnt lgkmcnt(9)
  v_mfma_f32_16x16x32_bf16 v[64:67], a[40:43], v[164:167], v[64:67]
  ds_read_b128 a[24:27], v6 offset:20480
  v_mfma_f32_16x16x32_bf16 v[68:71], a[40:43], v[168:171], v[68:71]
  s_waitcnt lgkmcnt(9)
  v_mfma_f32_16x16x32_bf16 v[72:75], a[44:47], v[164:167], v[72:75]
  v_mfma_f32_16x16x32_bf16 v[76:79], a[44:47], v[168:171], v[76:79]
  buffer_load_dwordx4 v[124:127], v5, s[20:23], s54 offen offset:1024 sc1
  s_waitcnt lgkmcnt(8)
  v_mfma_f32_16x16x32_bf16 v[80:83], a[48:51], v[164:167], v[80:83]
  v_mfma_f32_16x16x32_bf16 v[84:87], a[48:51], v[168:171], v[84:87]
  buffer_load_dwordx4 v[128:131], v5, s[20:23], s55 offen offset:1024 sc1
  s_waitcnt lgkmcnt(7)
  v_mfma_f32_16x16x32_bf16 v[88:91], a[52:55], v[164:167], v[88:91]
  v_mfma_f32_16x16x32_bf16 v[92:95], a[52:55], v[168:171], v[92:95]
  s_waitcnt vmcnt(7) lgkmcnt(6)
  v_mfma_f32_16x16x32_bf16 v[40:43], a[0:3], v[172:175], v[40:43]
  s_barrier
  ds_read_b128 a[28:31], v6 offset:21504
  s_waitcnt vmcnt(6)
  v_mfma_f32_16x16x32_bf16 v[44:47], a[0:3], v[176:179], v[44:47]
  ds_read_b128 a[32:35], v6 offset:22528
  s_waitcnt lgkmcnt(7)
  v_mfma_f32_16x16x32_bf16 v[48:51], a[4:7], v[172:175], v[48:51]
  ds_read_b128 a[36:39], v6 offset:23552
  v_mfma_f32_16x16x32_bf16 v[52:55], a[4:7], v[176:179], v[52:55]
  ds_read_b128 a[40:43], v6 offset:24576
  s_waitcnt lgkmcnt(8)
  v_mfma_f32_16x16x32_bf16 v[56:59], a[8:11], v[172:175], v[56:59]
  ds_read_b128 a[44:47], v6 offset:25600
  v_mfma_f32_16x16x32_bf16 v[60:63], a[8:11], v[176:179], v[60:63]
  ds_read_b128 a[48:51], v6 offset:26624
  s_waitcnt lgkmcnt(9)
  v_mfma_f32_16x16x32_bf16 v[64:67], a[12:15], v[172:175], v[64:67]
  ds_read_b128 a[52:55], v6 offset:27648
  v_mfma_f32_16x16x32_bf16 v[68:71], a[12:15], v[176:179], v[68:71]
  s_waitcnt lgkmcnt(9)
  v_mfma_f32_16x16x32_bf16 v[72:75], a[16:19], v[172:175], v[72:75]
  v_mfma_f32_16x16x32_bf16 v[76:79], a[16:19], v[176:179], v[76:79]
  buffer_load_dwordx4 v[132:135], v5, s[20:23], s54 offen offset:2048 sc1
  s_waitcnt lgkmcnt(8)
  v_mfma_f32_16x16x32_bf16 v[80:83], a[20:23], v[172:175], v[80:83]
  v_mfma_f32_16x16x32_bf16 v[84:87], a[20:23], v[176:179], v[84:87]
  buffer_load_dwordx4 v[136:139], v5, s[20:23], s55 offen offset:2048 sc1
  s_waitcnt lgkmcnt(7)
  v_mfma_f32_16x16x32_bf16 v[88:91], a[24:27], v[172:175], v[88:91]
  v_mfma_f32_16x16x32_bf16 v[92:95], a[24:27], v[176:179], v[92:95]
  s_waitcnt vmcnt(7) lgkmcnt(6)
  v_mfma_f32_16x16x32_bf16 v[40:43], a[28:31], v[180:183], v[40:43]
  s_barrier
  ds_read_b128 a[0:3], v6 offset:28672
  v_add_f32 v118, v96, v98
  s_waitcnt vmcnt(6)
  v_mfma_f32_16x16x32_bf16 v[44:47], a[28:31], a[56:59], v[44:47]
  ds_read_b128 a[4:7], v6 offset:29696
  v_mov_b32 v119, v118
  s_waitcnt lgkmcnt(7)
  v_mfma_f32_16x16x32_bf16 v[48:51], a[32:35], v[180:183], v[48:51]
  ds_read_b128 a[8:11], v6 offset:30720
  s_nop 1
  v_mfma_f32_16x16x32_bf16 v[52:55], a[32:35], a[56:59], v[52:55]
  ds_read_b128 a[12:15], v6 offset:31744
  v_permlane16_swap_b32 v119, v118
  s_waitcnt lgkmcnt(8)
  v_mfma_f32_16x16x32_bf16 v[56:59], a[36:39], v[180:183], v[56:59]
  ds_read_b128 a[16:19], v6 offset:32768
  s_nop 1
  v_mfma_f32_16x16x32_bf16 v[60:63], a[36:39], a[56:59], v[60:63]
  ds_read_b128 a[20:23], v6 offset:33792
  v_add_f32 v118, v118, v119
  s_waitcnt lgkmcnt(9)
  v_mfma_f32_16x16x32_bf16 v[64:67], a[40:43], v[180:183], v[64:67]
  ds_read_b128 a[24:27], v6 offset:34816
  v_mov_b32 v119, v118
  v_mfma_f32_16x16x32_bf16 v[68:71], a[40:43], a[56:59], v[68:71]
  s_nop 1
  s_waitcnt lgkmcnt(9)
  v_mfma_f32_16x16x32_bf16 v[72:75], a[44:47], v[180:183], v[72:75]
  v_permlane32_swap_b32 v119, v118
  v_mfma_f32_16x16x32_bf16 v[76:79], a[44:47], a[56:59], v[76:79]
  buffer_load_dwordx4 v[140:143], v5, s[20:23], s54 offen offset:3072 sc1
  s_nop 1
  s_waitcnt lgkmcnt(8)
  v_mfma_f32_16x16x32_bf16 v[80:83], a[48:51], v[180:183], v[80:83]
  v_add_f32 v118, v118, v119
  v_mfma_f32_16x16x32_bf16 v[84:87], a[48:51], a[56:59], v[84:87]
  buffer_load_dwordx4 v[144:147], v5, s[20:23], s55 offen offset:3072 sc1
  v_mul_f32 v118, 0x3e000000, v118
  s_waitcnt lgkmcnt(7)
  v_mfma_f32_16x16x32_bf16 v[88:91], a[52:55], v[180:183], v[88:91]
  v_add_f32 v120, v97, v99
  v_mfma_f32_16x16x32_bf16 v[92:95], a[52:55], a[56:59], v[92:95]
  v_mov_b32 v121, 0
  s_waitcnt vmcnt(7) lgkmcnt(6)
  v_mfma_f32_16x16x32_bf16 v[40:43], a[0:3], a[60:63], v[40:43]
  s_barrier
  ds_read_b128 a[28:31], v6 offset:35840
  v_sub_f32 v96, v96, v118
  s_waitcnt vmcnt(6)
  v_mfma_f32_16x16x32_bf16 v[44:47], a[0:3], a[64:67], v[44:47]
  ds_read_b128 a[32:35], v6 offset:36864
  v_fmac_f32 v121, v96, v96
  s_waitcnt lgkmcnt(7)
  v_mfma_f32_16x16x32_bf16 v[48:51], a[4:7], a[60:63], v[48:51]
  ds_read_b128 a[36:39], v6 offset:37888
  v_sub_f32 v98, v98, v118
  v_mfma_f32_16x16x32_bf16 v[52:55], a[4:7], a[64:67], v[52:55]
  ds_read_b128 a[40:43], v6 offset:38912
  v_fmac_f32 v121, v98, v98
  s_waitcnt lgkmcnt(8)
  v_mfma_f32_16x16x32_bf16 v[56:59], a[8:11], a[60:63], v[56:59]
  ds_read_b128 a[44:47], v6 offset:39936
  v_fmamk_f32 v120, v121, 0x42a00000, v120
  v_mfma_f32_16x16x32_bf16 v[60:63], a[8:11], a[64:67], v[60:63]
  ds_read_b128 a[48:51], v6 offset:40960
  v_mov_b32 v119, v120
  s_waitcnt lgkmcnt(9)
  v_mfma_f32_16x16x32_bf16 v[64:67], a[12:15], a[60:63], v[64:67]
  ds_read_b128 a[52:55], v6 offset:41984
  s_nop 1
  v_mfma_f32_16x16x32_bf16 v[68:71], a[12:15], a[64:67], v[68:71]
  v_permlane16_swap_b32 v119, v120
  s_waitcnt lgkmcnt(9)
  v_mfma_f32_16x16x32_bf16 v[72:75], a[16:19], a[60:63], v[72:75]
  s_nop 1
  v_mfma_f32_16x16x32_bf16 v[76:79], a[16:19], a[64:67], v[76:79]
  s_add_u32 s54, s54, 4096
  s_add_u32 s55, s55, 4096
  buffer_load_dwordx4 v[148:151], v5, s[20:23], s54 offen offset:0 sc1
  v_add_f32 v120, v120, v119
  s_waitcnt lgkmcnt(8)
  v_mfma_f32_16x16x32_bf16 v[80:83], a[20:23], a[60:63], v[80:83]
  v_mov_b32 v119, v120
  v_mfma_f32_16x16x32_bf16 v[84:87], a[20:23], a[64:67], v[84:87]
  buffer_load_dwordx4 v[152:155], v5, s[20:23], s55 offen offset:0 sc1
  s_nop 1
  s_waitcnt lgkmcnt(7)
  v_mfma_f32_16x16x32_bf16 v[88:91], a[24:27], a[60:63], v[88:91]
  v_permlane32_swap_b32 v119, v120
  v_mfma_f32_16x16x32_bf16 v[92:95], a[24:27], a[64:67], v[92:95]
  s_nop 1
  s_waitcnt vmcnt(7) lgkmcnt(6)
  v_mfma_f32_16x16x32_bf16 v[40:43], a[28:31], v[124:127], v[40:43]
  s_barrier
  ds_read_b128 a[0:3], v6 offset:43008
  v_add_f32 v120, v120, v119
  s_waitcnt vmcnt(6)
  v_mfma_f32_16x16x32_bf16 v[44:47], a[28:31], v[128:131], v[44:47]
  ds_read_b128 a[4:7], v6 offset:44032
  v_mul_f32 v120, 0x3acccccd, v120
  s_waitcnt lgkmcnt(7)
  v_mfma_f32_16x16x32_bf16 v[48:51], a[32:35], v[124:127], v[48:51]
  ds_read_b128 a[8:11], v6 offset:45056
  v_add_f32 v121, 0x3727c5ac, v120
  v_mfma_f32_16x16x32_bf16 v[52:55], a[32:35], v[128:131], v[52:55]
  ds_read_b128 a[12:15], v6 offset:46080
  v_rsq_f32 v36, v121
  s_waitcnt lgkmcnt(8)
  v_mfma_f32_16x16x32_bf16 v[56:59], a[36:39], v[124:127], v[56:59]
  ds_read_b128 a[16:19], v6 offset:47104
  s_nop 0
  v_mfma_f32_16x16x32_bf16 v[60:63], a[36:39], v[128:131], v[60:63]
  ds_read_b128 a[20:23], v6 offset:48128
  v_mul_f32 v121, v36, v36
  s_waitcnt lgkmcnt(9)
  v_mfma_f32_16x16x32_bf16 v[64:67], a[40:43], v[124:127], v[64:67]
  ds_read_b128 a[24:27], v5 offset:0
  v_mul_f32 v121, v121, v120
  v_mfma_f32_16x16x32_bf16 v[68:71], a[40:43], v[128:131], v[68:71]
  v_add_f32 v121, 0x3727c5ac, v121
  s_waitcnt lgkmcnt(9)
  v_mfma_f32_16x16x32_bf16 v[72:75], a[44:47], v[124:127], v[72:75]
  v_rsq_f32 v121, v121
  v_mfma_f32_16x16x32_bf16 v[76:79], a[44:47], v[128:131], v[76:79]
  buffer_load_dwordx4 v[156:159], v5, s[20:23], s54 offen offset:1024 sc1
  s_nop 0
  s_waitcnt lgkmcnt(8)
  v_mfma_f32_16x16x32_bf16 v[80:83], a[48:51], v[124:127], v[80:83]
  v_mul_f32 v36, v36, v121
  v_mfma_f32_16x16x32_bf16 v[84:87], a[48:51], v[128:131], v[84:87]
  buffer_load_dwordx4 v[160:163], v5, s[20:23], s55 offen offset:1024 sc1
  v_mul_f32_e64 v122, -v118, v36
  s_waitcnt lgkmcnt(7)
  v_mfma_f32_16x16x32_bf16 v[88:91], a[52:55], v[124:127], v[88:91]
  v_add_f32 v118, v100, v102
  v_mfma_f32_16x16x32_bf16 v[92:95], a[52:55], v[128:131], v[92:95]
  v_mov_b32 v119, v118
  s_waitcnt vmcnt(7) lgkmcnt(6)
  v_mfma_f32_16x16x32_bf16 v[40:43], a[0:3], v[132:135], v[40:43]
  s_barrier
  ds_read_b128 a[28:31], v5 offset:1024
  s_nop 1
  s_waitcnt vmcnt(6)
  v_mfma_f32_16x16x32_bf16 v[44:47], a[0:3], v[136:139], v[44:47]
  ds_read_b128 a[32:35], v5 offset:2048
  v_permlane16_swap_b32 v119, v118
  s_waitcnt lgkmcnt(7)
  v_mfma_f32_16x16x32_bf16 v[48:51], a[4:7], v[132:135], v[48:51]
  ds_read_b128 a[36:39], v5 offset:3072
  s_nop 1
  v_mfma_f32_16x16x32_bf16 v[52:55], a[4:7], v[136:139], v[52:55]
  ds_read_b128 a[40:43], v5 offset:4096
  v_add_f32 v118, v118, v119
  s_waitcnt lgkmcnt(8)
  v_mfma_f32_16x16x32_bf16 v[56:59], a[8:11], v[132:135], v[56:59]
  ds_read_b128 a[44:47], v5 offset:5120
  v_mov_b32 v119, v118
  v_mfma_f32_16x16x32_bf16 v[60:63], a[8:11], v[136:139], v[60:63]
  ds_read_b128 a[48:51], v5 offset:6144
  s_nop 1
  s_waitcnt lgkmcnt(9)
  v_mfma_f32_16x16x32_bf16 v[64:67], a[12:15], v[132:135], v[64:67]
  ds_read_b128 a[52:55], v5 offset:7168
  v_permlane32_swap_b32 v119, v118
  v_mfma_f32_16x16x32_bf16 v[68:71], a[12:15], v[136:139], v[68:71]
  s_nop 1
  s_waitcnt lgkmcnt(9)
  v_mfma_f32_16x16x32_bf16 v[72:75], a[16:19], v[132:135], v[72:75]
  v_add_f32 v118, v118, v119
  v_mfma_f32_16x16x32_bf16 v[76:79], a[16:19], v[136:139], v[76:79]
  buffer_load_dwordx4 v[164:167], v5, s[20:23], s54 offen offset:2048 sc1
  v_mul_f32 v118, 0x3e000000, v118
  s_waitcnt lgkmcnt(8)
  v_mfma_f32_16x16x32_bf16 v[80:83], a[20:23], v[132:135], v[80:83]
  v_add_f32 v120, v101, v103
  v_mfma_f32_16x16x32_bf16 v[84:87], a[20:23], v[136:139], v[84:87]
  buffer_load_dwordx4 v[168:171], v5, s[20:23], s55 offen offset:2048 sc1
  v_mov_b32 v121, 0
  s_waitcnt lgkmcnt(7)
  v_mfma_f32_16x16x32_bf16 v[88:91], a[24:27], v[132:135], v[88:91]
  v_sub_f32 v100, v100, v118
  v_mfma_f32_16x16x32_bf16 v[92:95], a[24:27], v[136:139], v[92:95]
  v_fmac_f32 v121, v100, v100
  s_waitcnt vmcnt(7) lgkmcnt(6)
  v_mfma_f32_16x16x32_bf16 v[40:43], a[28:31], v[140:143], v[40:43]
  s_barrier
  ds_read_b128 a[0:3], v5 offset:8192
  v_sub_f32 v102, v102, v118
  s_waitcnt vmcnt(6)
  v_mfma_f32_16x16x32_bf16 v[44:47], a[28:31], v[144:147], v[44:47]
  ds_read_b128 a[4:7], v5 offset:9216
  v_fmac_f32 v121, v102, v102
  s_waitcnt lgkmcnt(7)
  v_mfma_f32_16x16x32_bf16 v[48:51], a[32:35], v[140:143], v[48:51]
  ds_read_b128 a[8:11], v5 offset:10240
  v_fmamk_f32 v120, v121, 0x42a00000, v120
  v_mfma_f32_16x16x32_bf16 v[52:55], a[32:35], v[144:147], v[52:55]
  ds_read_b128 a[12:15], v5 offset:11264
  v_mov_b32 v119, v120
  s_waitcnt lgkmcnt(8)
  v_mfma_f32_16x16x32_bf16 v[56:59], a[36:39], v[140:143], v[56:59]
  ds_read_b128 a[16:19], v5 offset:12288
  s_nop 1
  v_mfma_f32_16x16x32_bf16 v[60:63], a[36:39], v[144:147], v[60:63]
  ds_read_b128 a[20:23], v5 offset:13312
  v_permlane16_swap_b32 v119, v120
  s_waitcnt lgkmcnt(9)
  v_mfma_f32_16x16x32_bf16 v[64:67], a[40:43], v[140:143], v[64:67]
  ds_read_b128 a[24:27], v5 offset:14336
  s_nop 1
  v_mfma_f32_16x16x32_bf16 v[68:71], a[40:43], v[144:147], v[68:71]
  v_add_f32 v120, v120, v119
  s_waitcnt lgkmcnt(9)
  v_mfma_f32_16x16x32_bf16 v[72:75], a[44:47], v[140:143], v[72:75]
  v_mov_b32 v119, v120
  v_mfma_f32_16x16x32_bf16 v[76:79], a[44:47], v[144:147], v[76:79]
  buffer_load_dwordx4 v[172:175], v5, s[20:23], s54 offen offset:3072 sc1
  s_nop 1
  s_waitcnt lgkmcnt(8)
  v_mfma_f32_16x16x32_bf16 v[80:83], a[48:51], v[140:143], v[80:83]
  v_permlane32_swap_b32 v119, v120
  v_mfma_f32_16x16x32_bf16 v[84:87], a[48:51], v[144:147], v[84:87]
  buffer_load_dwordx4 v[176:179], v5, s[20:23], s55 offen offset:3072 sc1
  s_nop 1
  s_waitcnt lgkmcnt(7)
  v_mfma_f32_16x16x32_bf16 v[88:91], a[52:55], v[140:143], v[88:91]
  v_add_f32 v120, v120, v119
  v_mfma_f32_16x16x32_bf16 v[92:95], a[52:55], v[144:147], v[92:95]
  v_mul_f32 v120, 0x3acccccd, v120
  s_waitcnt vmcnt(7) lgkmcnt(6)
  v_mfma_f32_16x16x32_bf16 v[40:43], a[0:3], v[148:151], v[40:43]
  s_barrier
  ds_read_b128 a[28:31], v5 offset:15360
  v_add_f32 v121, 0x3727c5ac, v120
  s_waitcnt vmcnt(6)
  v_mfma_f32_16x16x32_bf16 v[44:47], a[0:3], v[152:155], v[44:47]
  ds_read_b128 a[32:35], v5 offset:16384
  v_rsq_f32 v37, v121
  s_waitcnt lgkmcnt(7)
  v_mfma_f32_16x16x32_bf16 v[48:51], a[4:7], v[148:151], v[48:51]
  ds_read_b128 a[36:39], v5 offset:17408
  s_nop 0
  v_mfma_f32_16x16x32_bf16 v[52:55], a[4:7], v[152:155], v[52:55]
  ds_read_b128 a[40:43], v5 offset:18432
  v_mul_f32 v121, v37, v37
  s_waitcnt lgkmcnt(8)
  v_mfma_f32_16x16x32_bf16 v[56:59], a[8:11], v[148:151], v[56:59]
  ds_read_b128 a[44:47], v5 offset:19456
  v_mul_f32 v121, v121, v120
  v_mfma_f32_16x16x32_bf16 v[60:63], a[8:11], v[152:155], v[60:63]
  ds_read_b128 a[48:51], v5 offset:20480
  v_add_f32 v121, 0x3727c5ac, v121
  s_waitcnt lgkmcnt(9)
  v_mfma_f32_16x16x32_bf16 v[64:67], a[12:15], v[148:151], v[64:67]
  ds_read_b128 a[52:55], v5 offset:21504
  v_rsq_f32 v121, v121
  v_mfma_f32_16x16x32_bf16 v[68:71], a[12:15], v[152:155], v[68:71]
  s_nop 0
  s_waitcnt lgkmcnt(9)
  v_mfma_f32_16x16x32_bf16 v[72:75], a[16:19], v[148:151], v[72:75]
  v_mul_f32 v37, v37, v121
  v_mfma_f32_16x16x32_bf16 v[76:79], a[16:19], v[152:155], v[76:79]
  s_add_u32 s54, s54, 4096
  s_add_u32 s55, s55, 4096
  buffer_load_dwordx4 v[180:183], v5, s[20:23], s54 offen offset:0 sc1
  v_mul_f32_e64 v123, -v118, v37
  s_waitcnt lgkmcnt(8)
  v_mfma_f32_16x16x32_bf16 v[80:83], a[20:23], v[148:151], v[80:83]
  v_mfma_f32_16x16x32_bf16 v[84:87], a[20:23], v[152:155], v[84:87]
  buffer_load_dwordx4 a[56:59], v5, s[20:23], s55 offen offset:0 sc1
  s_waitcnt lgkmcnt(7)
  v_mfma_f32_16x16x32_bf16 v[88:91], a[24:27], v[148:151], v[88:91]
  v_mfma_f32_16x16x32_bf16 v[92:95], a[24:27], v[152:155], v[92:95]
  s_waitcnt vmcnt(7) lgkmcnt(6)
  v_mfma_f32_16x16x32_bf16 v[40:43], a[28:31], v[156:159], v[40:43]
  s_barrier
  ds_read_b128 a[0:3], v5 offset:22528
  s_waitcnt vmcnt(6)
  v_mfma_f32_16x16x32_bf16 v[44:47], a[28:31], v[160:163], v[44:47]
  ds_read_b128 a[4:7], v5 offset:23552
  s_waitcnt lgkmcnt(7)
  v_mfma_f32_16x16x32_bf16 v[48:51], a[32:35], v[156:159], v[48:51]
  ds_read_b128 a[8:11], v5 offset:24576
  v_mfma_f32_16x16x32_bf16 v[52:55], a[32:35], v[160:163], v[52:55]
  ds_read_b128 a[12:15], v5 offset:25600
  s_waitcnt lgkmcnt(8)
  v_mfma_f32_16x16x32_bf16 v[56:59], a[36:39], v[156:159], v[56:59]
  ds_read_b128 a[16:19], v5 offset:26624
  v_mfma_f32_16x16x32_bf16 v[60:63], a[36:39], v[160:163], v[60:63]
  ds_read_b128 a[20:23], v5 offset:27648
  s_waitcnt lgkmcnt(9)
  v_mfma_f32_16x16x32_bf16 v[64:67], a[40:43], v[156:159], v[64:67]
  ds_read_b128 a[24:27], v5 offset:28672
  v_mfma_f32_16x16x32_bf16 v[68:71], a[40:43], v[160:163], v[68:71]
  s_waitcnt lgkmcnt(9)
  v_mfma_f32_16x16x32_bf16 v[72:75], a[44:47], v[156:159], v[72:75]
  v_mfma_f32_16x16x32_bf16 v[76:79], a[44:47], v[160:163], v[76:79]
  buffer_load_dwordx4 a[60:63], v5, s[20:23], s54 offen offset:1024 sc1
  s_waitcnt lgkmcnt(8)
  v_mfma_f32_16x16x32_bf16 v[80:83], a[48:51], v[156:159], v[80:83]
  v_mfma_f32_16x16x32_bf16 v[84:87], a[48:51], v[160:163], v[84:87]
  buffer_load_dwordx4 a[64:67], v5, s[20:23], s55 offen offset:1024 sc1
  s_waitcnt lgkmcnt(7)
  v_mfma_f32_16x16x32_bf16 v[88:91], a[52:55], v[156:159], v[88:91]
  v_mfma_f32_16x16x32_bf16 v[92:95], a[52:55], v[160:163], v[92:95]
  s_waitcnt vmcnt(7) lgkmcnt(6)
  v_mfma_f32_16x16x32_bf16 v[40:43], a[0:3], v[164:167], v[40:43]
  s_barrier
  ds_read_b128 a[28:31], v5 offset:29696
  s_waitcnt vmcnt(6)
  v_mfma_f32_16x16x32_bf16 v[44:47], a[0:3], v[168:171], v[44:47]
  ds_read_b128 a[32:35], v5 offset:30720
  s_waitcnt lgkmcnt(7)
  v_mfma_f32_16x16x32_bf16 v[48:51], a[4:7], v[164:167], v[48:51]
  ds_read_b128 a[36:39], v5 offset:31744
  v_mfma_f32_16x16x32_bf16 v[52:55], a[4:7], v[168:171], v[52:55]
  ds_read_b128 a[40:43], v5 offset:32768
  s_waitcnt lgkmcnt(8)
  v_mfma_f32_16x16x32_bf16 v[56:59], a[8:11], v[164:167], v[56:59]
  ds_read_b128 a[44:47], v5 offset:33792
  v_mfma_f32_16x16x32_bf16 v[60:63], a[8:11], v[168:171], v[60:63]
  ds_read_b128 a[48:51], v5 offset:34816
  s_waitcnt lgkmcnt(9)
  v_mfma_f32_16x16x32_bf16 v[64:67], a[12:15], v[164:167], v[64:67]
  ds_read_b128 a[52:55], v5 offset:35840
  v_mfma_f32_16x16x32_bf16 v[68:71], a[12:15], v[168:171], v[68:71]
  s_waitcnt lgkmcnt(9)
  v_mfma_f32_16x16x32_bf16 v[72:75], a[16:19], v[164:167], v[72:75]
  v_mfma_f32_16x16x32_bf16 v[76:79], a[16:19], v[168:171], v[76:79]
  buffer_load_dwordx4 v[124:127], v5, s[20:23], s54 offen offset:2048 sc1
  s_waitcnt lgkmcnt(8)
  v_mfma_f32_16x16x32_bf16 v[80:83], a[20:23], v[164:167], v[80:83]
  v_mfma_f32_16x16x32_bf16 v[84:87], a[20:23], v[168:171], v[84:87]
  buffer_load_dwordx4 v[128:131], v5, s[20:23], s55 offen offset:2048 sc1
  s_waitcnt lgkmcnt(7)
  v_mfma_f32_16x16x32_bf16 v[88:91], a[24:27], v[164:167], v[88:91]
  v_mfma_f32_16x16x32_bf16 v[92:95], a[24:27], v[168:171], v[92:95]
  s_waitcnt vmcnt(7) lgkmcnt(6)
  v_mfma_f32_16x16x32_bf16 v[40:43], a[28:31], v[172:175], v[40:43]
  s_barrier
  ds_read_b128 a[0:3], v5 offset:36864
  s_waitcnt vmcnt(6)
  v_mfma_f32_16x16x32_bf16 v[44:47], a[28:31], v[176:179], v[44:47]
  ds_read_b128 a[4:7], v5 offset:37888
  s_waitcnt lgkmcnt(7)
  v_mfma_f32_16x16x32_bf16 v[48:51], a[32:35], v[172:175], v[48:51]
  ds_read_b128 a[8:11], v5 offset:38912
  v_mfma_f32_16x16x32_bf16 v[52:55], a[32:35], v[176:179], v[52:55]
  ds_read_b128 a[12:15], v5 offset:39936
  s_waitcnt lgkmcnt(8)
  v_mfma_f32_16x16x32_bf16 v[56:59], a[36:39], v[172:175], v[56:59]
  ds_read_b128 a[16:19], v5 offset:40960
  v_mfma_f32_16x16x32_bf16 v[60:63], a[36:39], v[176:179], v[60:63]
  ds_read_b128 a[20:23], v5 offset:41984
  s_waitcnt lgkmcnt(9)
  v_mfma_f32_16x16x32_bf16 v[64:67], a[40:43], v[172:175], v[64:67]
  ds_read_b128 a[24:27], v5 offset:43008
  v_mfma_f32_16x16x32_bf16 v[68:71], a[40:43], v[176:179], v[68:71]
  s_waitcnt lgkmcnt(9)
  v_mfma_f32_16x16x32_bf16 v[72:75], a[44:47], v[172:175], v[72:75]
  v_mfma_f32_16x16x32_bf16 v[76:79], a[44:47], v[176:179], v[76:79]
  buffer_load_dwordx4 v[132:135], v5, s[20:23], s54 offen offset:3072 sc1
  s_waitcnt lgkmcnt(8)
  v_mfma_f32_16x16x32_bf16 v[80:83], a[48:51], v[172:175], v[80:83]
  v_mfma_f32_16x16x32_bf16 v[84:87], a[48:51], v[176:179], v[84:87]
  buffer_load_dwordx4 v[136:139], v5, s[20:23], s55 offen offset:3072 sc1
  s_waitcnt lgkmcnt(7)
  v_mfma_f32_16x16x32_bf16 v[88:91], a[52:55], v[172:175], v[88:91]
  v_mfma_f32_16x16x32_bf16 v[92:95], a[52:55], v[176:179], v[92:95]
  s_waitcnt vmcnt(7) lgkmcnt(6)
  v_mfma_f32_16x16x32_bf16 v[40:43], a[0:3], v[180:183], v[40:43]
  s_barrier
  ds_read_b128 a[28:31], v5 offset:44032
  s_waitcnt vmcnt(6)
  v_mfma_f32_16x16x32_bf16 v[44:47], a[0:3], a[56:59], v[44:47]
  ds_read_b128 a[32:35], v5 offset:45056
  s_waitcnt lgkmcnt(7)
  v_mfma_f32_16x16x32_bf16 v[48:51], a[4:7], v[180:183], v[48:51]
  ds_read_b128 a[36:39], v5 offset:46080
  v_mfma_f32_16x16x32_bf16 v[52:55], a[4:7], a[56:59], v[52:55]
  ds_read_b128 a[40:43], v5 offset:47104
  s_waitcnt lgkmcnt(8)
  v_mfma_f32_16x16x32_bf16 v[56:59], a[8:11], v[180:183], v[56:59]
  ds_read_b128 a[44:47], v5 offset:48128
  v_mfma_f32_16x16x32_bf16 v[60:63], a[8:11], a[56:59], v[60:63]
  ds_read_b128 a[48:51], v5 offset:49152
  s_waitcnt lgkmcnt(9)
  v_mfma_f32_16x16x32_bf16 v[64:67], a[12:15], v[180:183], v[64:67]
  ds_read_b128 a[52:55], v5 offset:50176
  v_mfma_f32_16x16x32_bf16 v[68:71], a[12:15], a[56:59], v[68:71]
  s_waitcnt lgkmcnt(9)
  v_mfma_f32_16x16x32_bf16 v[72:75], a[16:19], v[180:183], v[72:75]
  v_mfma_f32_16x16x32_bf16 v[76:79], a[16:19], a[56:59], v[76:79]
  s_waitcnt lgkmcnt(8)
  v_mfma_f32_16x16x32_bf16 v[80:83], a[20:23], v[180:183], v[80:83]
  v_mfma_f32_16x16x32_bf16 v[84:87], a[20:23], a[56:59], v[84:87]
  s_waitcnt lgkmcnt(7)
  v_mfma_f32_16x16x32_bf16 v[88:91], a[24:27], v[180:183], v[88:91]
  v_mfma_f32_16x16x32_bf16 v[92:95], a[24:27], a[56:59], v[92:95]
  s_waitcnt vmcnt(5) lgkmcnt(6)
  v_mfma_f32_16x16x32_bf16 v[40:43], a[28:31], a[60:63], v[40:43]
  s_barrier
  ds_read_b128 a[0:3], v5 offset:51200
  s_waitcnt vmcnt(4)
  v_mfma_f32_16x16x32_bf16 v[44:47], a[28:31], a[64:67], v[44:47]
  ds_read_b128 a[4:7], v5 offset:52224
  s_waitcnt lgkmcnt(7)
  v_mfma_f32_16x16x32_bf16 v[48:51], a[32:35], a[60:63], v[48:51]
  ds_read_b128 a[8:11], v5 offset:53248
  v_mfma_f32_16x16x32_bf16 v[52:55], a[32:35], a[64:67], v[52:55]
  ds_read_b128 a[12:15], v5 offset:54272
  s_waitcnt lgkmcnt(8)
  v_mfma_f32_16x16x32_bf16 v[56:59], a[36:39], a[60:63], v[56:59]
  ds_read_b128 a[16:19], v5 offset:55296
  v_mfma_f32_16x16x32_bf16 v[60:63], a[36:39], a[64:67], v[60:63]
  ds_read_b128 a[20:23], v5 offset:56320
  s_waitcnt lgkmcnt(9)
  v_mfma_f32_16x16x32_bf16 v[64:67], a[40:43], a[60:63], v[64:67]
  ds_read_b128 a[24:27], v5 offset:57344
  v_mfma_f32_16x16x32_bf16 v[68:71], a[40:43], a[64:67], v[68:71]
  s_waitcnt lgkmcnt(9)
  v_mfma_f32_16x16x32_bf16 v[72:75], a[44:47], a[60:63], v[72:75]
  v_mfma_f32_16x16x32_bf16 v[76:79], a[44:47], a[64:67], v[76:79]
  s_waitcnt lgkmcnt(8)
  v_mfma_f32_16x16x32_bf16 v[80:83], a[48:51], a[60:63], v[80:83]
  v_mfma_f32_16x16x32_bf16 v[84:87], a[48:51], a[64:67], v[84:87]
  s_waitcnt lgkmcnt(7)
  v_mfma_f32_16x16x32_bf16 v[88:91], a[52:55], a[60:63], v[88:91]
  v_mfma_f32_16x16x32_bf16 v[92:95], a[52:55], a[64:67], v[92:95]
  s_waitcnt vmcnt(3) lgkmcnt(6)
  v_mfma_f32_16x16x32_bf16 v[40:43], a[0:3], v[124:127], v[40:43]
  s_barrier
  ds_read_b128 a[28:31], v5 offset:58368
  s_waitcnt vmcnt(2)
  v_mfma_f32_16x16x32_bf16 v[44:47], a[0:3], v[128:131], v[44:47]
  ds_read_b128 a[32:35], v5 offset:59392
  s_waitcnt lgkmcnt(7)
  v_mfma_f32_16x16x32_bf16 v[48:51], a[4:7], v[124:127], v[48:51]
  ds_read_b128 a[36:39], v5 offset:60416
  v_mfma_f32_16x16x32_bf16 v[52:55], a[4:7], v[128:131], v[52:55]
  ds_read_b128 a[40:43], v5 offset:61440
  s_waitcnt lgkmcnt(8)
  v_mfma_f32_16x16x32_bf16 v[56:59], a[8:11], v[124:127], v[56:59]
  ds_read_b128 a[44:47], v5 offset:62464
  v_mfma_f32_16x16x32_bf16 v[60:63], a[8:11], v[128:131], v[60:63]
  ds_read_b128 a[48:51], v5 offset:63488
  s_waitcnt lgkmcnt(9)
  v_mfma_f32_16x16x32_bf16 v[64:67], a[12:15], v[124:127], v[64:67]
  ds_read_b128 a[52:55], v5 offset:64512
  v_mfma_f32_16x16x32_bf16 v[68:71], a[12:15], v[128:131], v[68:71]
  s_waitcnt lgkmcnt(9)
  v_mfma_f32_16x16x32_bf16 v[72:75], a[16:19], v[124:127], v[72:75]
  v_mfma_f32_16x16x32_bf16 v[76:79], a[16:19], v[128:131], v[76:79]
  s_waitcnt lgkmcnt(8)
  v_mfma_f32_16x16x32_bf16 v[80:83], a[20:23], v[124:127], v[80:83]
  v_mfma_f32_16x16x32_bf16 v[84:87], a[20:23], v[128:131], v[84:87]
  s_waitcnt lgkmcnt(7)
  v_mfma_f32_16x16x32_bf16 v[88:91], a[24:27], v[124:127], v[88:91]
  v_mfma_f32_16x16x32_bf16 v[92:95], a[24:27], v[128:131], v[92:95]
  s_waitcnt vmcnt(1) lgkmcnt(6)
  v_mfma_f32_16x16x32_bf16 v[40:43], a[28:31], v[132:135], v[40:43]
  s_waitcnt vmcnt(0)
  v_mfma_f32_16x16x32_bf16 v[44:47], a[28:31], v[136:139], v[44:47]
  s_waitcnt lgkmcnt(5)
  v_mfma_f32_16x16x32_bf16 v[48:51], a[32:35], v[132:135], v[48:51]
  v_mfma_f32_16x16x32_bf16 v[52:55], a[32:35], v[136:139], v[52:55]
  s_waitcnt lgkmcnt(4)
  v_mfma_f32_16x16x32_bf16 v[56:59], a[36:39], v[132:135], v[56:59]
  v_mfma_f32_16x16x32_bf16 v[60:63], a[36:39], v[136:139], v[60:63]
  s_waitcnt lgkmcnt(3)
  v_mfma_f32_16x16x32_bf16 v[64:67], a[40:43], v[132:135], v[64:67]
  v_mfma_f32_16x16x32_bf16 v[68:71], a[40:43], v[136:139], v[68:71]
  s_waitcnt lgkmcnt(2)
  v_mfma_f32_16x16x32_bf16 v[72:75], a[44:47], v[132:135], v[72:75]
  v_mfma_f32_16x16x32_bf16 v[76:79], a[44:47], v[136:139], v[76:79]
  s_waitcnt lgkmcnt(1)
  v_mfma_f32_16x16x32_bf16 v[80:83], a[48:51], v[132:135], v[80:83]
  v_mfma_f32_16x16x32_bf16 v[84:87], a[48:51], v[136:139], v[84:87]
  s_waitcnt lgkmcnt(0)
  v_mfma_f32_16x16x32_bf16 v[88:91], a[52:55], v[132:135], v[88:91]
  v_mfma_f32_16x16x32_bf16 v[92:95], a[52:55], v[136:139], v[92:95]
  s_barrier
  v_lshlrev_b32 v30, 4, v4
  v_add_u32 v30, 163072, v30
  ds_read_b128 v[156:159], v30 offset:0
  ds_read_b128 v[160:163], v30 offset:64
  ds_read_b128 v[164:167], v30 offset:128
  ds_read_b128 v[168:171], v30 offset:192
  ds_read_b128 v[172:175], v30 offset:256
  ds_read_b128 v[176:179], v30 offset:320
  ds_read_b128 v[180:183], v30 offset:384
  s_waitcnt lgkmcnt(0)
  s_mov_b32 s50, 0xbdd2d3e8
  s_mov_b32 s51, s50
  v_mov_b32 v32, 0xc0135761
  v_mov_b32 v33, 0xc0135761
  s_mov_b32 s52, 1.0
  s_mov_b32 s53, 1.0
  s_lshl_b32 s46, s40, 3
  s_lshl_b32 s47, s18, 1
  s_add_u32 s46, s46, s47
  s_mul_i32 s46, s46, 57344
  s_mul_i32 s47, s41, 3584
  s_add_u32 s46, s46, s47
  s_mul_i32 s47, s16, 0
  s_add_u32 s46, s46, s47
  s_add_u32 s46, s46, 13631488
  v_lshlrev_b32 v124, 16, v104
  v_and_b32 v125, 0xffff0000, v104
  v_lshlrev_b32 v126, 16, v105
  v_and_b32 v127, 0xffff0000, v105
  v_pk_fma_f32 v[132:133], v[156:157], v[122:123], v[124:125] op_sel_hi:[1,0,1]
  v_pk_fma_f32 v[134:135], v[158:159], v[122:123], v[126:127] op_sel_hi:[1,0,1]
  v_pk_fma_f32 v[136:137], v[156:157], v[122:123], v[124:125] op_sel:[0,1,0] op_sel_hi:[1,1,1]
  v_pk_fma_f32 v[138:139], v[158:159], v[122:123], v[126:127] op_sel:[0,1,0] op_sel_hi:[1,1,1]
  v_pk_fma_f32 v[40:41], v[40:41], v[36:37], v[132:133] op_sel_hi:[1,0,1]
  v_pk_fma_f32 v[42:43], v[42:43], v[36:37], v[134:135] op_sel_hi:[1,0,1]
  v_pk_fma_f32 v[44:45], v[44:45], v[36:37], v[136:137] op_sel:[0,1,0] op_sel_hi:[1,1,1]
  v_pk_fma_f32 v[46:47], v[46:47], v[36:37], v[138:139] op_sel:[0,1,0] op_sel_hi:[1,1,1]
  v_pk_mul_f32 v[132:133], v[40:41], v[40:41]
  v_pk_mul_f32 v[134:135], v[42:43], v[42:43]
  v_pk_mul_f32 v[136:137], v[44:45], v[44:45]
  v_pk_mul_f32 v[138:139], v[46:47], v[46:47]
  v_pk_fma_f32 v[132:133], v[132:133], s[50:51], v[32:33]
  v_pk_fma_f32 v[134:135], v[134:135], s[50:51], v[32:33]
  v_pk_fma_f32 v[136:137], v[136:137], s[50:51], v[32:33]
  v_pk_fma_f32 v[138:139], v[138:139], s[50:51], v[32:33]
  v_pk_mul_f32 v[132:133], v[132:133], v[40:41]
  v_pk_mul_f32 v[134:135], v[134:135], v[42:43]
  v_pk_mul_f32 v[136:137], v[136:137], v[44:45]
  v_pk_mul_f32 v[138:139], v[138:139], v[46:47]
  v_exp_f32 v132, v132
  v_exp_f32 v133, v133
  v_exp_f32 v134, v134
  v_exp_f32 v135, v135
  v_exp_f32 v136, v136
  v_exp_f32 v137, v137
  v_exp_f32 v138, v138
  v_exp_f32 v139, v139
  v_pk_add_f32 v[132:133], v[132:133], s[52:53]
  v_pk_add_f32 v[134:135], v[134:135], s[52:53]
  v_pk_add_f32 v[136:137], v[136:137], s[52:53]
  v_pk_add_f32 v[138:139], v[138:139], s[52:53]
  v_rcp_f32 v132, v132
  v_rcp_f32 v133, v133
  v_rcp_f32 v134, v134
  v_rcp_f32 v135, v135
  v_rcp_f32 v136, v136
  v_rcp_f32 v137, v137
  v_rcp_f32 v138, v138
  v_rcp_f32 v139, v139
  s_nop 0
  v_pk_mul_f32 v[132:133], v[132:133], v[40:41]
  v_pk_mul_f32 v[134:135], v[134:135], v[42:43]
  v_pk_mul_f32 v[136:137], v[136:137], v[44:45]
  v_pk_mul_f32 v[138:139], v[138:139], v[46:47]
  v_cvt_pk_bf16_f32 v140, v132, v133
  v_cvt_pk_bf16_f32 v141, v134, v135
  v_cvt_pk_bf16_f32 v142, v136, v137
  v_cvt_pk_bf16_f32 v143, v138, v139
  s_nop 1
  v_permlane16_swap_b32 v140, v142
  v_permlane16_swap_b32 v141, v143
  s_nop 0
  buffer_store_dwordx4 v[140:143], v29, s[20:23], s46 offen offset:0
  v_lshlrev_b32 v128, 16, v106
  v_and_b32 v129, 0xffff0000, v106
  v_lshlrev_b32 v130, 16, v107
  v_and_b32 v131, 0xffff0000, v107
  v_pk_fma_f32 v[144:145], v[160:161], v[122:123], v[128:129] op_sel_hi:[1,0,1]
  v_pk_fma_f32 v[146:147], v[162:163], v[122:123], v[130:131] op_sel_hi:[1,0,1]
  v_pk_fma_f32 v[148:149], v[160:161], v[122:123], v[128:129] op_sel:[0,1,0] op_sel_hi:[1,1,1]
  v_pk_fma_f32 v[150:151], v[162:163], v[122:123], v[130:131] op_sel:[0,1,0] op_sel_hi:[1,1,1]
  v_pk_fma_f32 v[48:49], v[48:49], v[36:37], v[144:145] op_sel_hi:[1,0,1]
  v_pk_fma_f32 v[50:51], v[50:51], v[36:37], v[146:147] op_sel_hi:[1,0,1]
  v_pk_fma_f32 v[52:53], v[52:53], v[36:37], v[148:149] op_sel:[0,1,0] op_sel_hi:[1,1,1]
  v_pk_fma_f32 v[54:55], v[54:55], v[36:37], v[150:151] op_sel:[0,1,0] op_sel_hi:[1,1,1]
  v_pk_mul_f32 v[144:145], v[48:49], v[48:49]
  v_pk_mul_f32 v[146:147], v[50:51], v[50:51]
  v_pk_mul_f32 v[148:149], v[52:53], v[52:53]
  v_pk_mul_f32 v[150:151], v[54:55], v[54:55]
  v_pk_fma_f32 v[144:145], v[144:145], s[50:51], v[32:33]
  v_pk_fma_f32 v[146:147], v[146:147], s[50:51], v[32:33]
  v_pk_fma_f32 v[148:149], v[148:149], s[50:51], v[32:33]
  v_pk_fma_f32 v[150:151], v[150:151], s[50:51], v[32:33]
  v_pk_mul_f32 v[144:145], v[144:145], v[48:49]
  v_pk_mul_f32 v[146:147], v[146:147], v[50:51]
  v_pk_mul_f32 v[148:149], v[148:149], v[52:53]
  v_pk_mul_f32 v[150:151], v[150:151], v[54:55]
  v_exp_f32 v144, v144
  v_exp_f32 v145, v145
  v_exp_f32 v146, v146
  v_exp_f32 v147, v147
  v_exp_f32 v148, v148
  v_exp_f32 v149, v149
  v_exp_f32 v150, v150
  v_exp_f32 v151, v151
  v_pk_add_f32 v[144:145], v[144:145], s[52:53]
  v_pk_add_f32 v[146:147], v[146:147], s[52:53]
  v_pk_add_f32 v[148:149], v[148:149], s[52:53]
  v_pk_add_f32 v[150:151], v[150:151], s[52:53]
  v_rcp_f32 v144, v144
  v_rcp_f32 v145, v145
  v_rcp_f32 v146, v146
  v_rcp_f32 v147, v147
  v_rcp_f32 v148, v148
  v_rcp_f32 v149, v149
  v_rcp_f32 v150, v150
  v_rcp_f32 v151, v151
  s_nop 0
  v_pk_mul_f32 v[144:145], v[144:145], v[48:49]
  v_pk_mul_f32 v[146:147], v[146:147], v[50:51]
  v_pk_mul_f32 v[148:149], v[148:149], v[52:53]
  v_pk_mul_f32 v[150:151], v[150:151], v[54:55]
  v_cvt_pk_bf16_f32 v152, v144, v145
  v_cvt_pk_bf16_f32 v153, v146, v147
  v_cvt_pk_bf16_f32 v154, v148, v149
  v_cvt_pk_bf16_f32 v155, v150, v151
  s_nop 1
  v_permlane16_swap_b32 v152, v154
  v_permlane16_swap_b32 v153, v155
  s_nop 0
  buffer_store_dwordx4 v[152:155], v29, s[20:23], s46 offen offset:512
  v_lshlrev_b32 v124, 16, v108
  v_and_b32 v125, 0xffff0000, v108
  v_lshlrev_b32 v126, 16, v109
  v_and_b32 v127, 0xffff0000, v109
  v_pk_fma_f32 v[132:133], v[164:165], v[122:123], v[124:125] op_sel_hi:[1,0,1]
  v_pk_fma_f32 v[134:135], v[166:167], v[122:123], v[126:127] op_sel_hi:[1,0,1]
  v_pk_fma_f32 v[136:137], v[164:165], v[122:123], v[124:125] op_sel:[0,1,0] op_sel_hi:[1,1,1]
  v_pk_fma_f32 v[138:139], v[166:167], v[122:123], v[126:127] op_sel:[0,1,0] op_sel_hi:[1,1,1]
  v_pk_fma_f32 v[56:57], v[56:57], v[36:37], v[132:133] op_sel_hi:[1,0,1]
  v_pk_fma_f32 v[58:59], v[58:59], v[36:37], v[134:135] op_sel_hi:[1,0,1]
  v_pk_fma_f32 v[60:61], v[60:61], v[36:37], v[136:137] op_sel:[0,1,0] op_sel_hi:[1,1,1]
  v_pk_fma_f32 v[62:63], v[62:63], v[36:37], v[138:139] op_sel:[0,1,0] op_sel_hi:[1,1,1]
  v_pk_mul_f32 v[132:133], v[56:57], v[56:57]
  v_pk_mul_f32 v[134:135], v[58:59], v[58:59]
  v_pk_mul_f32 v[136:137], v[60:61], v[60:61]
  v_pk_mul_f32 v[138:139], v[62:63], v[62:63]
  v_pk_fma_f32 v[132:133], v[132:133], s[50:51], v[32:33]
  v_pk_fma_f32 v[134:135], v[134:135], s[50:51], v[32:33]
  v_pk_fma_f32 v[136:137], v[136:137], s[50:51], v[32:33]
  v_pk_fma_f32 v[138:139], v[138:139], s[50:51], v[32:33]
  v_pk_mul_f32 v[132:133], v[132:133], v[56:57]
  v_pk_mul_f32 v[134:135], v[134:135], v[58:59]
  v_pk_mul_f32 v[136:137], v[136:137], v[60:61]
  v_pk_mul_f32 v[138:139], v[138:139], v[62:63]
  v_exp_f32 v132, v132
  v_exp_f32 v133, v133
  v_exp_f32 v134, v134
  v_exp_f32 v135, v135
  v_exp_f32 v136, v136
  v_exp_f32 v137, v137
  v_exp_f32 v138, v138
  v_exp_f32 v139, v139
  v_pk_add_f32 v[132:133], v[132:133], s[52:53]
  v_pk_add_f32 v[134:135], v[134:135], s[52:53]
  v_pk_add_f32 v[136:137], v[136:137], s[52:53]
  v_pk_add_f32 v[138:139], v[138:139], s[52:53]
  v_rcp_f32 v132, v132
  v_rcp_f32 v133, v133
  v_rcp_f32 v134, v134
  v_rcp_f32 v135, v135
  v_rcp_f32 v136, v136
  v_rcp_f32 v137, v137
  v_rcp_f32 v138, v138
  v_rcp_f32 v139, v139
  s_nop 0
  v_pk_mul_f32 v[132:133], v[132:133], v[56:57]
  v_pk_mul_f32 v[134:135], v[134:135], v[58:59]
  v_pk_mul_f32 v[136:137], v[136:137], v[60:61]
  v_pk_mul_f32 v[138:139], v[138:139], v[62:63]
  v_cvt_pk_bf16_f32 v140, v132, v133
  v_cvt_pk_bf16_f32 v141, v134, v135
  v_cvt_pk_bf16_f32 v142, v136, v137
  v_cvt_pk_bf16_f32 v143, v138, v139
  s_nop 1
  v_permlane16_swap_b32 v140, v142
  v_permlane16_swap_b32 v141, v143
  s_nop 0
  buffer_store_dwordx4 v[140:143], v29, s[20:23], s46 offen offset:1024
  v_lshlrev_b32 v128, 16, v110
  v_and_b32 v129, 0xffff0000, v110
  v_lshlrev_b32 v130, 16, v111
  v_and_b32 v131, 0xffff0000, v111
  v_pk_fma_f32 v[144:145], v[168:169], v[122:123], v[128:129] op_sel_hi:[1,0,1]
  v_pk_fma_f32 v[146:147], v[170:171], v[122:123], v[130:131] op_sel_hi:[1,0,1]
  v_pk_fma_f32 v[148:149], v[168:169], v[122:123], v[128:129] op_sel:[0,1,0] op_sel_hi:[1,1,1]
  v_pk_fma_f32 v[150:151], v[170:171], v[122:123], v[130:131] op_sel:[0,1,0] op_sel_hi:[1,1,1]
  v_pk_fma_f32 v[64:65], v[64:65], v[36:37], v[144:145] op_sel_hi:[1,0,1]
  v_pk_fma_f32 v[66:67], v[66:67], v[36:37], v[146:147] op_sel_hi:[1,0,1]
  v_pk_fma_f32 v[68:69], v[68:69], v[36:37], v[148:149] op_sel:[0,1,0] op_sel_hi:[1,1,1]
  v_pk_fma_f32 v[70:71], v[70:71], v[36:37], v[150:151] op_sel:[0,1,0] op_sel_hi:[1,1,1]
  v_pk_mul_f32 v[144:145], v[64:65], v[64:65]
  v_pk_mul_f32 v[146:147], v[66:67], v[66:67]
  v_pk_mul_f32 v[148:149], v[68:69], v[68:69]
  v_pk_mul_f32 v[150:151], v[70:71], v[70:71]
  v_pk_fma_f32 v[144:145], v[144:145], s[50:51], v[32:33]
  v_pk_fma_f32 v[146:147], v[146:147], s[50:51], v[32:33]
  v_pk_fma_f32 v[148:149], v[148:149], s[50:51], v[32:33]
  v_pk_fma_f32 v[150:151], v[150:151], s[50:51], v[32:33]
  v_pk_mul_f32 v[144:145], v[144:145], v[64:65]
  v_pk_mul_f32 v[146:147], v[146:147], v[66:67]
  v_pk_mul_f32 v[148:149], v[148:149], v[68:69]
  v_pk_mul_f32 v[150:151], v[150:151], v[70:71]
  v_exp_f32 v144, v144
  v_exp_f32 v145, v145
  v_exp_f32 v146, v146
  v_exp_f32 v147, v147
  v_exp_f32 v148, v148
  v_exp_f32 v149, v149
  v_exp_f32 v150, v150
  v_exp_f32 v151, v151
  v_pk_add_f32 v[144:145], v[144:145], s[52:53]
  v_pk_add_f32 v[146:147], v[146:147], s[52:53]
  v_pk_add_f32 v[148:149], v[148:149], s[52:53]
  v_pk_add_f32 v[150:151], v[150:151], s[52:53]
  v_rcp_f32 v144, v144
  v_rcp_f32 v145, v145
  v_rcp_f32 v146, v146
  v_rcp_f32 v147, v147
  v_rcp_f32 v148, v148
  v_rcp_f32 v149, v149
  v_rcp_f32 v150, v150
  v_rcp_f32 v151, v151
  s_nop 0
  v_pk_mul_f32 v[144:145], v[144:145], v[64:65]
  v_pk_mul_f32 v[146:147], v[146:147], v[66:67]
  v_pk_mul_f32 v[148:149], v[148:149], v[68:69]
  v_pk_mul_f32 v[150:151], v[150:151], v[70:71]
  v_cvt_pk_bf16_f32 v152, v144, v145
  v_cvt_pk_bf16_f32 v153, v146, v147
  v_cvt_pk_bf16_f32 v154, v148, v149
  v_cvt_pk_bf16_f32 v155, v150, v151
  s_nop 1
  v_permlane16_swap_b32 v152, v154
  v_permlane16_swap_b32 v153, v155
  s_nop 0
  buffer_store_dwordx4 v[152:155], v29, s[20:23], s46 offen offset:1536
  v_lshlrev_b32 v124, 16, v112
  v_and_b32 v125, 0xffff0000, v112
  v_lshlrev_b32 v126, 16, v113
  v_and_b32 v127, 0xffff0000, v113
  v_pk_fma_f32 v[132:133], v[172:173], v[122:123], v[124:125] op_sel_hi:[1,0,1]
  v_pk_fma_f32 v[134:135], v[174:175], v[122:123], v[126:127] op_sel_hi:[1,0,1]
  v_pk_fma_f32 v[136:137], v[172:173], v[122:123], v[124:125] op_sel:[0,1,0] op_sel_hi:[1,1,1]
  v_pk_fma_f32 v[138:139], v[174:175], v[122:123], v[126:127] op_sel:[0,1,0] op_sel_hi:[1,1,1]
  v_pk_fma_f32 v[72:73], v[72:73], v[36:37], v[132:133] op_sel_hi:[1,0,1]
  v_pk_fma_f32 v[74:75], v[74:75], v[36:37], v[134:135] op_sel_hi:[1,0,1]
  v_pk_fma_f32 v[76:77], v[76:77], v[36:37], v[136:137] op_sel:[0,1,0] op_sel_hi:[1,1,1]
  v_pk_fma_f32 v[78:79], v[78:79], v[36:37], v[138:139] op_sel:[0,1,0] op_sel_hi:[1,1,1]
  v_pk_mul_f32 v[132:133], v[72:73], v[72:73]
  v_pk_mul_f32 v[134:135], v[74:75], v[74:75]
  v_pk_mul_f32 v[136:137], v[76:77], v[76:77]
  v_pk_mul_f32 v[138:139], v[78:79], v[78:79]
  v_pk_fma_f32 v[132:133], v[132:133], s[50:51], v[32:33]
  v_pk_fma_f32 v[134:135], v[134:135], s[50:51], v[32:33]
  v_pk_fma_f32 v[136:137], v[136:137], s[50:51], v[32:33]
  v_pk_fma_f32 v[138:139], v[138:139], s[50:51], v[32:33]
  v_pk_mul_f32 v[132:133], v[132:133], v[72:73]
  v_pk_mul_f32 v[134:135], v[134:135], v[74:75]
  v_pk_mul_f32 v[136:137], v[136:137], v[76:77]
  v_pk_mul_f32 v[138:139], v[138:139], v[78:79]
  v_exp_f32 v132, v132
  v_exp_f32 v133, v133
  v_exp_f32 v134, v134
  v_exp_f32 v135, v135
  v_exp_f32 v136, v136
  v_exp_f32 v137, v137
  v_exp_f32 v138, v138
  v_exp_f32 v139, v139
  v_pk_add_f32 v[132:133], v[132:133], s[52:53]
  v_pk_add_f32 v[134:135], v[134:135], s[52:53]
  v_pk_add_f32 v[136:137], v[136:137], s[52:53]
  v_pk_add_f32 v[138:139], v[138:139], s[52:53]
  v_rcp_f32 v132, v132
  v_rcp_f32 v133, v133
  v_rcp_f32 v134, v134
  v_rcp_f32 v135, v135
  v_rcp_f32 v136, v136
  v_rcp_f32 v137, v137
  v_rcp_f32 v138, v138
  v_rcp_f32 v139, v139
  s_nop 0
  v_pk_mul_f32 v[132:133], v[132:133], v[72:73]
  v_pk_mul_f32 v[134:135], v[134:135], v[74:75]
  v_pk_mul_f32 v[136:137], v[136:137], v[76:77]
  v_pk_mul_f32 v[138:139], v[138:139], v[78:79]
  v_cvt_pk_bf16_f32 v140, v132, v133
  v_cvt_pk_bf16_f32 v141, v134, v135
  v_cvt_pk_bf16_f32 v142, v136, v137
  v_cvt_pk_bf16_f32 v143, v138, v139
  s_nop 1
  v_permlane16_swap_b32 v140, v142
  v_permlane16_swap_b32 v141, v143
  s_nop 0
  buffer_store_dwordx4 v[140:143], v29, s[20:23], s46 offen offset:2048
  v_lshlrev_b32 v128, 16, v114
  v_and_b32 v129, 0xffff0000, v114
  v_lshlrev_b32 v130, 16, v115
  v_and_b32 v131, 0xffff0000, v115
  v_pk_fma_f32 v[144:145], v[176:177], v[122:123], v[128:129] op_sel_hi:[1,0,1]
  v_pk_fma_f32 v[146:147], v[178:179], v[122:123], v[130:131] op_sel_hi:[1,0,1]
  v_pk_fma_f32 v[148:149], v[176:177], v[122:123], v[128:129] op_sel:[0,1,0] op_sel_hi:[1,1,1]
  v_pk_fma_f32 v[150:151], v[178:179], v[122:123], v[130:131] op_sel:[0,1,0] op_sel_hi:[1,1,1]
  v_pk_fma_f32 v[80:81], v[80:81], v[36:37], v[144:145] op_sel_hi:[1,0,1]
  v_pk_fma_f32 v[82:83], v[82:83], v[36:37], v[146:147] op_sel_hi:[1,0,1]
  v_pk_fma_f32 v[84:85], v[84:85], v[36:37], v[148:149] op_sel:[0,1,0] op_sel_hi:[1,1,1]
  v_pk_fma_f32 v[86:87], v[86:87], v[36:37], v[150:151] op_sel:[0,1,0] op_sel_hi:[1,1,1]
  v_pk_mul_f32 v[144:145], v[80:81], v[80:81]
  v_pk_mul_f32 v[146:147], v[82:83], v[82:83]
  v_pk_mul_f32 v[148:149], v[84:85], v[84:85]
  v_pk_mul_f32 v[150:151], v[86:87], v[86:87]
  v_pk_fma_f32 v[144:145], v[144:145], s[50:51], v[32:33]
  v_pk_fma_f32 v[146:147], v[146:147], s[50:51], v[32:33]
  v_pk_fma_f32 v[148:149], v[148:149], s[50:51], v[32:33]
  v_pk_fma_f32 v[150:151], v[150:151], s[50:51], v[32:33]
  v_pk_mul_f32 v[144:145], v[144:145], v[80:81]
  v_pk_mul_f32 v[146:147], v[146:147], v[82:83]
  v_pk_mul_f32 v[148:149], v[148:149], v[84:85]
  v_pk_mul_f32 v[150:151], v[150:151], v[86:87]
  v_exp_f32 v144, v144
  v_exp_f32 v145, v145
  v_exp_f32 v146, v146
  v_exp_f32 v147, v147
  v_exp_f32 v148, v148
  v_exp_f32 v149, v149
  v_exp_f32 v150, v150
  v_exp_f32 v151, v151
  v_pk_add_f32 v[144:145], v[144:145], s[52:53]
  v_pk_add_f32 v[146:147], v[146:147], s[52:53]
  v_pk_add_f32 v[148:149], v[148:149], s[52:53]
  v_pk_add_f32 v[150:151], v[150:151], s[52:53]
  v_rcp_f32 v144, v144
  v_rcp_f32 v145, v145
  v_rcp_f32 v146, v146
  v_rcp_f32 v147, v147
  v_rcp_f32 v148, v148
  v_rcp_f32 v149, v149
  v_rcp_f32 v150, v150
  v_rcp_f32 v151, v151
  s_nop 0
  v_pk_mul_f32 v[144:145], v[144:145], v[80:81]
  v_pk_mul_f32 v[146:147], v[146:147], v[82:83]
  v_pk_mul_f32 v[148:149], v[148:149], v[84:85]
  v_pk_mul_f32 v[150:151], v[150:151], v[86:87]
  v_cvt_pk_bf16_f32 v152, v144, v145
  v_cvt_pk_bf16_f32 v153, v146, v147
  v_cvt_pk_bf16_f32 v154, v148, v149
  v_cvt_pk_bf16_f32 v155, v150, v151
  s_nop 1
  v_permlane16_swap_b32 v152, v154
  v_permlane16_swap_b32 v153, v155
  s_nop 0
  buffer_store_dwordx4 v[152:155], v29, s[20:23], s46 offen offset:2560
  v_lshlrev_b32 v124, 16, v116
  v_and_b32 v125, 0xffff0000, v116
  v_lshlrev_b32 v126, 16, v117
  v_and_b32 v127, 0xffff0000, v117
  v_pk_fma_f32 v[132:133], v[180:181], v[122:123], v[124:125] op_sel_hi:[1,0,1]
  v_pk_fma_f32 v[134:135], v[182:183], v[122:123], v[126:127] op_sel_hi:[1,0,1]
  v_pk_fma_f32 v[136:137], v[180:181], v[122:123], v[124:125] op_sel:[0,1,0] op_sel_hi:[1,1,1]
  v_pk_fma_f32 v[138:139], v[182:183], v[122:123], v[126:127] op_sel:[0,1,0] op_sel_hi:[1,1,1]
  v_pk_fma_f32 v[88:89], v[88:89], v[36:37], v[132:133] op_sel_hi:[1,0,1]
  v_pk_fma_f32 v[90:91], v[90:91], v[36:37], v[134:135] op_sel_hi:[1,0,1]
  v_pk_fma_f32 v[92:93], v[92:93], v[36:37], v[136:137] op_sel:[0,1,0] op_sel_hi:[1,1,1]
  v_pk_fma_f32 v[94:95], v[94:95], v[36:37], v[138:139] op_sel:[0,1,0] op_sel_hi:[1,1,1]
  v_pk_mul_f32 v[132:133], v[88:89], v[88:89]
  v_pk_mul_f32 v[134:135], v[90:91], v[90:91]
  v_pk_mul_f32 v[136:137], v[92:93], v[92:93]
  v_pk_mul_f32 v[138:139], v[94:95], v[94:95]
  v_pk_fma_f32 v[132:133], v[132:133], s[50:51], v[32:33]
  v_pk_fma_f32 v[134:135], v[134:135], s[50:51], v[32:33]
  v_pk_fma_f32 v[136:137], v[136:137], s[50:51], v[32:33]
  v_pk_fma_f32 v[138:139], v[138:139], s[50:51], v[32:33]
  v_pk_mul_f32 v[132:133], v[132:133], v[88:89]
  v_pk_mul_f32 v[134:135], v[134:135], v[90:91]
  v_pk_mul_f32 v[136:137], v[136:137], v[92:93]
  v_pk_mul_f32 v[138:139], v[138:139], v[94:95]
  v_exp_f32 v132, v132
  v_exp_f32 v133, v133
  v_exp_f32 v134, v134
  v_exp_f32 v135, v135
  v_exp_f32 v136, v136
  v_exp_f32 v137, v137
  v_exp_f32 v138, v138
  v_exp_f32 v139, v139
  v_pk_add_f32 v[132:133], v[132:133], s[52:53]
  v_pk_add_f32 v[134:135], v[134:135], s[52:53]
  v_pk_add_f32 v[136:137], v[136:137], s[52:53]
  v_pk_add_f32 v[138:139], v[138:139], s[52:53]
  v_rcp_f32 v132, v132
  v_rcp_f32 v133, v133
  v_rcp_f32 v134, v134
  v_rcp_f32 v135, v135
  v_rcp_f32 v136, v136
  v_rcp_f32 v137, v137
  v_rcp_f32 v138, v138
  v_rcp_f32 v139, v139
  s_nop 0
  v_pk_mul_f32 v[132:133], v[132:133], v[88:89]
  v_pk_mul_f32 v[134:135], v[134:135], v[90:91]
  v_pk_mul_f32 v[136:137], v[136:137], v[92:93]
  v_pk_mul_f32 v[138:139], v[138:139], v[94:95]
  v_cvt_pk_bf16_f32 v140, v132, v133
  v_cvt_pk_bf16_f32 v141, v134, v135
  v_cvt_pk_bf16_f32 v142, v136, v137
  v_cvt_pk_bf16_f32 v143, v138, v139
  s_nop 1
  v_permlane16_swap_b32 v140, v142
  v_permlane16_swap_b32 v141, v143
  s_nop 0
  buffer_store_dwordx4 v[140:143], v29, s[20:23], s46 offen offset:3072
  s_lshl_b32 s47, s16, 2
  s_add_u32 s47, s47, 3
  s_waitcnt vmcnt(0)
  v_mov_b32 v30, s47
  s_mov_b64 exec, 1
  s_cmp_lg_u32 s17, 0
  s_cbranch_scc1 g3_pub_fast
  buffer_wbl2 sc1
  s_waitcnt vmcnt(0)
  buffer_store_dword v30, v21, s[20:23], s61 offen sc0 sc1
  s_branch g3_pub_done
g3_pub_fast:
  buffer_store_dword v30, v21, s[20:23], s61 offen
g3_pub_done:
  s_mov_b64 exec, -1
  s_barrier
  s_mul_i32 s44, s16, 0
  s_add_u32 s44, s44, 13631488
  s_lshl_b32 s46, s40, 3
  s_lshr_b32 s47, s41, 3
  s_lshl_b32 s47, s47, 2
  s_add_u32 s46, s46, s47
  s_xor_b32 s47, s18, 0
  s_add_u32 s47, s47, s46
  s_mul_i32 s47, s47, 57344
  s_add_u32 s54, s44, s47
  s_xor_b32 s47, s18, 1
  s_add_u32 s47, s47, s46
  s_mul_i32 s47, s47, 57344
  s_add_u32 s55, s44, s47
  s_lshl_b32 s57, s16, 2
  s_add_u32 s57, s57, 3
  s_cmp_eq_u32 s57, 0
  s_cbranch_scc1 c_g4_ok2
  s_cmp_lg_u32 s18, 0
  s_cbranch_scc1 c_g4_ok2
  s_mov_b32 s58, 0
  v_mov_b32 v32, 0
c_g4_poll:
  buffer_load_dword v32, v0, s[20:23], s56 offen sc1
  s_waitcnt vmcnt(8)
  v_cmp_le_u32 vcc, s57, v32
  s_add_u32 s58, s58, 1
  s_cmp_eq_u64 vcc, -1
  s_cbranch_scc1 c_g4_ok
  s_cmp_lg_u32 s19, 0
  s_cbranch_scc1 c_g4_ok
  s_cmp_lt_u32 s58, 1048576
  s_cbranch_scc1 c_g4_poll
  s_mov_b32 s19, 1
c_g4_ok:
  s_cmp_lg_u32 s17, 0
  s_cbranch_scc1 c_g4_ok2
  s_waitcnt vmcnt(0)
  buffer_inv sc1
  s_waitcnt vmcnt(0)
c_g4_ok2:
  s_barrier
  buffer_load_dwordx4 v[80:83], v9, s[20:23], s54 offen offset:0 sc1
  buffer_load_dwordx4 v[84:87], v9, s[20:23], s55 offen offset:0 sc1
  buffer_load_dwordx4 v[88:91], v9, s[20:23], s54 offen offset:2048 sc1
  buffer_load_dwordx4 v[92:95], v9, s[20:23], s55 offen offset:2048 sc1
  s_add_u32 s54, s54, 4096
  s_add_u32 s55, s55, 4096
  buffer_load_dwordx4 v[96:99], v9, s[20:23], s54 offen offset:0 sc1
  buffer_load_dwordx4 v[100:103], v9, s[20:23], s55 offen offset:0 sc1
  buffer_load_dwordx4 v[104:107], v9, s[20:23], s54 offen offset:2048 sc1
  buffer_load_dwordx4 v[108:111], v9, s[20:23], s55 offen offset:2048 sc1
  ds_read_b128 a[0:3], v35 offset:0
  ds_read_b128 a[4:7], v35 offset:1024
  ds_read_b128 a[8:11], v35 offset:2048
  ds_read_b128 a[12:15], v35 offset:3072
  ds_read_b128 a[16:19], v35 offset:4096
  v_lshlrev_b32 v30, 3, v4
  s_and_b32 s46, s41, 7
  s_mul_i32 s46, s46, 160
  buffer_load_dwordx2 v[120:121], v30, s[28:31], s46 offen offset:0
  buffer_load_dwordx2 v[122:123], v30, s[28:31], s46 offen offset:32
  buffer_load_dwordx2 v[124:125], v30, s[28:31], s46 offen offset:64
  buffer_load_dwordx2 v[126:127], v30, s[28:31], s46 offen offset:96
  buffer_load_dwordx2 v[128:129], v30, s[28:31], s46 offen offset:128
  s_waitcnt vmcnt(12) lgkmcnt(4)
  v_mfma_f32_16x16x32_bf16 v[40:43], a[0:3], v[80:83], 0
  s_barrier
  ds_read_b128 a[20:23], v35 offset:10240
  s_waitcnt vmcnt(11)
  v_mfma_f32_16x16x32_bf16 v[44:47], a[0:3], v[84:87], 0
  ds_read_b128 a[24:27], v35 offset:11264
  s_waitcnt lgkmcnt(5)
  v_mfma_f32_16x16x32_bf16 v[48:51], a[4:7], v[80:83], 0
  ds_read_b128 a[28:31], v35 offset:12288
  v_mfma_f32_16x16x32_bf16 v[52:55], a[4:7], v[84:87], 0
  ds_read_b128 a[32:35], v35 offset:13312
  s_waitcnt lgkmcnt(6)
  v_mfma_f32_16x16x32_bf16 v[56:59], a[8:11], v[80:83], 0
  ds_read_b128 a[36:39], v35 offset:14336
  v_mfma_f32_16x16x32_bf16 v[60:63], a[8:11], v[84:87], 0
  s_waitcnt lgkmcnt(6)
  v_mfma_f32_16x16x32_bf16 v[64:67], a[12:15], v[80:83], 0
  s_add_u32 s54, s54, 4096
  s_add_u32 s55, s55, 4096
  buffer_load_dwordx4 v[112:115], v9, s[20:23], s54 offen offset:0 sc1
  v_mfma_f32_16x16x32_bf16 v[68:71], a[12:15], v[84:87], 0
  s_waitcnt lgkmcnt(5)
  v_mfma_f32_16x16x32_bf16 v[72:75], a[16:19], v[80:83], 0
  buffer_load_dwordx4 v[116:119], v9, s[20:23], s55 offen offset:0 sc1
  v_mfma_f32_16x16x32_bf16 v[76:79], a[16:19], v[84:87], 0
  s_waitcnt vmcnt(12) lgkmcnt(4)
  v_mfma_f32_16x16x32_bf16 v[40:43], a[20:23], v[88:91], v[40:43]
  s_barrier
  ds_read_b128 a[0:3], v35 offset:20480
  s_waitcnt vmcnt(11)
  v_mfma_f32_16x16x32_bf16 v[44:47], a[20:23], v[92:95], v[44:47]
  ds_read_b128 a[4:7], v35 offset:21504
  s_waitcnt lgkmcnt(5)
  v_mfma_f32_16x16x32_bf16 v[48:51], a[24:27], v[88:91], v[48:51]
  ds_read_b128 a[8:11], v35 offset:22528
  v_mfma_f32_16x16x32_bf16 v[52:55], a[24:27], v[92:95], v[52:55]
  ds_read_b128 a[12:15], v35 offset:23552
  s_waitcnt lgkmcnt(6)
  v_mfma_f32_16x16x32_bf16 v[56:59], a[28:31], v[88:91], v[56:59]
  ds_read_b128 a[16:19], v35 offset:24576
  v_mfma_f32_16x16x32_bf16 v[60:63], a[28:31], v[92:95], v[60:63]
  s_waitcnt lgkmcnt(6)
  v_mfma_f32_16x16x32_bf16 v[64:67], a[32:35], v[88:91], v[64:67]
  buffer_load_dwordx4 v[132:135], v9, s[20:23], s54 offen offset:2048 sc1
  v_mfma_f32_16x16x32_bf16 v[68:71], a[32:35], v[92:95], v[68:71]
  s_waitcnt lgkmcnt(5)
  v_mfma_f32_16x16x32_bf16 v[72:75], a[36:39], v[88:91], v[72:75]
  buffer_load_dwordx4 v[136:139], v9, s[20:23], s55 offen offset:2048 sc1
  v_mfma_f32_16x16x32_bf16 v[76:79], a[36:39], v[92:95], v[76:79]
  s_waitcnt vmcnt(12) lgkmcnt(4)
  v_mfma_f32_16x16x32_bf16 v[40:43], a[0:3], v[96:99], v[40:43]
  s_barrier
  ds_read_b128 a[20:23], v35 offset:30720
  s_waitcnt vmcnt(11)
  v_mfma_f32_16x16x32_bf16 v[44:47], a[0:3], v[100:103], v[44:47]
  ds_read_b128 a[24:27], v35 offset:31744
  s_waitcnt lgkmcnt(5)
  v_mfma_f32_16x16x32_bf16 v[48:51], a[4:7], v[96:99], v[48:51]
  ds_read_b128 a[28:31], v35 offset:32768
  v_mfma_f32_16x16x32_bf16 v[52:55], a[4:7], v[100:103], v[52:55]
  ds_read_b128 a[32:35], v35 offset:33792
  s_waitcnt lgkmcnt(6)
  v_mfma_f32_16x16x32_bf16 v[56:59], a[8:11], v[96:99], v[56:59]
  ds_read_b128 a[36:39], v35 offset:34816
  v_mfma_f32_16x16x32_bf16 v[60:63], a[8:11], v[100:103], v[60:63]
  s_waitcnt lgkmcnt(6)
  v_mfma_f32_16x16x32_bf16 v[64:67], a[12:15], v[96:99], v[64:67]
  s_add_u32 s54, s54, 4096
  s_add_u32 s55, s55, 4096
  buffer_load_dwordx4 v[140:143], v9, s[20:23], s54 offen offset:0 sc1
  v_mfma_f32_16x16x32_bf16 v[68:71], a[12:15], v[100:103], v[68:71]
  s_waitcnt lgkmcnt(5)
  v_mfma_f32_16x16x32_bf16 v[72:75], a[16:19], v[96:99], v[72:75]
  buffer_load_dwordx4 v[144:147], v9, s[20:23], s55 offen offset:0 sc1
  v_mfma_f32_16x16x32_bf16 v[76:79], a[16:19], v[100:103], v[76:79]
  s_waitcnt vmcnt(12) lgkmcnt(4)
  v_mfma_f32_16x16x32_bf16 v[40:43], a[20:23], v[104:107], v[40:43]
  s_barrier
  ds_read_b128 a[0:3], v35 offset:40960
  s_waitcnt vmcnt(11)
  v_mfma_f32_16x16x32_bf16 v[44:47], a[20:23], v[108:111], v[44:47]
  ds_read_b128 a[4:7], v35 offset:41984
  s_waitcnt lgkmcnt(5)
  v_mfma_f32_16x16x32_bf16 v[48:51], a[24:27], v[104:107], v[48:51]
  ds_read_b128 a[8:11], v35 offset:43008
  v_mfma_f32_16x16x32_bf16 v[52:55], a[24:27], v[108:111], v[52:55]
  ds_read_b128 a[12:15], v2 offset:0
  s_waitcnt lgkmcnt(6)
  v_mfma_f32_16x16x32_bf16 v[56:59], a[28:31], v[104:107], v[56:59]
  ds_read_b128 a[16:19], v2 offset:1024
  v_mfma_f32_16x16x32_bf16 v[60:63], a[28:31], v[108:111], v[60:63]
  s_waitcnt lgkmcnt(6)
  v_mfma_f32_16x16x32_bf16 v[64:67], a[32:35], v[104:107], v[64:67]
  buffer_load_dwordx4 v[148:151], v9, s[20:23], s54 offen offset:2048 sc1
  v_mfma_f32_16x16x32_bf16 v[68:71], a[32:35], v[108:111], v[68:71]
  s_waitcnt lgkmcnt(5)
  v_mfma_f32_16x16x32_bf16 v[72:75], a[36:39], v[104:107], v[72:75]
  buffer_load_dwordx4 v[152:155], v9, s[20:23], s55 offen offset:2048 sc1
  v_mfma_f32_16x16x32_bf16 v[76:79], a[36:39], v[108:111], v[76:79]
  s_waitcnt vmcnt(7) lgkmcnt(4)
  v_mfma_f32_16x16x32_bf16 v[40:43], a[0:3], v[112:115], v[40:43]
  s_barrier
  ds_read_b128 a[20:23], v34 offset:2048
  s_waitcnt vmcnt(6)
  v_mfma_f32_16x16x32_bf16 v[44:47], a[0:3], v[116:119], v[44:47]
  ds_read_b128 a[24:27], v34 offset:3072
  s_waitcnt lgkmcnt(5)
  v_mfma_f32_16x16x32_bf16 v[48:51], a[4:7], v[112:115], v[48:51]
  ds_read_b128 a[28:31], v34 offset:4096
  v_mfma_f32_16x16x32_bf16 v[52:55], a[4:7], v[116:119], v[52:55]
  ds_read_b128 a[32:35], v34 offset:5120
  s_waitcnt lgkmcnt(6)
  v_mfma_f32_16x16x32_bf16 v[56:59], a[8:11], v[112:115], v[56:59]
  ds_read_b128 a[36:39], v34 offset:6144
  v_mfma_f32_16x16x32_bf16 v[60:63], a[8:11], v[116:119], v[60:63]
  s_waitcnt lgkmcnt(6)
  v_mfma_f32_16x16x32_bf16 v[64:67], a[12:15], v[112:115], v[64:67]
  s_add_u32 s54, s54, 4096
  s_add_u32 s55, s55, 4096
  buffer_load_dwordx4 v[156:159], v9, s[20:23], s54 offen offset:0 sc1
  v_mfma_f32_16x16x32_bf16 v[68:71], a[12:15], v[116:119], v[68:71]
  s_waitcnt lgkmcnt(5)
  v_mfma_f32_16x16x32_bf16 v[72:75], a[16:19], v[112:115], v[72:75]
  buffer_load_dwordx4 v[160:163], v9, s[20:23], s55 offen offset:0 sc1
  v_mfma_f32_16x16x32_bf16 v[76:79], a[16:19], v[116:119], v[76:79]
  s_waitcnt vmcnt(7) lgkmcnt(4)
  v_mfma_f32_16x16x32_bf16 v[40:43], a[20:23], v[132:135], v[40:43]
  s_barrier
  ds_read_b128 a[0:3], v34 offset:12288
  s_waitcnt vmcnt(6)
  v_mfma_f32_16x16x32_bf16 v[44:47], a[20:23], v[136:139], v[44:47]
  ds_read_b128 a[4:7], v34 offset:13312
  s_waitcnt lgkmcnt(5)
  v_mfma_f32_16x16x32_bf16 v[48:51], a[24:27], v[132:135], v[48:51]
  ds_read_b128 a[8:11], v34 offset:14336
  v_mfma_f32_16x16x32_bf16 v[52:55], a[24:27], v[136:139], v[52:55]
  ds_read_b128 a[12:15], v34 offset:15360
  s_waitcnt lgkmcnt(6)
  v_mfma_f32_16x16x32_bf16 v[56:59], a[28:31], v[132:135], v[56:59]
  ds_read_b128 a[16:19], v34 offset:16384
  v_mfma_f32_16x16x32_bf16 v[60:63], a[28:31], v[136:139], v[60:63]
  s_waitcnt lgkmcnt(6)
  v_mfma_f32_16x16x32_bf16 v[64:67], a[32:35], v[132:135], v[64:67]
  buffer_load_dwordx4 v[164:167], v9, s[20:23], s54 offen offset:2048 sc1
  v_mfma_f32_16x16x32_bf16 v[68:71], a[32:35], v[136:139], v[68:71]
  s_waitcnt lgkmcnt(5)
  v_mfma_f32_16x16x32_bf16 v[72:75], a[36:39], v[132:135], v[72:75]
  buffer_load_dwordx4 v[168:171], v9, s[20:23], s55 offen offset:2048 sc1
  v_mfma_f32_16x16x32_bf16 v[76:79], a[36:39], v[136:139], v[76:79]
  s_waitcnt vmcnt(7) lgkmcnt(4)
  v_mfma_f32_16x16x32_bf16 v[40:43], a[0:3], v[140:143], v[40:43]
  s_barrier
  ds_read_b128 a[20:23], v34 offset:22528
  s_waitcnt vmcnt(6)
  v_mfma_f32_16x16x32_bf16 v[44:47], a[0:3], v[144:147], v[44:47]
  ds_read_b128 a[24:27], v34 offset:23552
  s_waitcnt lgkmcnt(5)
  v_mfma_f32_16x16x32_bf16 v[48:51], a[4:7], v[140:143], v[48:51]
  ds_read_b128 a[28:31], v34 offset:24576
  v_mfma_f32_16x16x32_bf16 v[52:55], a[4:7], v[144:147], v[52:55]
  ds_read_b128 a[32:35], v34 offset:25600
  s_waitcnt lgkmcnt(6)
  v_mfma_f32_16x16x32_bf16 v[56:59], a[8:11], v[140:143], v[56:59]
  ds_read_b128 a[36:39], v34 offset:26624
  v_mfma_f32_16x16x32_bf16 v[60:63], a[8:11], v[144:147], v[60:63]
  s_waitcnt lgkmcnt(6)
  v_mfma_f32_16x16x32_bf16 v[64:67], a[12:15], v[140:143], v[64:67]
  s_add_u32 s54, s54, 4096
  s_add_u32 s55, s55, 4096
  buffer_load_dwordx4 v[172:175], v9, s[20:23], s54 offen offset:0 sc1
  v_mfma_f32_16x16x32_bf16 v[68:71], a[12:15], v[144:147], v[68:71]
  s_waitcnt lgkmcnt(5)
  v_mfma_f32_16x16x32_bf16 v[72:75], a[16:19], v[140:143], v[72:75]
  buffer_load_dwordx4 v[176:179], v9, s[20:23], s55 offen offset:0 sc1
  v_mfma_f32_16x16x32_bf16 v[76:79], a[16:19], v[144:147], v[76:79]
  s_waitcnt vmcnt(7) lgkmcnt(4)
  v_mfma_f32_16x16x32_bf16 v[40:43], a[20:23], v[148:151], v[40:43]
  s_barrier
  ds_read_b128 a[0:3], v34 offset:32768
  s_waitcnt vmcnt(6)
  v_mfma_f32_16x16x32_bf16 v[44:47], a[20:23], v[152:155], v[44:47]
  ds_read_b128 a[4:7], v34 offset:33792
  s_waitcnt lgkmcnt(5)
  v_mfma_f32_16x16x32_bf16 v[48:51], a[24:27], v[148:151], v[48:51]
  ds_read_b128 a[8:11], v34 offset:34816
  v_mfma_f32_16x16x32_bf16 v[52:55], a[24:27], v[152:155], v[52:55]
  ds_read_b128 a[12:15], v34 offset:35840
  s_waitcnt lgkmcnt(6)
  v_mfma_f32_16x16x32_bf16 v[56:59], a[28:31], v[148:151], v[56:59]
  ds_read_b128 a[16:19], v34 offset:36864
  v_mfma_f32_16x16x32_bf16 v[60:63], a[28:31], v[152:155], v[60:63]
  s_waitcnt lgkmcnt(6)
  v_mfma_f32_16x16x32_bf16 v[64:67], a[32:35], v[148:151], v[64:67]
  buffer_load_dwordx4 v[180:183], v9, s[20:23], s54 offen offset:2048 sc1
  v_mfma_f32_16x16x32_bf16 v[68:71], a[32:35], v[152:155], v[68:71]
  s_waitcnt lgkmcnt(5)
  v_mfma_f32_16x16x32_bf16 v[72:75], a[36:39], v[148:151], v[72:75]
  buffer_load_dwordx4 a[40:43], v9, s[20:23], s55 offen offset:2048 sc1
  v_mfma_f32_16x16x32_bf16 v[76:79], a[36:39], v[152:155], v[76:79]
  s_waitcnt vmcnt(7) lgkmcnt(4)
  v_mfma_f32_16x16x32_bf16 v[40:43], a[0:3], v[156:159], v[40:43]
  s_barrier
  ds_read_b128 a[20:23], v34 offset:43008
  s_waitcnt vmcnt(6)
  v_mfma_f32_16x16x32_bf16 v[44:47], a[0:3], v[160:163], v[44:47]
  ds_read_b128 a[24:27], v34 offset:44032
  s_waitcnt lgkmcnt(5)
  v_mfma_f32_16x16x32_bf16 v[48:51], a[4:7], v[156:159], v[48:51]
  ds_read_b128 a[28:31], v34 offset:45056
  v_mfma_f32_16x16x32_bf16 v[52:55], a[4:7], v[160:163], v[52:55]
  ds_read_b128 a[32:35], v34 offset:46080
  s_waitcnt lgkmcnt(6)
  v_mfma_f32_16x16x32_bf16 v[56:59], a[8:11], v[156:159], v[56:59]
  ds_read_b128 a[36:39], v34 offset:47104
  v_mfma_f32_16x16x32_bf16 v[60:63], a[8:11], v[160:163], v[60:63]
  s_waitcnt lgkmcnt(6)
  v_mfma_f32_16x16x32_bf16 v[64:67], a[12:15], v[156:159], v[64:67]
  s_add_u32 s54, s54, 4096
  s_add_u32 s55, s55, 4096
  buffer_load_dwordx4 a[44:47], v9, s[20:23], s54 offen offset:0 sc1
  v_mfma_f32_16x16x32_bf16 v[68:71], a[12:15], v[160:163], v[68:71]
  s_waitcnt lgkmcnt(5)
  v_mfma_f32_16x16x32_bf16 v[72:75], a[16:19], v[156:159], v[72:75]
  buffer_load_dwordx4 a[48:51], v9, s[20:23], s55 offen offset:0 sc1
  v_mfma_f32_16x16x32_bf16 v[76:79], a[16:19], v[160:163], v[76:79]
  s_waitcnt vmcnt(7) lgkmcnt(4)
  v_mfma_f32_16x16x32_bf16 v[40:43], a[20:23], v[164:167], v[40:43]
  s_barrier
  ds_read_b128 a[0:3], v34 offset:53248
  s_waitcnt vmcnt(6)
  v_mfma_f32_16x16x32_bf16 v[44:47], a[20:23], v[168:171], v[44:47]
  ds_read_b128 a[4:7], v34 offset:54272
  s_waitcnt lgkmcnt(5)
  v_mfma_f32_16x16x32_bf16 v[48:51], a[24:27], v[164:167], v[48:51]
  ds_read_b128 a[8:11], v34 offset:55296
  v_mfma_f32_16x16x32_bf16 v[52:55], a[24:27], v[168:171], v[52:55]
  ds_read_b128 a[12:15], v34 offset:56320
  s_waitcnt lgkmcnt(6)
  v_mfma_f32_16x16x32_bf16 v[56:59], a[28:31], v[164:167], v[56:59]
  ds_read_b128 a[16:19], v34 offset:57344
  v_mfma_f32_16x16x32_bf16 v[60:63], a[28:31], v[168:171], v[60:63]
  s_waitcnt lgkmcnt(6)
  v_mfma_f32_16x16x32_bf16 v[64:67], a[32:35], v[164:167], v[64:67]
  buffer_load_dwordx4 a[52:55], v9, s[20:23], s54 offen offset:2048 sc1
  v_mfma_f32_16x16x32_bf16 v[68:71], a[32:35], v[168:171], v[68:71]
  s_waitcnt lgkmcnt(5)
  v_mfma_f32_16x16x32_bf16 v[72:75], a[36:39], v[164:167], v[72:75]
  buffer_load_dwordx4 a[56:59], v9, s[20:23], s55 offen offset:2048 sc1
  v_mfma_f32_16x16x32_bf16 v[76:79], a[36:39], v[168:171], v[76:79]
  s_waitcnt vmcnt(7) lgkmcnt(4)
  v_mfma_f32_16x16x32_bf16 v[40:43], a[0:3], v[172:175], v[40:43]
  s_barrier
  ds_read_b128 a[20:23], v34 offset:63488
  s_waitcnt vmcnt(6)
  v_mfma_f32_16x16x32_bf16 v[44:47], a[0:3], v[176:179], v[44:47]
  ds_read_b128 a[24:27], v34 offset:64512
  s_waitcnt lgkmcnt(5)
  v_mfma_f32_16x16x32_bf16 v[48:51], a[4:7], v[172:175], v[48:51]
  ds_read_b128 a[28:31], v35 offset:0
  v_mfma_f32_16x16x32_bf16 v[52:55], a[4:7], v[176:179], v[52:55]
  ds_read_b128 a[32:35], v35 offset:1024
  s_waitcnt lgkmcnt(6)
  v_mfma_f32_16x16x32_bf16 v[56:59], a[8:11], v[172:175], v[56:59]
  ds_read_b128 a[36:39], v35 offset:2048
  v_mfma_f32_16x16x32_bf16 v[60:63], a[8:11], v[176:179], v[60:63]
  s_waitcnt lgkmcnt(6)
  v_mfma_f32_16x16x32_bf16 v[64:67], a[12:15], v[172:175], v[64:67]
  s_add_u32 s54, s54, 4096
  s_add_u32 s55, s55, 4096
  buffer_load_dwordx4 a[60:63], v9, s[20:23], s54 offen offset:0 sc1
  v_mfma_f32_16x16x32_bf16 v[68:71], a[12:15], v[176:179], v[68:71]
  s_waitcnt lgkmcnt(5)
  v_mfma_f32_16x16x32_bf16 v[72:75], a[16:19], v[172:175], v[72:75]
  buffer_load_dwordx4 a[64:67], v9, s[20:23], s55 offen offset:0 sc1
  v_mfma_f32_16x16x32_bf16 v[76:79], a[16:19], v[176:179], v[76:79]
  s_waitcnt vmcnt(7) lgkmcnt(4)
  v_mfma_f32_16x16x32_bf16 v[40:43], a[20:23], v[180:183], v[40:43]
  s_barrier
  ds_read_b128 a[0:3], v35 offset:8192
  s_waitcnt vmcnt(6)
  v_mfma_f32_16x16x32_bf16 v[44:47], a[20:23], a[40:43], v[44:47]
  ds_read_b128 a[4:7], v35 offset:9216
  s_waitcnt lgkmcnt(5)
  v_mfma_f32_16x16x32_bf16 v[48:51], a[24:27], v[180:183], v[48:51]
  ds_read_b128 a[8:11], v35 offset:10240
  v_mfma_f32_16x16x32_bf16 v[52:55], a[24:27], a[40:43], v[52:55]
  ds_read_b128 a[12:15], v35 offset:11264
  s_waitcnt lgkmcnt(6)
  v_mfma_f32_16x16x32_bf16 v[56:59], a[28:31], v[180:183], v[56:59]
  ds_read_b128 a[16:19], v35 offset:12288
  v_mfma_f32_16x16x32_bf16 v[60:63], a[28:31], a[40:43], v[60:63]
  s_waitcnt lgkmcnt(6)
  v_mfma_f32_16x16x32_bf16 v[64:67], a[32:35], v[180:183], v[64:67]
  buffer_load_dwordx4 v[80:83], v9, s[20:23], s54 offen offset:2048 sc1
  v_mfma_f32_16x16x32_bf16 v[68:71], a[32:35], a[40:43], v[68:71]
  s_waitcnt lgkmcnt(5)
  v_mfma_f32_16x16x32_bf16 v[72:75], a[36:39], v[180:183], v[72:75]
  buffer_load_dwordx4 v[84:87], v9, s[20:23], s55 offen offset:2048 sc1
  v_mfma_f32_16x16x32_bf16 v[76:79], a[36:39], a[40:43], v[76:79]
  s_waitcnt vmcnt(7) lgkmcnt(4)
  v_mfma_f32_16x16x32_bf16 v[40:43], a[0:3], a[44:47], v[40:43]
  s_barrier
  ds_read_b128 a[20:23], v35 offset:18432
  s_waitcnt vmcnt(6)
  v_mfma_f32_16x16x32_bf16 v[44:47], a[0:3], a[48:51], v[44:47]
  ds_read_b128 a[24:27], v35 offset:19456
  s_waitcnt lgkmcnt(5)
  v_mfma_f32_16x16x32_bf16 v[48:51], a[4:7], a[44:47], v[48:51]
  ds_read_b128 a[28:31], v35 offset:20480
  v_mfma_f32_16x16x32_bf16 v[52:55], a[4:7], a[48:51], v[52:55]
  ds_read_b128 a[32:35], v35 offset:21504
  s_waitcnt lgkmcnt(6)
  v_mfma_f32_16x16x32_bf16 v[56:59], a[8:11], a[44:47], v[56:59]
  ds_read_b128 a[36:39], v35 offset:22528
  v_mfma_f32_16x16x32_bf16 v[60:63], a[8:11], a[48:51], v[60:63]
  s_waitcnt lgkmcnt(6)
  v_mfma_f32_16x16x32_bf16 v[64:67], a[12:15], a[44:47], v[64:67]
  s_add_u32 s54, s54, 4096
  s_add_u32 s55, s55, 4096
  buffer_load_dwordx4 v[88:91], v9, s[20:23], s54 offen offset:0 sc1
  v_mfma_f32_16x16x32_bf16 v[68:71], a[12:15], a[48:51], v[68:71]
  s_waitcnt lgkmcnt(5)
  v_mfma_f32_16x16x32_bf16 v[72:75], a[16:19], a[44:47], v[72:75]
  buffer_load_dwordx4 v[92:95], v9, s[20:23], s55 offen offset:0 sc1
  v_mfma_f32_16x16x32_bf16 v[76:79], a[16:19], a[48:51], v[76:79]
  s_waitcnt vmcnt(7) lgkmcnt(4)
  v_mfma_f32_16x16x32_bf16 v[40:43], a[20:23], a[52:55], v[40:43]
  s_barrier
  ds_read_b128 a[0:3], v35 offset:28672
  s_waitcnt vmcnt(6)
  v_mfma_f32_16x16x32_bf16 v[44:47], a[20:23], a[56:59], v[44:47]
  ds_read_b128 a[4:7], v35 offset:29696
  s_waitcnt lgkmcnt(5)
  v_mfma_f32_16x16x32_bf16 v[48:51], a[24:27], a[52:55], v[48:51]
  ds_read_b128 a[8:11], v35 offset:30720
  v_mfma_f32_16x16x32_bf16 v[52:55], a[24:27], a[56:59], v[52:55]
  ds_read_b128 a[12:15], v35 offset:31744
  s_waitcnt lgkmcnt(6)
  v_mfma_f32_16x16x32_bf16 v[56:59], a[28:31], a[52:55], v[56:59]
  ds_read_b128 a[16:19], v35 offset:32768
  v_mfma_f32_16x16x32_bf16 v[60:63], a[28:31], a[56:59], v[60:63]
  s_waitcnt lgkmcnt(6)
  v_mfma_f32_16x16x32_bf16 v[64:67], a[32:35], a[52:55], v[64:67]
  buffer_load_dwordx4 v[96:99], v9, s[20:23], s54 offen offset:2048 sc1
  v_mfma_f32_16x16x32_bf16 v[68:71], a[32:35], a[56:59], v[68:71]
  s_waitcnt lgkmcnt(5)
  v_mfma_f32_16x16x32_bf16 v[72:75], a[36:39], a[52:55], v[72:75]
  buffer_load_dwordx4 v[100:103], v9, s[20:23], s55 offen offset:2048 sc1
  v_mfma_f32_16x16x32_bf16 v[76:79], a[36:39], a[56:59], v[76:79]
  s_waitcnt vmcnt(7) lgkmcnt(4)
  v_mfma_f32_16x16x32_bf16 v[40:43], a[0:3], a[60:63], v[40:43]
  s_barrier
  ds_read_b128 a[20:23], v35 offset:38912
  s_waitcnt vmcnt(6)
  v_mfma_f32_16x16x32_bf16 v[44:47], a[0:3], a[64:67], v[44:47]
  ds_read_b128 a[24:27], v35 offset:39936
  s_waitcnt lgkmcnt(5)
  v_mfma_f32_16x16x32_bf16 v[48:51], a[4:7], a[60:63], v[48:51]
  ds_read_b128 a[28:31], v35 offset:40960
  v_mfma_f32_16x16x32_bf16 v[52:55], a[4:7], a[64:67], v[52:55]
  ds_read_b128 a[32:35], v35 offset:41984
  s_waitcnt lgkmcnt(6)
  v_mfma_f32_16x16x32_bf16 v[56:59], a[8:11], a[60:63], v[56:59]
  ds_read_b128 a[36:39], v35 offset:43008
  v_mfma_f32_16x16x32_bf16 v[60:63], a[8:11], a[64:67], v[60:63]
  s_waitcnt lgkmcnt(6)
  v_mfma_f32_16x16x32_bf16 v[64:67], a[12:15], a[60:63], v[64:67]
  s_add_u32 s54, s54, 4096
  s_add_u32 s55, s55, 4096
  buffer_load_dwordx4 v[104:107], v9, s[20:23], s54 offen offset:0 sc1
  v_mfma_f32_16x16x32_bf16 v[68:71], a[12:15], a[64:67], v[68:71]
  s_waitcnt lgkmcnt(5)
  v_mfma_f32_16x16x32_bf16 v[72:75], a[16:19], a[60:63], v[72:75]
  buffer_load_dwordx4 v[108:111], v9, s[20:23], s55 offen offset:0 sc1
  v_mfma_f32_16x16x32_bf16 v[76:79], a[16:19], a[64:67], v[76:79]
  s_waitcnt vmcnt(7) lgkmcnt(4)
  v_mfma_f32_16x16x32_bf16 v[40:43], a[20:23], v[80:83], v[40:43]
  s_barrier
  ds_read_b128 a[0:3], v34 offset:0
  s_waitcnt vmcnt(6)
  v_mfma_f32_16x16x32_bf16 v[44:47], a[20:23], v[84:87], v[44:47]
  ds_read_b128 a[4:7], v34 offset:1024
  s_waitcnt lgkmcnt(5)
  v_mfma_f32_16x16x32_bf16 v[48:51], a[24:27], v[80:83], v[48:51]
  ds_read_b128 a[8:11], v34 offset:2048
  v_mfma_f32_16x16x32_bf16 v[52:55], a[24:27], v[84:87], v[52:55]
  ds_read_b128 a[12:15], v34 offset:3072
  s_waitcnt lgkmcnt(6)
  v_mfma_f32_16x16x32_bf16 v[56:59], a[28:31], v[80:83], v[56:59]
  ds_read_b128 a[16:19], v34 offset:4096
  v_mfma_f32_16x16x32_bf16 v[60:63], a[28:31], v[84:87], v[60:63]
  s_waitcnt lgkmcnt(6)
  v_mfma_f32_16x16x32_bf16 v[64:67], a[32:35], v[80:83], v[64:67]
  buffer_load_dwordx4 v[112:115], v9, s[20:23], s54 offen offset:2048 sc1
  v_mfma_f32_16x16x32_bf16 v[68:71], a[32:35], v[84:87], v[68:71]
  s_waitcnt lgkmcnt(5)
  v_mfma_f32_16x16x32_bf16 v[72:75], a[36:39], v[80:83], v[72:75]
  buffer_load_dwordx4 v[116:119], v9, s[20:23], s55 offen offset:2048 sc1
  v_mfma_f32_16x16x32_bf16 v[76:79], a[36:39], v[84:87], v[76:79]
  s_waitcnt vmcnt(7) lgkmcnt(4)
  v_mfma_f32_16x16x32_bf16 v[40:43], a[0:3], v[88:91], v[40:43]
  s_barrier
  ds_read_b128 a[20:23], v34 offset:10240
  s_waitcnt vmcnt(6)
  v_mfma_f32_16x16x32_bf16 v[44:47], a[0:3], v[92:95], v[44:47]
  ds_read_b128 a[24:27], v34 offset:11264
  s_waitcnt lgkmcnt(5)
  v_mfma_f32_16x16x32_bf16 v[48:51], a[4:7], v[88:91], v[48:51]
  ds_read_b128 a[28:31], v34 offset:12288
  v_mfma_f32_16x16x32_bf16 v[52:55], a[4:7], v[92:95], v[52:55]
  ds_read_b128 a[32:35], v34 offset:13312
  s_waitcnt lgkmcnt(6)
  v_mfma_f32_16x16x32_bf16 v[56:59], a[8:11], v[88:91], v[56:59]
  ds_read_b128 a[36:39], v34 offset:14336
  v_mfma_f32_16x16x32_bf16 v[60:63], a[8:11], v[92:95], v[60:63]
  s_waitcnt lgkmcnt(6)
  v_mfma_f32_16x16x32_bf16 v[64:67], a[12:15], v[88:91], v[64:67]
  s_add_u32 s54, s54, 4096
  s_add_u32 s55, s55, 4096
  buffer_load_dwordx4 v[132:135], v9, s[20:23], s54 offen offset:0 sc1
  v_mfma_f32_16x16x32_bf16 v[68:71], a[12:15], v[92:95], v[68:71]
  s_waitcnt lgkmcnt(5)
  v_mfma_f32_16x16x32_bf16 v[72:75], a[16:19], v[88:91], v[72:75]
  buffer_load_dwordx4 v[136:139], v9, s[20:23], s55 offen offset:0 sc1
  v_mfma_f32_16x16x32_bf16 v[76:79], a[16:19], v[92:95], v[76:79]
  s_waitcnt vmcnt(7) lgkmcnt(4)
  v_mfma_f32_16x16x32_bf16 v[40:43], a[20:23], v[96:99], v[40:43]
  s_barrier
  ds_read_b128 a[0:3], v34 offset:20480
  s_waitcnt vmcnt(6)
  v_mfma_f32_16x16x32_bf16 v[44:47], a[20:23], v[100:103], v[44:47]
  ds_read_b128 a[4:7], v34 offset:21504
  s_waitcnt lgkmcnt(5)
  v_mfma_f32_16x16x32_bf16 v[48:51], a[24:27], v[96:99], v[48:51]
  ds_read_b128 a[8:11], v34 offset:22528
  v_mfma_f32_16x16x32_bf16 v[52:55], a[24:27], v[100:103], v[52:55]
  ds_read_b128 a[12:15], v34 offset:23552
  s_waitcnt lgkmcnt(6)
  v_mfma_f32_16x16x32_bf16 v[56:59], a[28:31], v[96:99], v[56:59]
  ds_read_b128 a[16:19], v34 offset:24576
  v_mfma_f32_16x16x32_bf16 v[60:63], a[28:31], v[100:103], v[60:63]
  s_waitcnt lgkmcnt(6)
  v_mfma_f32_16x16x32_bf16 v[64:67], a[32:35], v[96:99], v[64:67]
  buffer_load_dwordx4 v[140:143], v9, s[20:23], s54 offen offset:2048 sc1
  v_mfma_f32_16x16x32_bf16 v[68:71], a[32:35], v[100:103], v[68:71]
  s_waitcnt lgkmcnt(5)
  v_mfma_f32_16x16x32_bf16 v[72:75], a[36:39], v[96:99], v[72:75]
  buffer_load_dwordx4 v[144:147], v9, s[20:23], s55 offen offset:2048 sc1
  v_mfma_f32_16x16x32_bf16 v[76:79], a[36:39], v[100:103], v[76:79]
  s_waitcnt vmcnt(7) lgkmcnt(4)
  v_mfma_f32_16x16x32_bf16 v[40:43], a[0:3], v[104:107], v[40:43]
  s_barrier
  ds_read_b128 a[20:23], v34 offset:30720
  s_waitcnt vmcnt(6)
  v_mfma_f32_16x16x32_bf16 v[44:47], a[0:3], v[108:111], v[44:47]
  ds_read_b128 a[24:27], v34 offset:31744
  s_waitcnt lgkmcnt(5)
  v_mfma_f32_16x16x32_bf16 v[48:51], a[4:7], v[104:107], v[48:51]
  ds_read_b128 a[28:31], v34 offset:32768
  v_mfma_f32_16x16x32_bf16 v[52:55], a[4:7], v[108:111], v[52:55]
  ds_read_b128 a[32:35], v34 offset:33792
  s_waitcnt lgkmcnt(6)
  v_mfma_f32_16x16x32_bf16 v[56:59], a[8:11], v[104:107], v[56:59]
  ds_read_b128 a[36:39], v34 offset:34816
  v_mfma_f32_16x16x32_bf16 v[60:63], a[8:11], v[108:111], v[60:63]
  s_waitcnt lgkmcnt(6)
  v_mfma_f32_16x16x32_bf16 v[64:67], a[12:15], v[104:107], v[64:67]
  s_add_u32 s54, s54, 4096
  s_add_u32 s55, s55, 4096
  buffer_load_dwordx4 v[148:151], v9, s[20:23], s54 offen offset:0 sc1
  v_mfma_f32_16x16x32_bf16 v[68:71], a[12:15], v[108:111], v[68:71]
  s_waitcnt lgkmcnt(5)
  v_mfma_f32_16x16x32_bf16 v[72:75], a[16:19], v[104:107], v[72:75]
  buffer_load_dwordx4 v[152:155], v9, s[20:23], s55 offen offset:0 sc1
  v_mfma_f32_16x16x32_bf16 v[76:79], a[16:19], v[108:111], v[76:79]
  s_waitcnt vmcnt(7) lgkmcnt(4)
  v_mfma_f32_16x16x32_bf16 v[40:43], a[20:23], v[112:115], v[40:43]
  s_barrier
  ds_read_b128 a[0:3], v34 offset:40960
  s_waitcnt vmcnt(6)
  v_mfma_f32_16x16x32_bf16 v[44:47], a[20:23], v[116:119], v[44:47]
  ds_read_b128 a[4:7], v34 offset:41984
  s_waitcnt lgkmcnt(5)
  v_mfma_f32_16x16x32_bf16 v[48:51], a[24:27], v[112:115], v[48:51]
  ds_read_b128 a[8:11], v34 offset:43008
  v_mfma_f32_16x16x32_bf16 v[52:55], a[24:27], v[116:119], v[52:55]
  ds_read_b128 a[12:15], v34 offset:44032
  s_waitcnt lgkmcnt(6)
  v_mfma_f32_16x16x32_bf16 v[56:59], a[28:31], v[112:115], v[56:59]
  ds_read_b128 a[16:19], v34 offset:45056
  v_mfma_f32_16x16x32_bf16 v[60:63], a[28:31], v[116:119], v[60:63]
  s_waitcnt lgkmcnt(6)
  v_mfma_f32_16x16x32_bf16 v[64:67], a[32:35], v[112:115], v[64:67]
  buffer_load_dwordx4 v[156:159], v9, s[20:23], s54 offen offset:2048 sc1
  v_mfma_f32_16x16x32_bf16 v[68:71], a[32:35], v[116:119], v[68:71]
  s_waitcnt lgkmcnt(5)
  v_mfma_f32_16x16x32_bf16 v[72:75], a[36:39], v[112:115], v[72:75]
  buffer_load_dwordx4 v[160:163], v9, s[20:23], s55 offen offset:2048 sc1
  v_mfma_f32_16x16x32_bf16 v[76:79], a[36:39], v[116:119], v[76:79]
  s_waitcnt vmcnt(7) lgkmcnt(4)
  v_mfma_f32_16x16x32_bf16 v[40:43], a[0:3], v[132:135], v[40:43]
  s_barrier
  ds_read_b128 a[20:23], v34 offset:51200
  s_waitcnt vmcnt(6)
  v_mfma_f32_16x16x32_bf16 v[44:47], a[0:3], v[136:139], v[44:47]
  ds_read_b128 a[24:27], v34 offset:52224
  s_waitcnt lgkmcnt(5)
  v_mfma_f32_16x16x32_bf16 v[48:51], a[4:7], v[132:135], v[48:51]
  ds_read_b128 a[28:31], v34 offset:53248
  v_mfma_f32_16x16x32_bf16 v[52:55], a[4:7], v[136:139], v[52:55]
  ds_read_b128 a[32:35], v34 offset:54272
  s_waitcnt lgkmcnt(6)
  v_mfma_f32_16x16x32_bf16 v[56:59], a[8:11], v[132:135], v[56:59]
  ds_read_b128 a[36:39], v34 offset:55296
  v_mfma_f32_16x16x32_bf16 v[60:63], a[8:11], v[136:139], v[60:63]
  s_waitcnt lgkmcnt(6)
  v_mfma_f32_16x16x32_bf16 v[64:67], a[12:15], v[132:135], v[64:67]
  s_add_u32 s54, s54, 4096
  s_add_u32 s55, s55, 4096
  buffer_load_dwordx4 v[164:167], v9, s[20:23], s54 offen offset:0 sc1
  v_mfma_f32_16x16x32_bf16 v[68:71], a[12:15], v[136:139], v[68:71]
  s_waitcnt lgkmcnt(5)
  v_mfma_f32_16x16x32_bf16 v[72:75], a[16:19], v[132:135], v[72:75]
  buffer_load_dwordx4 v[168:171], v9, s[20:23], s55 offen offset:0 sc1
  v_mfma_f32_16x16x32_bf16 v[76:79], a[16:19], v[136:139], v[76:79]
  s_waitcnt vmcnt(7) lgkmcnt(4)
  v_mfma_f32_16x16x32_bf16 v[40:43], a[20:23], v[140:143], v[40:43]
  s_barrier
  ds_read_b128 a[0:3], v34 offset:61440
  s_waitcnt vmcnt(6)
  v_mfma_f32_16x16x32_bf16 v[44:47], a[20:23], v[144:147], v[44:47]
  ds_read_b128 a[4:7], v34 offset:62464
  s_waitcnt lgkmcnt(5)
  v_mfma_f32_16x16x32_bf16 v[48:51], a[24:27], v[140:143], v[48:51]
  ds_read_b128 a[8:11], v34 offset:63488
  v_mfma_f32_16x16x32_bf16 v[52:55], a[24:27], v[144:147], v[52:55]
  ds_read_b128 a[12:15], v34 offset:64512
  s_waitcnt lgkmcnt(6)
  v_mfma_f32_16x16x32_bf16 v[56:59], a[28:31], v[140:143], v[56:59]
  ds_read_b128 a[16:19], v35 offset:0
  v_mfma_f32_16x16x32_bf16 v[60:63], a[28:31], v[144:147], v[60:63]
  s_waitcnt lgkmcnt(6)
  v_mfma_f32_16x16x32_bf16 v[64:67], a[32:35], v[140:143], v[64:67]
  buffer_load_dwordx4 v[172:175], v9, s[20:23], s54 offen offset:2048 sc1
  v_mfma_f32_16x16x32_bf16 v[68:71], a[32:35], v[144:147], v[68:71]
  s_waitcnt lgkmcnt(5)
  v_mfma_f32_16x16x32_bf16 v[72:75], a[36:39], v[140:143], v[72:75]
  buffer_load_dwordx4 v[176:179], v9, s[20:23], s55 offen offset:2048 sc1
  v_mfma_f32_16x16x32_bf16 v[76:79], a[36:39], v[144:147], v[76:79]
  s_waitcnt vmcnt(7) lgkmcnt(4)
  v_mfma_f32_16x16x32_bf16 v[40:43], a[0:3], v[148:151], v[40:43]
  s_barrier
  ds_read_b128 a[20:23], v35 offset:6144
  s_waitcnt vmcnt(6)
  v_mfma_f32_16x16x32_bf16 v[44:47], a[0:3], v[152:155], v[44:47]
  ds_read_b128 a[24:27], v35 offset:7168
  s_waitcnt lgkmcnt(5)
  v_mfma_f32_16x16x32_bf16 v[48:51], a[4:7], v[148:151], v[48:51]
  ds_read_b128 a[28:31], v35 offset:8192
  v_mfma_f32_16x16x32_bf16 v[52:55], a[4:7], v[152:155], v[52:55]
  ds_read_b128 a[32:35], v35 offset:9216
  s_waitcnt lgkmcnt(6)
  v_mfma_f32_16x16x32_bf16 v[56:59], a[8:11], v[148:151], v[56:59]
  ds_read_b128 a[36:39], v35 offset:10240
  v_mfma_f32_16x16x32_bf16 v[60:63], a[8:11], v[152:155], v[60:63]
  s_waitcnt lgkmcnt(6)
  v_mfma_f32_16x16x32_bf16 v[64:67], a[12:15], v[148:151], v[64:67]
  s_add_u32 s54, s54, 4096
  s_add_u32 s55, s55, 4096
  buffer_load_dwordx4 v[180:183], v9, s[20:23], s54 offen offset:0 sc1
  v_mfma_f32_16x16x32_bf16 v[68:71], a[12:15], v[152:155], v[68:71]
  s_waitcnt lgkmcnt(5)
  v_mfma_f32_16x16x32_bf16 v[72:75], a[16:19], v[148:151], v[72:75]
  buffer_load_dwordx4 a[40:43], v9, s[20:23], s55 offen offset:0 sc1
  v_mfma_f32_16x16x32_bf16 v[76:79], a[16:19], v[152:155], v[76:79]
  s_waitcnt vmcnt(7) lgkmcnt(4)
  v_mfma_f32_16x16x32_bf16 v[40:43], a[20:23], v[156:159], v[40:43]
  s_barrier
  ds_read_b128 a[0:3], v35 offset:16384
  s_waitcnt vmcnt(6)
  v_mfma_f32_16x16x32_bf16 v[44:47], a[20:23], v[160:163], v[44:47]
  ds_read_b128 a[4:7], v35 offset:17408
  s_waitcnt lgkmcnt(5)
  v_mfma_f32_16x16x32_bf16 v[48:51], a[24:27], v[156:159], v[48:51]
  ds_read_b128 a[8:11], v35 offset:18432
  v_mfma_f32_16x16x32_bf16 v[52:55], a[24:27], v[160:163], v[52:55]
  ds_read_b128 a[12:15], v35 offset:19456
  s_waitcnt lgkmcnt(6)
  v_mfma_f32_16x16x32_bf16 v[56:59], a[28:31], v[156:159], v[56:59]
  ds_read_b128 a[16:19], v35 offset:20480
  v_mfma_f32_16x16x32_bf16 v[60:63], a[28:31], v[160:163], v[60:63]
  s_waitcnt lgkmcnt(6)
  v_mfma_f32_16x16x32_bf16 v[64:67], a[32:35], v[156:159], v[64:67]
  v_mfma_f32_16x16x32_bf16 v[68:71], a[32:35], v[160:163], v[68:71]
  s_waitcnt lgkmcnt(5)
  v_mfma_f32_16x16x32_bf16 v[72:75], a[36:39], v[156:159], v[72:75]
  v_mfma_f32_16x16x32_bf16 v[76:79], a[36:39], v[160:163], v[76:79]
  s_waitcnt vmcnt(5) lgkmcnt(4)
  v_mfma_f32_16x16x32_bf16 v[40:43], a[0:3], v[164:167], v[40:43]
  s_barrier
  ds_read_b128 a[20:23], v35 offset:26624
  s_waitcnt vmcnt(4)
  v_mfma_f32_16x16x32_bf16 v[44:47], a[0:3], v[168:171], v[44:47]
  ds_read_b128 a[24:27], v35 offset:27648
  s_waitcnt lgkmcnt(5)
  v_mfma_f32_16x16x32_bf16 v[48:51], a[4:7], v[164:167], v[48:51]
  ds_read_b128 a[28:31], v35 offset:28672
  v_mfma_f32_16x16x32_bf16 v[52:55], a[4:7], v[168:171], v[52:55]
  ds_read_b128 a[32:35], v35 offset:29696
  s_waitcnt lgkmcnt(6)
  v_mfma_f32_16x16x32_bf16 v[56:59], a[8:11], v[164:167], v[56:59]
  ds_read_b128 a[36:39], v35 offset:30720
  v_mfma_f32_16x16x32_bf16 v[60:63], a[8:11], v[168:171], v[60:63]
  s_waitcnt lgkmcnt(6)
  v_mfma_f32_16x16x32_bf16 v[64:67], a[12:15], v[164:167], v[64:67]
  v_mfma_f32_16x16x32_bf16 v[68:71], a[12:15], v[168:171], v[68:71]
  s_waitcnt lgkmcnt(5)
  v_mfma_f32_16x16x32_bf16 v[72:75], a[16:19], v[164:167], v[72:75]
  v_mfma_f32_16x16x32_bf16 v[76:79], a[16:19], v[168:171], v[76:79]
  s_waitcnt vmcnt(3) lgkmcnt(4)
  v_mfma_f32_16x16x32_bf16 v[40:43], a[20:23], v[172:175], v[40:43]
  s_barrier
  ds_read_b128 a[0:3], v35 offset:36864
  s_waitcnt vmcnt(2)
  v_mfma_f32_16x16x32_bf16 v[44:47], a[20:23], v[176:179], v[44:47]
  ds_read_b128 a[4:7], v35 offset:37888
  s_waitcnt lgkmcnt(5)
  v_mfma_f32_16x16x32_bf16 v[48:51], a[24:27], v[172:175], v[48:51]
  ds_read_b128 a[8:11], v35 offset:38912
  v_mfma_f32_16x16x32_bf16 v[52:55], a[24:27], v[176:179], v[52:55]
  ds_read_b128 a[12:15], v35 offset:39936
  s_waitcnt lgkmcnt(6)
  v_mfma_f32_16x16x32_bf16 v[56:59], a[28:31], v[172:175], v[56:59]
  ds_read_b128 a[16:19], v35 offset:40960
  v_mfma_f32_16x16x32_bf16 v[60:63], a[28:31], v[176:179], v[60:63]
  s_waitcnt lgkmcnt(6)
  v_mfma_f32_16x16x32_bf16 v[64:67], a[32:35], v[172:175], v[64:67]
  v_mfma_f32_16x16x32_bf16 v[68:71], a[32:35], v[176:179], v[68:71]
  s_waitcnt lgkmcnt(5)
  v_mfma_f32_16x16x32_bf16 v[72:75], a[36:39], v[172:175], v[72:75]
  v_mfma_f32_16x16x32_bf16 v[76:79], a[36:39], v[176:179], v[76:79]
  s_waitcnt vmcnt(1) lgkmcnt(4)
  v_mfma_f32_16x16x32_bf16 v[40:43], a[0:3], v[180:183], v[40:43]
  s_waitcnt vmcnt(0)
  v_mfma_f32_16x16x32_bf16 v[44:47], a[0:3], a[40:43], v[44:47]
  s_waitcnt lgkmcnt(3)
  v_mfma_f32_16x16x32_bf16 v[48:51], a[4:7], v[180:183], v[48:51]
  v_mfma_f32_16x16x32_bf16 v[52:55], a[4:7], a[40:43], v[52:55]
  s_waitcnt lgkmcnt(2)
  v_mfma_f32_16x16x32_bf16 v[56:59], a[8:11], v[180:183], v[56:59]
  v_mfma_f32_16x16x32_bf16 v[60:63], a[8:11], a[40:43], v[60:63]
  s_waitcnt lgkmcnt(1)
  v_mfma_f32_16x16x32_bf16 v[64:67], a[12:15], v[180:183], v[64:67]
  v_mfma_f32_16x16x32_bf16 v[68:71], a[12:15], a[40:43], v[68:71]
  s_waitcnt lgkmcnt(0)
  v_mfma_f32_16x16x32_bf16 v[72:75], a[16:19], v[180:183], v[72:75]
  v_mfma_f32_16x16x32_bf16 v[76:79], a[16:19], a[40:43], v[76:79]
  s_barrier
  s_nop 7
  ds_write_b128 v27, v[44:47] offset:0
  ds_write_b128 v27, v[52:55] offset:1024
  ds_write_b128 v27, v[60:63] offset:2048
  ds_write_b128 v27, v[68:71] offset:3072
  ds_write_b128 v27, v[76:79] offset:4096
  s_waitcnt lgkmcnt(0)
  s_barrier
  ds_read_b128 v[80:83], v28 offset:0
  ds_read_b128 v[84:87], v28 offset:1024
  ds_read_b128 v[88:91], v28 offset:2048
  ds_read_b128 v[92:95], v28 offset:3072
  ds_read_b128 v[96:99], v28 offset:4096
  s_waitcnt lgkmcnt(4)
  v_pk_add_f32 v[100:101], v[40:41], v[80:81]
  v_lshlrev_b32 v30, 16, v10
  v_and_b32 v31, 0xffff0000, v10
  v_pk_add_f32 v[100:101], v[100:101], v[30:31]
  v_lshlrev_b32 v38, 16, v120
  v_and_b32 v39, 0xffff0000, v120
  v_pk_add_f32 v[100:101], v[100:101], v[38:39]
  v_pk_add_f32 v[102:103], v[42:43], v[82:83]
  v_lshlrev_b32 v30, 16, v11
  v_and_b32 v31, 0xffff0000, v11
  v_pk_add_f32 v[102:103], v[102:103], v[30:31]
  v_lshlrev_b32 v38, 16, v121
  v_and_b32 v39, 0xffff0000, v121
  v_pk_add_f32 v[102:103], v[102:103], v[38:39]
  s_waitcnt lgkmcnt(3)
  v_pk_add_f32 v[104:105], v[48:49], v[84:85]
  v_lshlrev_b32 v30, 16, v12
  v_and_b32 v31, 0xffff0000, v12
  v_pk_add_f32 v[104:105], v[104:105], v[30:31]
  v_lshlrev_b32 v38, 16, v122
  v_and_b32 v39, 0xffff0000, v122
  v_pk_add_f32 v[104:105], v[104:105], v[38:39]
  v_pk_add_f32 v[106:107], v[50:51], v[86:87]
  v_lshlrev_b32 v30, 16, v13
  v_and_b32 v31, 0xffff0000, v13
  v_pk_add_f32 v[106:107], v[106:107], v[30:31]
  v_lshlrev_b32 v38, 16, v123
  v_and_b32 v39, 0xffff0000, v123
  v_pk_add_f32 v[106:107], v[106:107], v[38:39]
  s_waitcnt lgkmcnt(2)
  v_pk_add_f32 v[108:109], v[56:57], v[88:89]
  v_lshlrev_b32 v30, 16, v14
  v_and_b32 v31, 0xffff0000, v14
  v_pk_add_f32 v[108:109], v[108:109], v[30:31]
  v_lshlrev_b32 v38, 16, v124
  v_and_b32 v39, 0xffff0000, v124
  v_pk_add_f32 v[108:109], v[108:109], v[38:39]
  v_pk_add_f32 v[110:111], v[58:59], v[90:91]
  v_lshlrev_b32 v30, 16, v15
  v_and_b32 v31, 0xffff0000, v15
  v_pk_add_f32 v[110:111], v[110:111], v[30:31]
  v_lshlrev_b32 v38, 16, v125
  v_and_b32 v39, 0xffff0000, v125
  v_pk_add_f32 v[110:111], v[110:111], v[38:39]
  s_waitcnt lgkmcnt(1)
  v_pk_add_f32 v[112:113], v[64:65], v[92:93]
  v_lshlrev_b32 v30, 16, v16
  v_and_b32 v31, 0xffff0000, v16
  v_pk_add_f32 v[112:113], v[112:113], v[30:31]
  v_lshlrev_b32 v38, 16, v126
  v_and_b32 v39, 0xffff0000, v126
  v_pk_add_f32 v[112:113], v[112:113], v[38:39]
  v_pk_add_f32 v[114:115], v[66:67], v[94:95]
  v_lshlrev_b32 v30, 16, v17
  v_and_b32 v31, 0xffff0000, v17
  v_pk_add_f32 v[114:115], v[114:115], v[30:31]
  v_lshlrev_b32 v38, 16, v127
  v_and_b32 v39, 0xffff0000, v127
  v_pk_add_f32 v[114:115], v[114:115], v[38:39]
  s_waitcnt lgkmcnt(0)
  v_pk_add_f32 v[116:117], v[72:73], v[96:97]
  v_lshlrev_b32 v30, 16, v18
  v_and_b32 v31, 0xffff0000, v18
  v_pk_add_f32 v[116:117], v[116:117], v[30:31]
  v_lshlrev_b32 v38, 16, v128
  v_and_b32 v39, 0xffff0000, v128
  v_pk_add_f32 v[116:117], v[116:117], v[38:39]
  v_pk_add_f32 v[118:119], v[74:75], v[98:99]
  v_lshlrev_b32 v30, 16, v19
  v_and_b32 v31, 0xffff0000, v19
  v_pk_add_f32 v[118:119], v[118:119], v[30:31]
  v_lshlrev_b32 v38, 16, v129
  v_and_b32 v39, 0xffff0000, v129
  v_pk_add_f32 v[118:119], v[118:119], v[38:39]
  v_cvt_pk_bf16_f32 v10, v100, v101
  v_cvt_pk_bf16_f32 v11, v102, v103
  v_cvt_pk_bf16_f32 v12, v104, v105
  v_cvt_pk_bf16_f32 v13, v106, v107
  v_cvt_pk_bf16_f32 v14, v108, v109
  v_cvt_pk_bf16_f32 v15, v110, v111
  v_cvt_pk_bf16_f32 v16, v112, v113
  v_cvt_pk_bf16_f32 v17, v114, v115
  v_cvt_pk_bf16_f32 v18, v116, v117
  v_cvt_pk_bf16_f32 v19, v118, v119
  v_mov_b32 v80, v10
  v_mov_b32 v81, v11
  v_mov_b32 v82, v12
  v_mov_b32 v83, v13
  v_mov_b32 v84, v14
  v_mov_b32 v85, v15
  v_mov_b32 v86, v16
  v_mov_b32 v87, v17
  s_nop 1
  v_permlane16_swap_b32 v80, v82
  v_permlane16_swap_b32 v81, v83
  v_permlane16_swap_b32 v84, v86
  v_permlane16_swap_b32 v85, v87
  s_lshl_b32 s46, s40, 3
  s_lshr_b32 s47, s41, 3
  s_lshl_b32 s47, s47, 2
  s_add_u32 s46, s46, s47
  s_add_u32 s46, s46, s18
  s_and_b32 s47, s41, 7
  s_cmp_eq_u32 s16, 1
  s_cbranch_scc1 g4_final
  s_mul_i32 s48, s46, 20480
  s_mul_i32 s49, s47, 2560
  s_add_u32 s48, s48, s49
  s_mul_i32 s49, s16, 0
  s_add_u32 s48, s48, s49
  s_add_u32 s48, s48, 8388608
  s_nop 0
  buffer_store_dwordx4 v[80:83], v23, s[20:23], s48 offen offset:0
  buffer_store_dwordx4 v[84:87], v23, s[20:23], s48 offen offset:1024
  v_lshrrev_b32 v30, 1, v4
  v_lshlrev_b32 v30, 8, v30
  v_lshlrev_b32 v31, 4, v3
  v_add_u32 v30, v30, v31
  v_and_b32 v31, 1, v4
  v_lshlrev_b32 v31, 3, v31
  v_add_u32 v30, v30, v31
  buffer_store_dwordx2 v[18:19], v30, s[20:23], s48 offen offset:2048
  s_lshl_b32 s48, s46, 10
  s_lshl_b32 s49, s47, 3
  s_add_u32 s48, s48, s49
  s_mul_i32 s49, s16, 0
  s_add_u32 s48, s48, s49
  s_add_u32 s48, s48, 20971520
  v_lshlrev_b32 v100, 16, v10
  v_and_b32 v101, 0xffff0000, v10
  v_lshlrev_b32 v102, 16, v11
  v_and_b32 v103, 0xffff0000, v11
  v_lshlrev_b32 v104, 16, v12
  v_and_b32 v105, 0xffff0000, v12
  v_lshlrev_b32 v106, 16, v13
  v_and_b32 v107, 0xffff0000, v13
  v_lshlrev_b32 v108, 16, v14
  v_and_b32 v109, 0xffff0000, v14
  v_lshlrev_b32 v110, 16, v15
  v_and_b32 v111, 0xffff0000, v15
  v_lshlrev_b32 v112, 16, v16
  v_and_b32 v113, 0xffff0000, v16
  v_lshlrev_b32 v114, 16, v17
  v_and_b32 v115, 0xffff0000, v17
  v_lshlrev_b32 v116, 16, v18
  v_and_b32 v117, 0xffff0000, v18
  v_lshlrev_b32 v118, 16, v19
  v_and_b32 v119, 0xffff0000, v19
  v_pk_add_f32 v[132:133], v[100:101], v[102:103]
  v_pk_add_f32 v[134:135], v[104:105], v[106:107]
  v_pk_add_f32 v[132:133], v[132:133], v[108:109]
  v_pk_add_f32 v[134:135], v[134:135], v[110:111]
  v_pk_add_f32 v[132:133], v[132:133], v[112:113]
  v_pk_add_f32 v[134:135], v[134:135], v[114:115]
  v_pk_add_f32 v[132:133], v[132:133], v[116:117]
  v_pk_add_f32 v[134:135], v[134:135], v[118:119]
  v_pk_add_f32 v[132:133], v[132:133], v[134:135]
  v_add_f32 v130, v132, v133
  v_mov_b32 v131, v130
  s_nop 1
  v_permlane16_swap_b32 v131, v130
  s_nop 1
  v_add_f32 v130, v130, v131
  v_mov_b32 v131, v130
  s_nop 1
  v_permlane32_swap_b32 v131, v130
  s_nop 1
  v_add_f32 v130, v130, v131
  v_mul_f32 v130, 0x3c4ccccd, v130
  v_sub_f32 v100, v100, v130
  v_mul_f32 v132, v100, v100
  v_sub_f32 v101, v101, v130
  v_mul_f32 v133, v101, v101
  v_sub_f32 v102, v102, v130
  v_fmac_f32 v132, v102, v102
  v_sub_f32 v103, v103, v130
  v_fmac_f32 v133, v103, v103
  v_sub_f32 v104, v104, v130
  v_fmac_f32 v132, v104, v104
  v_sub_f32 v105, v105, v130
  v_fmac_f32 v133, v105, v105
  v_sub_f32 v106, v106, v130
  v_fmac_f32 v132, v106, v106
  v_sub_f32 v107, v107, v130
  v_fmac_f32 v133, v107, v107
  v_sub_f32 v108, v108, v130
  v_fmac_f32 v132, v108, v108
  v_sub_f32 v109, v109, v130
  v_fmac_f32 v133, v109, v109
  v_sub_f32 v110, v110, v130
  v_fmac_f32 v132, v110, v110
  v_sub_f32 v111, v111, v130
  v_fmac_f32 v133, v111, v111
  v_sub_f32 v112, v112, v130
  v_fmac_f32 v132, v112, v112
  v_sub_f32 v113, v113, v130
  v_fmac_f32 v133, v113, v113
  v_sub_f32 v114, v114, v130
  v_fmac_f32 v132, v114, v114
  v_sub_f32 v115, v115, v130
  v_fmac_f32 v133, v115, v115
  v_sub_f32 v116, v116, v130
  v_fmac_f32 v132, v116, v116
  v_sub_f32 v117, v117, v130
  v_fmac_f32 v133, v117, v117
  v_sub_f32 v118, v118, v130
  v_fmac_f32 v132, v118, v118
  v_sub_f32 v119, v119, v130
  v_fmac_f32 v133, v119, v119
  v_add_f32 v132, v132, v133
  v_mov_b32 v131, v132
  s_nop 1
  v_permlane16_swap_b32 v131, v132
  s_nop 1
  v_add_f32 v132, v132, v131
  v_mov_b32 v131, v132
  s_nop 1
  v_permlane32_swap_b32 v131, v132
  s_nop 1
  v_add_f32 v132, v132, v131
  v_mov_b32 v133, v132
  v_mov_b32 v132, v130
  buffer_store_dwordx2 v[132:133], v26, s[20:23], s48 offen
  s_lshl_b32 s47, s16, 2
  s_add_u32 s47, s47, 4
  s_waitcnt vmcnt(0)
  v_mov_b32 v30, s47
  s_mov_b64 exec, 1
  s_cmp_lg_u32 s17, 0
  s_cbranch_scc1 g4_pub_fast
  buffer_wbl2 sc1
  s_waitcnt vmcnt(0)
  buffer_store_dword v30, v21, s[20:23], s61 offen sc0 sc1
  s_branch g4_pub_done
g4_pub_fast:
  buffer_store_dword v30, v21, s[20:23], s61 offen
g4_pub_done:
  s_mov_b64 exec, -1
  s_branch g4_done
g4_final:
  v_and_b32 v30, 1, v4
  v_lshlrev_b32 v30, 1, v30
  v_lshrrev_b32 v31, 1, v4
  v_add_u32 v30, v30, v31
  v_lshlrev_b32 v30, 4, v30
  v_mul_u32_u24 v31, 1280, v3
  v_add_u32 v30, v30, v31
  v_lshlrev_b32 v32, 3, v4
  v_add_u32 v32, v32, v31
  s_mul_i32 s48, s46, 20480
  s_mul_i32 s49, s47, 160
  s_add_u32 s48, s48, s49
  buffer_store_dwordx4 v[80:83], v30, s[32:35], s48 offen offset:0
  buffer_store_dwordx4 v[84:87], v30, s[32:35], s48 offen offset:64
  buffer_store_dwordx2 v[18:19], v32, s[32:35], s48 offen offset:128
g4_done:
  s_barrier
  s_waitcnt vmcnt(0) lgkmcnt(0)
  s_add_u32 s16, s16, 1
  s_cmp_lt_u32 s16, 2
  s_cbranch_scc1 c_layer
c_end:
  s_waitcnt vmcnt(0)
  s_endpgm
  .p2align 6
p_start:
  s_sub_u32 s42, s18, 4
  s_mul_i32 s44, s41, 163840
  s_add_u32 s44, s44, 0
  s_and_b32 s43, s41, 7
  s_mul_i32 s45, s43, 102400
  s_add_u32 s45, s45, 7340032
  s_mul_i32 s46, s41, 143360
  s_add_u32 s46, s46, 2621440
  s_mul_i32 s47, s43, 276480
  s_add_u32 s47, s47, 4980736
  s_lshl_b32 s48, s42, 11
  s_add_u32 s44, s44, s48
  s_add_u32 s45, s45, s48
  s_add_u32 s46, s46, s48
  s_add_u32 s47, s47, s48
  v_add_u32 v2, s48, v5
  v_add_u32 v3, 0x10000, v2
  s_cmp_lg_u32 s42, 3
  s_cbranch_scc1 p2_noarr
  s_lshr_b32 s52, s2, 5
  s_lshl_b32 s52, s52, 7
  s_lshr_b32 s53, s2, 3
  s_and_b32 s53, s53, 3
  s_lshl_b32 s53, s53, 2
  s_add_u32 s52, s52, s53
  s_add_u32 s52, s52, 0x1480000
  v_lshlrev_b32 v8, 10, v1
  v_mov_b32 v9, 1
  s_mov_b64 exec, 0xff
  buffer_atomic_add v9, v8, s[20:23], s52 offen
  s_mov_b64 exec, -1
p2_noarr:
  s_add_u32 s49, s44, 0
  s_add_u32 m0, s48, 0
  s_nop 0
  buffer_load_dwordx4 v5, s[20:23], s49 offen offset:0 lds
  buffer_load_dwordx4 v5, s[20:23], s49 offen offset:1024 lds
  s_add_u32 s49, s44, 8192
  s_add_u32 m0, s48, 8192
  s_nop 0
  buffer_load_dwordx4 v5, s[20:23], s49 offen offset:0 lds
  buffer_load_dwordx4 v5, s[20:23], s49 offen offset:1024 lds
  s_add_u32 s49, s44, 16384
  s_add_u32 m0, s48, 16384
  s_nop 0
  buffer_load_dwordx4 v5, s[20:23], s49 offen offset:0 lds
  buffer_load_dwordx4 v5, s[20:23], s49 offen offset:1024 lds
  s_add_u32 s49, s44, 24576
  s_add_u32 m0, s48, 24576
  s_nop 0
  buffer_load_dwordx4 v5, s[20:23], s49 offen offset:0 lds
  buffer_load_dwordx4 v5, s[20:23], s49 offen offset:1024 lds
  s_waitcnt vmcnt(6)
  s_barrier
  s_add_u32 s49, s44, 32768
  s_add_u32 m0, s48, 32768
  s_nop 0
  buffer_load_dwordx4 v5, s[20:23], s49 offen offset:0 lds
  buffer_load_dwordx4 v5, s[20:23], s49 offen offset:1024 lds
  s_waitcnt vmcnt(6)
  s_barrier
  s_add_u32 s49, s44, 40960
  s_add_u32 m0, s48, 40960
  s_nop 0
  buffer_load_dwordx4 v5, s[20:23], s49 offen offset:0 lds
  buffer_load_dwordx4 v5, s[20:23], s49 offen offset:1024 lds
  s_waitcnt vmcnt(6)
  s_barrier
  s_add_u32 s49, s44, 49152
  s_add_u32 m0, s48, 49152
  s_nop 0
  buffer_load_dwordx4 v5, s[20:23], s49 offen offset:0 lds
  buffer_load_dwordx4 v5, s[20:23], s49 offen offset:1024 lds
  s_waitcnt vmcnt(6)
  s_barrier
  s_add_u32 s49, s44, 57344
  s_add_u32 m0, s48, 57344
  s_nop 0
  buffer_load_dwordx4 v5, s[20:23], s49 offen offset:0 lds
  buffer_load_dwordx4 v5, s[20:23], s49 offen offset:1024 lds
  s_add_u32 s49, s44, 65536
  s_add_u32 m0, s48, 65536
  s_nop 0
  buffer_load_dwordx4 v5, s[20:23], s49 offen offset:0 lds
  buffer_load_dwordx4 v5, s[20:23], s49 offen offset:1024 lds
  s_waitcnt vmcnt(8)
  s_barrier
  s_add_u32 s49, s44, 73728
  s_add_u32 m0, s48, 73728
  s_nop 0
  buffer_load_dwordx4 v5, s[20:23], s49 offen offset:0 lds
  buffer_load_dwordx4 v5, s[20:23], s49 offen offset:1024 lds
  s_waitcnt vmcnt(8)
  s_barrier
  s_add_u32 s49, s44, 81920
  s_add_u32 m0, s48, 81920
  s_nop 0
  buffer_load_dwordx4 v5, s[20:23], s49 offen offset:0 lds
  buffer_load_dwordx4 v5, s[20:23], s49 offen offset:1024 lds
  s_waitcnt vmcnt(8)
  s_barrier
  s_add_u32 s49, s44, 90112
  s_add_u32 m0, s48, 90112
  s_nop 0
  buffer_load_dwordx4 v5, s[20:23], s49 offen offset:0 lds
  buffer_load_dwordx4 v5, s[20:23], s49 offen offset:1024 lds
  s_waitcnt vmcnt(8)
  s_barrier
  s_add_u32 s49, s44, 98304
  s_add_u32 m0, s48, 98304
  s_nop 0
  buffer_load_dwordx4 v5, s[20:23], s49 offen offset:0 lds
  buffer_load_dwordx4 v5, s[20:23], s49 offen offset:1024 lds
  s_add_u32 s49, s44, 106496
  s_add_u32 m0, s48, 106496
  s_nop 0
  buffer_load_dwordx4 v5, s[20:23], s49 offen offset:0 lds
  buffer_load_dwordx4 v5, s[20:23], s49 offen offset:1024 lds
  s_waitcnt vmcnt(10)
  s_barrier
  s_add_u32 s49, s44, 114688
  s_add_u32 m0, s48, 0
  s_nop 0
  buffer_load_dwordx4 v5, s[20:23], s49 offen offset:0 lds
  buffer_load_dwordx4 v5, s[20:23], s49 offen offset:1024 lds
  s_waitcnt vmcnt(10)
  s_barrier
  s_add_u32 s49, s44, 122880
  s_add_u32 m0, s48, 8192
  s_nop 0
  buffer_load_dwordx4 v5, s[20:23], s49 offen offset:0 lds
  buffer_load_dwordx4 v5, s[20:23], s49 offen offset:1024 lds
  s_waitcnt vmcnt(10)
  s_barrier
  s_add_u32 s49, s44, 131072
  s_add_u32 m0, s48, 16384
  s_nop 0
  buffer_load_dwordx4 v5, s[20:23], s49 offen offset:0 lds
  buffer_load_dwordx4 v5, s[20:23], s49 offen offset:1024 lds
  s_waitcnt vmcnt(10)
  s_barrier
  s_add_u32 s49, s44, 139264
  s_add_u32 m0, s48, 24576
  s_nop 0
  buffer_load_dwordx4 v5, s[20:23], s49 offen offset:0 lds
  buffer_load_dwordx4 v5, s[20:23], s49 offen offset:1024 lds
  s_add_u32 s49, s44, 147456
  s_add_u32 m0, s48, 32768
  s_nop 0
  buffer_load_dwordx4 v5, s[20:23], s49 offen offset:0 lds
  buffer_load_dwordx4 v5, s[20:23], s49 offen offset:1024 lds
  s_waitcnt vmcnt(12)
  s_barrier
  s_and_b32 s52, s2, 7
  s_lshl_b32 s52, s52, 10
  s_add_u32 s52, s52, 0x1480000
  s_cmp_eq_u32 s42, 0
  s_cselect_b32 s53, 0, 0x80000000
  v_bfe_u32 v8, v1, 2, 3
  v_lshlrev_b32 v8, 7, v8
  v_and_b32 v9, 3, v1
  v_lshlrev_b32 v9, 2, v9
  v_or_b32 v8, v8, v9
  v_or_b32 v8, s53, v8
  buffer_load_dword v10, v8, s[20:23], s52 offen sc0 sc1
  s_add_u32 s49, s44, 155648
  s_add_u32 m0, s48, 40960
  s_nop 0
  buffer_load_dwordx4 v5, s[20:23], s49 offen offset:0 lds
  buffer_load_dwordx4 v5, s[20:23], s49 offen offset:1024 lds
  s_waitcnt vmcnt(13)
  s_barrier
  s_waitcnt vmcnt(11)
  s_barrier
  s_waitcnt vmcnt(9)
  s_waitcnt vmcnt(2)
  s_cmp_lg_u32 s42, 0
  s_cbranch_scc1 p2_done
  s_mov_b32 s58, 0
p2_poll:
  v_cmp_eq_u32 vcc, 8, v10
  s_add_u32 s58, s58, 1
  s_cmp_eq_u64 vcc, -1
  s_cbranch_scc1 p2_done
  s_cmp_ge_u32 s58, 524288
  s_cbranch_scc1 p2_fail
  buffer_load_dword v10, v8, s[20:23], s52 offen sc0 sc1
  s_waitcnt vmcnt(0)
  s_branch p2_poll
p2_fail:
  s_mov_b32 s19, 1
p2_done:
  s_barrier
  s_add_u32 s49, s45, 0
  s_add_u32 m0, s48, 49152
  s_nop 0
  buffer_load_dwordx4 v5, s[20:23], s49 offen offset:0 lds
  buffer_load_dwordx4 v5, s[20:23], s49 offen offset:1024 lds
  s_add_u32 s49, s45, 8192
  s_add_u32 m0, s48, 57344
  s_nop 0
  buffer_load_dwordx4 v5, s[20:23], s49 offen offset:0 lds
  buffer_load_dwordx4 v5, s[20:23], s49 offen offset:1024 lds
  s_barrier
  s_add_u32 s49, s45, 16384
  s_add_u32 m0, s48, 65536
  s_nop 0
  buffer_load_dwordx4 v5, s[20:23], s49 offen offset:0 lds
  buffer_load_dwordx4 v5, s[20:23], s49 offen offset:1024 lds
  s_barrier
  s_add_u32 s49, s45, 24576
  s_add_u32 m0, s48, 73728
  s_nop 0
  buffer_load_dwordx4 v5, s[20:23], s49 offen offset:0 lds
  buffer_load_dwordx4 v5, s[20:23], s49 offen offset:1024 lds
  s_barrier
  s_add_u32 s49, s45, 32768
  s_add_u32 m0, s48, 81920
  s_nop 0
  buffer_load_dwordx4 v5, s[20:23], s49 offen offset:0 lds
  buffer_load_dwordx4 v5, s[20:23], s49 offen offset:1024 lds
  s_waitcnt vmcnt(10)
  s_barrier
  s_add_u32 s49, s45, 40960
  s_add_u32 m0, s48, 90112
  s_nop 0
  buffer_load_dwordx4 v5, s[20:23], s49 offen offset:0 lds
  buffer_load_dwordx4 v5, s[20:23], s49 offen offset:1024 lds
  s_add_u32 s49, s45, 49152
  s_add_u32 m0, s48, 98304
  s_nop 0
  buffer_load_dwordx4 v5, s[20:23], s49 offen offset:0 lds
  buffer_load_dwordx4 v5, s[20:23], s49 offen offset:1024 lds
  s_barrier
  s_add_u32 s49, s45, 57344
  s_add_u32 m0, s48, 106496
  s_nop 0
  buffer_load_dwordx4 v5, s[20:23], s49 offen offset:0 lds
  buffer_load_dwordx4 v5, s[20:23], s49 offen offset:1024 lds
  s_add_u32 s49, s45, 65536
  s_add_u32 m0, s48, 0
  s_nop 0
  buffer_load_dwordx4 v5, s[20:23], s49 offen offset:0 lds
  buffer_load_dwordx4 v5, s[20:23], s49 offen offset:1024 lds
  s_add_u32 s49, s45, 73728
  s_add_u32 m0, s48, 8192
  s_nop 0
  buffer_load_dwordx4 v5, s[20:23], s49 offen offset:0 lds
  buffer_load_dwordx4 v5, s[20:23], s49 offen offset:1024 lds
  s_add_u32 s49, s45, 81920
  s_add_u32 m0, s48, 16384
  s_nop 0
  buffer_load_dwordx4 v5, s[20:23], s49 offen offset:0 lds
  buffer_load_dwordx4 v5, s[20:23], s49 offen offset:1024 lds
  s_add_u32 s49, s45, 90112
  s_add_u32 m0, s48, 24576
  s_nop 0
  buffer_load_dwordx4 v5, s[20:23], s49 offen offset:0 lds
  buffer_load_dwordx4 v5, s[20:23], s49 offen offset:1024 lds
  s_add_u32 s49, s45, 98304
  s_add_u32 s51, s46, 4294963200
  s_cmp_lt_u32 s42, 2
  s_cselect_b32 s49, s49, s51
  s_add_u32 m0, s48, 32768
  s_nop 0
  buffer_load_dwordx4 v5, s[20:23], s49 offen offset:0 lds
  buffer_load_dwordx4 v5, s[20:23], s49 offen offset:1024 lds
  s_add_u32 s49, s46, 4096
  s_add_u32 m0, s48, 40960
  s_nop 0
  buffer_load_dwordx4 v5, s[20:23], s49 offen offset:0 lds
  buffer_load_dwordx4 v5, s[20:23], s49 offen offset:1024 lds
  s_add_u32 s49, s46, 12288
  buffer_load_dwordx4 v[60:63], v5, s[20:23], s49 offen offset:0
  buffer_load_dwordx4 v[64:67], v5, s[20:23], s49 offen offset:1024
  s_add_u32 s49, s46, 20480
  buffer_load_dwordx4 v[68:71], v5, s[20:23], s49 offen offset:0
  buffer_load_dwordx4 v[72:75], v5, s[20:23], s49 offen offset:1024
  s_add_u32 s49, s46, 28672
  buffer_load_dwordx4 v[76:79], v5, s[20:23], s49 offen offset:0
  buffer_load_dwordx4 v[80:83], v5, s[20:23], s49 offen offset:1024
  s_add_u32 s49, s46, 36864
  buffer_load_dwordx4 v[84:87], v5, s[20:23], s49 offen offset:0
  buffer_load_dwordx4 v[88:91], v5, s[20:23], s49 offen offset:1024
  s_add_u32 s49, s46, 45056
  buffer_load_dwordx4 v[92:95], v5, s[20:23], s49 offen offset:0
  buffer_load_dwordx4 v[96:99], v5, s[20:23], s49 offen offset:1024
  s_barrier
  s_barrier
  s_add_u32 s49, s46, 53248
  buffer_load_dwordx4 v[100:103], v5, s[20:23], s49 offen offset:0
  buffer_load_dwordx4 v[104:107], v5, s[20:23], s49 offen offset:1024
  s_add_u32 s49, s46, 61440
  buffer_load_dwordx4 v[108:111], v5, s[20:23], s49 offen offset:0
  buffer_load_dwordx4 v[112:115], v5, s[20:23], s49 offen offset:1024
  s_add_u32 s49, s46, 69632
  buffer_load_dwordx4 v[116:119], v5, s[20:23], s49 offen offset:0
  buffer_load_dwordx4 v[120:123], v5, s[20:23], s49 offen offset:1024
  s_add_u32 s49, s46, 77824
  buffer_load_dwordx4 v[124:127], v5, s[20:23], s49 offen offset:0
  buffer_load_dwordx4 v[128:131], v5, s[20:23], s49 offen offset:1024
  s_add_u32 s49, s46, 86016
  buffer_load_dwordx4 v[132:135], v5, s[20:23], s49 offen offset:0
  buffer_load_dwordx4 v[136:139], v5, s[20:23], s49 offen offset:1024
  s_add_u32 s49, s46, 94208
  buffer_load_dwordx4 v[140:143], v5, s[20:23], s49 offen offset:0
  buffer_load_dwordx4 v[144:147], v5, s[20:23], s49 offen offset:1024
  s_lshr_b32 s53, s42, 1
  s_lshl_b32 s49, s41, 1
  s_add_u32 s49, s49, s53
  s_mul_i32 s49, s49, 6144
  s_and_b32 s50, s42, 1
  s_mul_i32 s51, s50, 2016
  s_add_u32 s49, s49, s51
  s_add_u32 s49, s49, 0x1420000
  v_mov_b32 v18, 0x80000000
  v_cmp_gt_u32 vcc, 62, v1
  s_mul_i32 s51, s42, 1008
  s_add_u32 s51, s51, 151616
  v_cndmask_b32 v17, v18, v5, vcc
  v_lshlrev_b32 v18, 3, v1
  v_add_u32 v18, s51, v18
  s_mov_b32 s52, 0x41800000
  s_mov_b32 s58, 0
kv0_poll:
  buffer_load_dwordx4 v[20:23], v5, s[20:23], s49 offen sc1
  buffer_load_dwordx4 v[24:27], v17, s[20:23], s49 offen offset:1024 sc1
  s_add_u32 s58, s58, 1
  s_waitcnt vmcnt(0)
  v_cmp_eq_u32 s[50:51], s52, v23
  v_cmp_eq_u32 vcc, s52, v27
  s_or_b32 s50, s50, 0x55555555
  s_or_b32 s51, s51, 0x55555555
  s_or_b32 vcc_lo, vcc_lo, 0x55555555
  s_or_b32 vcc_hi, vcc_hi, 0xd5555555
  s_and_b64 vcc, vcc, s[50:51]
  s_cmp_eq_u64 vcc, -1
  s_cbranch_scc1 kv0_ok
  s_cmp_lg_u32 s19, 0
  s_cbranch_scc1 kv0_ok
  s_cmp_lt_u32 s58, 131072
  s_cbranch_scc1 kv0_poll
  s_mov_b32 s19, 1
kv0_ok:
  v_cvt_pk_bf16_f32 v20, v20, v21
  v_cvt_pk_bf16_f32 v21, v22, v23
  v_cvt_pk_bf16_f32 v24, v24, v25
  v_cvt_pk_bf16_f32 v25, v26, v27
  ds_write_b64 v18, v[20:21]
  s_mov_b32 exec_hi, 0x3fffffff
  ds_write_b64 v18, v[24:25] offset:512
  s_mov_b64 exec, -1
  s_waitcnt lgkmcnt(0)
  s_barrier
  s_add_u32 s49, s46, 102400
  buffer_load_dwordx4 v[148:151], v5, s[20:23], s49 offen offset:0
  buffer_load_dwordx4 v[152:155], v5, s[20:23], s49 offen offset:1024
  s_add_u32 s49, s46, 110592
  buffer_load_dwordx4 v[156:159], v5, s[20:23], s49 offen offset:0
  buffer_load_dwordx4 v[160:163], v5, s[20:23], s49 offen offset:1024
  s_barrier
  s_barrier
  s_barrier
  s_barrier
  ds_write_b128 v2, v[60:63] offset:49152
  ds_write_b128 v2, v[64:67] offset:50176
  s_add_u32 s49, s46, 118784
  buffer_load_dwordx4 v[164:167], v5, s[20:23], s49 offen offset:0
  buffer_load_dwordx4 v[168:171], v5, s[20:23], s49 offen offset:1024
  s_barrier
  ds_write_b128 v2, v[68:71] offset:57344
  ds_write_b128 v2, v[72:75] offset:58368
  s_barrier
  ds_write_b128 v3, v[76:79] offset:0
  ds_write_b128 v3, v[80:83] offset:1024
  s_barrier
  ds_write_b128 v3, v[84:87] offset:8192
  ds_write_b128 v3, v[88:91] offset:9216
  ds_write_b128 v3, v[92:95] offset:16384
  ds_write_b128 v3, v[96:99] offset:17408
  s_add_u32 s49, s46, 126976
  buffer_load_dwordx4 v[172:175], v5, s[20:23], s49 offen offset:0
  buffer_load_dwordx4 v[176:179], v5, s[20:23], s49 offen offset:1024
  s_barrier
  ds_write_b128 v3, v[100:103] offset:24576
  ds_write_b128 v3, v[104:107] offset:25600
  s_barrier
  ds_write_b128 v3, v[108:111] offset:32768
  ds_write_b128 v3, v[112:115] offset:33792
  s_barrier
  ds_write_b128 v3, v[116:119] offset:40960
  ds_write_b128 v3, v[120:123] offset:41984
  s_barrier
  ds_write_b128 v2, v[124:127] offset:0
  ds_write_b128 v2, v[128:131] offset:1024
  ds_write_b128 v2, v[132:135] offset:8192
  ds_write_b128 v2, v[136:139] offset:9216
  s_add_u32 s49, s46, 135168
  buffer_load_dwordx4 v[180:183], v5, s[20:23], s49 offen offset:0
  buffer_load_dwordx4 a[0:3], v5, s[20:23], s49 offen offset:1024
  s_barrier
  ds_write_b128 v2, v[140:143] offset:16384
  ds_write_b128 v2, v[144:147] offset:17408
  s_waitcnt vmcnt(8)
  ds_write_b128 v2, v[148:151] offset:24576
  ds_write_b128 v2, v[152:155] offset:25600
  s_add_u32 s49, s47, 0
  buffer_load_dwordx4 a[4:7], v5, s[20:23], s49 offen offset:0
  buffer_load_dwordx4 a[8:11], v5, s[20:23], s49 offen offset:1024
  s_barrier
  s_add_u32 s49, s47, 8192
  buffer_load_dwordx4 a[12:15], v5, s[20:23], s49 offen offset:0
  buffer_load_dwordx4 a[16:19], v5, s[20:23], s49 offen offset:1024
  s_add_u32 s49, s47, 16384
  buffer_load_dwordx4 a[20:23], v5, s[20:23], s49 offen offset:0
  buffer_load_dwordx4 a[24:27], v5, s[20:23], s49 offen offset:1024
  s_add_u32 s49, s47, 24576
  buffer_load_dwordx4 a[28:31], v5, s[20:23], s49 offen offset:0
  buffer_load_dwordx4 a[32:35], v5, s[20:23], s49 offen offset:1024
  s_add_u32 s49, s47, 32768
  buffer_load_dwordx4 a[36:39], v5, s[20:23], s49 offen offset:0
  buffer_load_dwordx4 a[40:43], v5, s[20:23], s49 offen offset:1024
  s_barrier
  s_barrier
  s_waitcnt lgkmcnt(15)
  s_barrier
  s_add_u32 s49, s47, 40960
  buffer_load_dwordx4 a[44:47], v5, s[20:23], s49 offen offset:0
  buffer_load_dwordx4 a[48:51], v5, s[20:23], s49 offen offset:1024
  s_barrier
  s_waitcnt vmcnt(18)
  ds_write_b128 v2, v[156:159] offset:32768
  ds_write_b128 v2, v[160:163] offset:33792
  s_add_u32 s49, s47, 49152
  buffer_load_dwordx4 a[52:55], v5, s[20:23], s49 offen offset:0
  buffer_load_dwordx4 a[56:59], v5, s[20:23], s49 offen offset:1024
  s_barrier
  s_waitcnt vmcnt(18)
  ds_write_b128 v2, v[164:167] offset:40960
  ds_write_b128 v2, v[168:171] offset:41984
  s_add_u32 s49, s47, 57344
  buffer_load_dwordx4 a[60:63], v5, s[20:23], s49 offen offset:0
  buffer_load_dwordx4 a[64:67], v5, s[20:23], s49 offen offset:1024
  s_barrier
  s_waitcnt vmcnt(18)
  ds_write_b128 v2, v[172:175] offset:49152
  ds_write_b128 v2, v[176:179] offset:50176
  s_barrier
  s_waitcnt vmcnt(16)
  ds_write_b128 v2, v[180:183] offset:57344
  ds_write_b128 v2, a[0:3] offset:58368
  s_add_u32 s49, s47, 65536
  buffer_load_dwordx4 v[60:63], v5, s[20:23], s49 offen offset:0
  buffer_load_dwordx4 v[64:67], v5, s[20:23], s49 offen offset:1024
  s_waitcnt lgkmcnt(15)
  s_barrier
  s_add_u32 s49, s47, 73728
  buffer_load_dwordx4 v[68:71], v5, s[20:23], s49 offen offset:0
  buffer_load_dwordx4 v[72:75], v5, s[20:23], s49 offen offset:1024
  s_barrier
  s_waitcnt vmcnt(18)
  ds_write_b128 v3, a[4:7] offset:0
  ds_write_b128 v3, a[8:11] offset:1024
  s_add_u32 s49, s47, 81920
  buffer_load_dwordx4 v[76:79], v5, s[20:23], s49 offen offset:0
  buffer_load_dwordx4 v[80:83], v5, s[20:23], s49 offen offset:1024
  s_barrier
  s_waitcnt vmcnt(18)
  ds_write_b128 v3, a[12:15] offset:8192
  ds_write_b128 v3, a[16:19] offset:9216
  s_barrier
  s_waitcnt vmcnt(16)
  ds_write_b128 v3, a[20:23] offset:16384
  ds_write_b128 v3, a[24:27] offset:17408
  s_add_u32 s49, s47, 90112
  buffer_load_dwordx4 v[84:87], v5, s[20:23], s49 offen offset:0
  buffer_load_dwordx4 v[88:91], v5, s[20:23], s49 offen offset:1024
  s_waitcnt lgkmcnt(15)
  s_barrier
  s_waitcnt vmcnt(16)
  ds_write_b128 v3, a[28:31] offset:24576
  ds_write_b128 v3, a[32:35] offset:25600
  s_add_u32 s49, s47, 98304
  buffer_load_dwordx4 v[92:95], v5, s[20:23], s49 offen offset:0
  buffer_load_dwordx4 v[96:99], v5, s[20:23], s49 offen offset:1024
  s_barrier
  s_waitcnt vmcnt(16)
  ds_write_b128 v3, a[36:39] offset:32768
  ds_write_b128 v3, a[40:43] offset:33792
  s_add_u32 s49, s47, 106496
  buffer_load_dwordx4 v[100:103], v5, s[20:23], s49 offen offset:0
  buffer_load_dwordx4 v[104:107], v5, s[20:23], s49 offen offset:1024
  s_barrier
  s_waitcnt vmcnt(16)
  ds_write_b128 v3, a[44:47] offset:40960
  ds_write_b128 v3, a[48:51] offset:41984
  s_barrier
  s_waitcnt vmcnt(14)
  ds_write_b128 v2, a[52:55] offset:0
  ds_write_b128 v2, a[56:59] offset:1024
  s_add_u32 s49, s47, 114688
  buffer_load_dwordx4 v[108:111], v5, s[20:23], s49 offen offset:0
  buffer_load_dwordx4 v[112:115], v5, s[20:23], s49 offen offset:1024
  s_waitcnt lgkmcnt(15)
  s_barrier
  s_add_u32 s49, s47, 122880
  buffer_load_dwordx4 v[116:119], v5, s[20:23], s49 offen offset:0
  buffer_load_dwordx4 v[120:123], v5, s[20:23], s49 offen offset:1024
  s_barrier
  s_waitcnt vmcnt(16)
  ds_write_b128 v2, a[60:63] offset:8192
  ds_write_b128 v2, a[64:67] offset:9216
  s_add_u32 s49, s47, 131072
  buffer_load_dwordx4 v[124:127], v5, s[20:23], s49 offen offset:0
  buffer_load_dwordx4 v[128:131], v5, s[20:23], s49 offen offset:1024
  s_barrier
  s_waitcnt vmcnt(16)
  ds_write_b128 v2, v[60:63] offset:16384
  ds_write_b128 v2, v[64:67] offset:17408
  s_barrier
  s_waitcnt vmcnt(14)
  ds_write_b128 v2, v[68:71] offset:24576
  ds_write_b128 v2, v[72:75] offset:25600
  s_add_u32 s49, s47, 139264
  buffer_load_dwordx4 v[132:135], v5, s[20:23], s49 offen offset:0
  buffer_load_dwordx4 v[136:139], v5, s[20:23], s49 offen offset:1024
  s_waitcnt lgkmcnt(15)
  s_barrier
  s_waitcnt vmcnt(14)
  ds_write_b128 v2, v[76:79] offset:32768
  ds_write_b128 v2, v[80:83] offset:33792
  s_add_u32 s49, s47, 147456
  buffer_load_dwordx4 v[140:143], v5, s[20:23], s49 offen offset:0
  buffer_load_dwordx4 v[144:147], v5, s[20:23], s49 offen offset:1024
  s_barrier
  s_waitcnt vmcnt(14)
  ds_write_b128 v2, v[84:87] offset:40960
  ds_write_b128 v2, v[88:91] offset:41984
  s_add_u32 s49, s47, 155648
  buffer_load_dwordx4 v[148:151], v5, s[20:23], s49 offen offset:0
  buffer_load_dwordx4 v[152:155], v5, s[20:23], s49 offen offset:1024
  s_barrier
  s_waitcnt vmcnt(14)
  ds_write_b128 v2, v[92:95] offset:49152
  ds_write_b128 v2, v[96:99] offset:50176
  s_waitcnt vmcnt(12)
  ds_write_b128 v2, v[100:103] offset:57344
  ds_write_b128 v2, v[104:107] offset:58368
  s_add_u32 s49, s47, 163840
  buffer_load_dwordx4 v[156:159], v5, s[20:23], s49 offen offset:0
  buffer_load_dwordx4 v[160:163], v5, s[20:23], s49 offen offset:1024
  s_add_u32 s49, s47, 172032
  buffer_load_dwordx4 v[164:167], v5, s[20:23], s49 offen offset:0
  buffer_load_dwordx4 v[168:171], v5, s[20:23], s49 offen offset:1024
  s_add_u32 s49, s47, 180224
  buffer_load_dwordx4 v[172:175], v5, s[20:23], s49 offen offset:0
  buffer_load_dwordx4 v[176:179], v5, s[20:23], s49 offen offset:1024
  s_add_u32 s49, s47, 188416
  buffer_load_dwordx4 v[180:183], v5, s[20:23], s49 offen offset:0
  buffer_load_dwordx4 a[0:3], v5, s[20:23], s49 offen offset:1024
  s_add_u32 s49, s47, 196608
  buffer_load_dwordx4 a[4:7], v5, s[20:23], s49 offen offset:0
  buffer_load_dwordx4 a[8:11], v5, s[20:23], s49 offen offset:1024
  s_add_u32 s49, s47, 204800
  buffer_load_dwordx4 a[12:15], v5, s[20:23], s49 offen offset:0
  buffer_load_dwordx4 a[16:19], v5, s[20:23], s49 offen offset:1024
  s_add_u32 s49, s47, 212992
  s_waitcnt lgkmcnt(15)
  buffer_load_dwordx4 a[20:23], v5, s[20:23], s49 offen offset:0
  buffer_load_dwordx4 a[24:27], v5, s[20:23], s49 offen offset:1024
  s_add_u32 s49, s47, 221184
  buffer_load_dwordx4 a[28:31], v5, s[20:23], s49 offen offset:0
  buffer_load_dwordx4 a[32:35], v5, s[20:23], s49 offen offset:1024
  s_barrier
  s_barrier
  s_barrier
  s_barrier
  s_waitcnt vmcnt(26)
  ds_write_b128 v3, v[108:111] offset:0
  ds_write_b128 v3, v[112:115] offset:1024
  s_add_u32 s49, s47, 229376
  buffer_load_dwordx4 a[36:39], v5, s[20:23], s49 offen offset:0
  buffer_load_dwordx4 a[40:43], v5, s[20:23], s49 offen offset:1024
  s_barrier
  s_waitcnt vmcnt(26)
  ds_write_b128 v3, v[116:119] offset:8192
  ds_write_b128 v3, v[120:123] offset:9216
  s_waitcnt lgkmcnt(15)
  s_barrier
  s_waitcnt vmcnt(24)
  ds_write_b128 v3, v[124:127] offset:16384
  ds_write_b128 v3, v[128:131] offset:17408
  s_barrier
  s_waitcnt vmcnt(22)
  ds_write_b128 v3, v[132:135] offset:24576
  ds_write_b128 v3, v[136:139] offset:25600
  s_waitcnt vmcnt(20)
  ds_write_b128 v3, v[140:143] offset:32768
  ds_write_b128 v3, v[144:147] offset:33792
  s_add_u32 s49, s47, 237568
  buffer_load_dwordx4 a[44:47], v5, s[20:23], s49 offen offset:0
  buffer_load_dwordx4 a[48:51], v5, s[20:23], s49 offen offset:1024
  s_waitcnt lgkmcnt(15)
  s_barrier
  s_waitcnt vmcnt(20)
  ds_write_b128 v3, v[148:151] offset:40960
  ds_write_b128 v3, v[152:155] offset:41984
  s_barrier
  s_waitcnt vmcnt(18)
  ds_write_b128 v2, v[156:159] offset:0
  ds_write_b128 v2, v[160:163] offset:1024
  s_waitcnt lgkmcnt(15)
  s_barrier
  s_waitcnt vmcnt(16)
  ds_write_b128 v2, v[164:167] offset:8192
  ds_write_b128 v2, v[168:171] offset:9216
  s_barrier
  s_waitcnt vmcnt(14)
  ds_write_b128 v2, v[172:175] offset:16384
  ds_write_b128 v2, v[176:179] offset:17408
  s_waitcnt vmcnt(12)
  ds_write_b128 v2, v[180:183] offset:24576
  ds_write_b128 v2, a[0:3] offset:25600
  s_add_u32 s49, s47, 245760
  buffer_load_dwordx4 a[52:55], v5, s[20:23], s49 offen offset:0
  buffer_load_dwordx4 a[56:59], v5, s[20:23], s49 offen offset:1024
  s_waitcnt lgkmcnt(15)
  s_barrier
  s_waitcnt vmcnt(12)
  ds_write_b128 v2, a[4:7] offset:32768
  ds_write_b128 v2, a[8:11] offset:33792
  s_barrier
  s_waitcnt vmcnt(10)
  ds_write_b128 v2, a[12:15] offset:40960
  ds_write_b128 v2, a[16:19] offset:41984
  s_waitcnt lgkmcnt(15)
  s_barrier
  s_waitcnt vmcnt(8)
  ds_write_b128 v2, a[20:23] offset:49152
  ds_write_b128 v2, a[24:27] offset:50176
  s_add_u32 s49, s47, 253952
  buffer_load_dwordx4 a[60:63], v5, s[20:23], s49 offen offset:0
  buffer_load_dwordx4 a[64:67], v5, s[20:23], s49 offen offset:1024
  s_barrier
  s_waitcnt vmcnt(8)
  ds_write_b128 v2, a[28:31] offset:57344
  ds_write_b128 v2, a[32:35] offset:58368
  s_waitcnt vmcnt(6)
  ds_write_b128 v3, a[36:39] offset:0
  ds_write_b128 v3, a[40:43] offset:1024
  s_waitcnt lgkmcnt(15)
  s_barrier
  s_waitcnt vmcnt(4)
  ds_write_b128 v3, a[44:47] offset:8192
  ds_write_b128 v3, a[48:51] offset:9216
  s_barrier
  s_add_u32 s49, s47, 262144
  buffer_load_dwordx4 v[60:63], v5, s[20:23], s49 offen offset:0
  buffer_load_dwordx4 v[64:67], v5, s[20:23], s49 offen offset:1024
  s_waitcnt lgkmcnt(15)
  s_barrier
  s_waitcnt lgkmcnt(14)
  s_barrier
  s_waitcnt vmcnt(4)
  ds_write_b128 v3, a[52:55] offset:16384
  ds_write_b128 v3, a[56:59] offset:17408
  s_add_u32 s49, s47, 270336
  s_add_u32 m0, s48, 106496
  s_nop 0
  buffer_load_dwordx4 v5, s[20:23], s49 offen offset:0 lds
  buffer_load_dwordx4 v5, s[20:23], s49 offen offset:1024 lds
  s_waitcnt lgkmcnt(14)
  s_barrier
  s_add_u32 s49, s44, 0
  s_add_u32 m0, s48, 0
  s_nop 0
  buffer_load_dwordx4 v5, s[20:23], s49 offen offset:0 lds
  buffer_load_dwordx4 v5, s[20:23], s49 offen offset:1024 lds
  s_waitcnt lgkmcnt(12)
  s_barrier
  s_add_u32 s49, s44, 8192
  s_add_u32 m0, s48, 8192
  s_nop 0
  buffer_load_dwordx4 v5, s[20:23], s49 offen offset:0 lds
  buffer_load_dwordx4 v5, s[20:23], s49 offen offset:1024 lds
  s_waitcnt lgkmcnt(8)
  s_barrier
  s_waitcnt vmcnt(8)
  ds_write_b128 v3, a[60:63] offset:24576
  ds_write_b128 v3, a[64:67] offset:25600
  s_add_u32 s49, s44, 16384
  s_add_u32 m0, s48, 16384
  s_nop 0
  buffer_load_dwordx4 v5, s[20:23], s49 offen offset:0 lds
  buffer_load_dwordx4 v5, s[20:23], s49 offen offset:1024 lds
  s_waitcnt lgkmcnt(8)
  s_barrier
  s_waitcnt vmcnt(8)
  ds_write_b128 v3, v[60:63] offset:32768
  ds_write_b128 v3, v[64:67] offset:33792
  s_add_u32 s49, s44, 24576
  s_add_u32 m0, s48, 24576
  s_nop 0
  buffer_load_dwordx4 v5, s[20:23], s49 offen offset:0 lds
  buffer_load_dwordx4 v5, s[20:23], s49 offen offset:1024 lds
  s_waitcnt lgkmcnt(8)
  s_barrier
  s_add_u32 s49, s44, 32768
  s_add_u32 m0, s48, 32768
  s_nop 0
  buffer_load_dwordx4 v5, s[20:23], s49 offen offset:0 lds
  buffer_load_dwordx4 v5, s[20:23], s49 offen offset:1024 lds
  s_waitcnt lgkmcnt(6)
  s_barrier
  s_add_u32 s49, s44, 40960
  s_add_u32 m0, s48, 40960
  s_nop 0
  buffer_load_dwordx4 v5, s[20:23], s49 offen offset:0 lds
  buffer_load_dwordx4 v5, s[20:23], s49 offen offset:1024 lds
  s_waitcnt lgkmcnt(2)
  s_barrier
  s_add_u32 s49, s44, 49152
  s_add_u32 m0, s48, 49152
  s_nop 0
  buffer_load_dwordx4 v5, s[20:23], s49 offen offset:0 lds
  buffer_load_dwordx4 v5, s[20:23], s49 offen offset:1024 lds
  s_waitcnt lgkmcnt(0)
  s_barrier
  s_add_u32 s49, s44, 57344
  s_add_u32 m0, s48, 57344
  s_nop 0
  buffer_load_dwordx4 v5, s[20:23], s49 offen offset:0 lds
  buffer_load_dwordx4 v5, s[20:23], s49 offen offset:1024 lds
  s_waitcnt vmcnt(16)
  s_barrier
  s_add_u32 s49, s44, 65536
  s_add_u32 m0, s48, 65536
  s_nop 0
  buffer_load_dwordx4 v5, s[20:23], s49 offen offset:0 lds
  buffer_load_dwordx4 v5, s[20:23], s49 offen offset:1024 lds
  s_barrier
  s_barrier
  s_add_u32 s49, s44, 73728
  s_add_u32 m0, s48, 73728
  s_nop 0
  buffer_load_dwordx4 v5, s[20:23], s49 offen offset:0 lds
  buffer_load_dwordx4 v5, s[20:23], s49 offen offset:1024 lds
  s_add_u32 s49, s44, 81920
  s_add_u32 m0, s48, 81920
  s_nop 0
  buffer_load_dwordx4 v5, s[20:23], s49 offen offset:0 lds
  buffer_load_dwordx4 v5, s[20:23], s49 offen offset:1024 lds
  s_add_u32 s49, s44, 90112
  s_add_u32 m0, s48, 90112
  s_nop 0
  buffer_load_dwordx4 v5, s[20:23], s49 offen offset:0 lds
  buffer_load_dwordx4 v5, s[20:23], s49 offen offset:1024 lds
  s_barrier
  s_waitcnt vmcnt(22)
  s_barrier
  s_waitcnt vmcnt(20)
  s_barrier
  s_add_u32 s49, s44, 98304
  s_add_u32 m0, s48, 98304
  s_nop 0
  buffer_load_dwordx4 v5, s[20:23], s49 offen offset:0 lds
  buffer_load_dwordx4 v5, s[20:23], s49 offen offset:1024 lds
  s_waitcnt vmcnt(20)
  s_barrier
  s_add_u32 s49, s44, 106496
  s_add_u32 m0, s48, 106496
  s_nop 0
  buffer_load_dwordx4 v5, s[20:23], s49 offen offset:0 lds
  buffer_load_dwordx4 v5, s[20:23], s49 offen offset:1024 lds
  s_waitcnt vmcnt(20)
  s_barrier
  s_add_u32 s49, s44, 114688
  s_add_u32 m0, s48, 0
  s_nop 0
  buffer_load_dwordx4 v5, s[20:23], s49 offen offset:0 lds
  buffer_load_dwordx4 v5, s[20:23], s49 offen offset:1024 lds
  s_waitcnt vmcnt(20)
  s_barrier
  s_waitcnt vmcnt(18)
  s_barrier
  s_add_u32 s49, s44, 122880
  s_add_u32 m0, s48, 8192
  s_nop 0
  buffer_load_dwordx4 v5, s[20:23], s49 offen offset:0 lds
  buffer_load_dwordx4 v5, s[20:23], s49 offen offset:1024 lds
  s_waitcnt vmcnt(18)
  s_barrier
  s_add_u32 s49, s44, 131072
  s_add_u32 m0, s48, 16384
  s_nop 0
  buffer_load_dwordx4 v5, s[20:23], s49 offen offset:0 lds
  buffer_load_dwordx4 v5, s[20:23], s49 offen offset:1024 lds
  s_waitcnt vmcnt(18)
  s_barrier
  s_add_u32 s49, s44, 139264
  s_add_u32 m0, s48, 24576
  s_nop 0
  buffer_load_dwordx4 v5, s[20:23], s49 offen offset:0 lds
  buffer_load_dwordx4 v5, s[20:23], s49 offen offset:1024 lds
  s_waitcnt vmcnt(18)
  s_barrier
  s_waitcnt vmcnt(16)
  s_barrier
  s_add_u32 s49, s44, 147456
  s_add_u32 m0, s48, 32768
  s_nop 0
  buffer_load_dwordx4 v5, s[20:23], s49 offen offset:0 lds
  buffer_load_dwordx4 v5, s[20:23], s49 offen offset:1024 lds
  s_waitcnt vmcnt(16)
  s_barrier
  s_add_u32 s49, s44, 155648
  s_add_u32 m0, s48, 40960
  s_nop 0
  buffer_load_dwordx4 v5, s[20:23], s49 offen offset:0 lds
  buffer_load_dwordx4 v5, s[20:23], s49 offen offset:1024 lds
  s_waitcnt vmcnt(16)
  s_barrier
  s_add_u32 s49, s45, 0
  s_add_u32 m0, s48, 49152
  s_nop 0
  buffer_load_dwordx4 v5, s[20:23], s49 offen offset:0 lds
  buffer_load_dwordx4 v5, s[20:23], s49 offen offset:1024 lds
  s_add_u32 s49, s45, 8192
  s_add_u32 m0, s48, 57344
  s_nop 0
  buffer_load_dwordx4 v5, s[20:23], s49 offen offset:0 lds
  buffer_load_dwordx4 v5, s[20:23], s49 offen offset:1024 lds
  s_waitcnt vmcnt(18)
  s_barrier
  s_add_u32 s49, s45, 16384
  s_add_u32 m0, s48, 65536
  s_nop 0
  buffer_load_dwordx4 v5, s[20:23], s49 offen offset:0 lds
  buffer_load_dwordx4 v5, s[20:23], s49 offen offset:1024 lds
  s_waitcnt vmcnt(18)
  s_barrier
  s_add_u32 s49, s45, 24576
  s_add_u32 m0, s48, 73728
  s_nop 0
  buffer_load_dwordx4 v5, s[20:23], s49 offen offset:0 lds
  buffer_load_dwordx4 v5, s[20:23], s49 offen offset:1024 lds
  s_waitcnt vmcnt(18)
  s_barrier
  s_add_u32 s49, s45, 32768
  s_add_u32 m0, s48, 81920
  s_nop 0
  buffer_load_dwordx4 v5, s[20:23], s49 offen offset:0 lds
  buffer_load_dwordx4 v5, s[20:23], s49 offen offset:1024 lds
  s_waitcnt vmcnt(18)
  s_barrier
  s_add_u32 s49, s45, 40960
  s_add_u32 m0, s48, 90112
  s_nop 0
  buffer_load_dwordx4 v5, s[20:23], s49 offen offset:0 lds
  buffer_load_dwordx4 v5, s[20:23], s49 offen offset:1024 lds
  s_add_u32 s49, s45, 49152
  s_add_u32 m0, s48, 98304
  s_nop 0
  buffer_load_dwordx4 v5, s[20:23], s49 offen offset:0 lds
  buffer_load_dwordx4 v5, s[20:23], s49 offen offset:1024 lds
  s_waitcnt vmcnt(20)
  s_barrier
  s_add_u32 s49, s45, 57344
  s_add_u32 m0, s48, 106496
  s_nop 0
  buffer_load_dwordx4 v5, s[20:23], s49 offen offset:0 lds
  buffer_load_dwordx4 v5, s[20:23], s49 offen offset:1024 lds
  s_waitcnt vmcnt(20)
  s_barrier
  s_add_u32 s49, s45, 65536
  s_add_u32 m0, s48, 0
  s_nop 0
  buffer_load_dwordx4 v5, s[20:23], s49 offen offset:0 lds
  buffer_load_dwordx4 v5, s[20:23], s49 offen offset:1024 lds
  s_waitcnt vmcnt(20)
  s_barrier
  s_add_u32 s49, s45, 73728
  s_add_u32 m0, s48, 8192
  s_nop 0
  buffer_load_dwordx4 v5, s[20:23], s49 offen offset:0 lds
  buffer_load_dwordx4 v5, s[20:23], s49 offen offset:1024 lds
  s_waitcnt vmcnt(20)
  s_barrier
  s_add_u32 s49, s45, 81920
  s_add_u32 m0, s48, 16384
  s_nop 0
  buffer_load_dwordx4 v5, s[20:23], s49 offen offset:0 lds
  buffer_load_dwordx4 v5, s[20:23], s49 offen offset:1024 lds
  s_add_u32 s49, s45, 90112
  s_add_u32 m0, s48, 24576
  s_nop 0
  buffer_load_dwordx4 v5, s[20:23], s49 offen offset:0 lds
  buffer_load_dwordx4 v5, s[20:23], s49 offen offset:1024 lds
  s_barrier
  s_add_u32 s49, s45, 98304
  s_add_u32 s51, s46, 4294963200
  s_cmp_lt_u32 s42, 2
  s_cselect_b32 s49, s49, s51
  s_add_u32 m0, s48, 32768
  s_nop 0
  buffer_load_dwordx4 v5, s[20:23], s49 offen offset:0 lds
  buffer_load_dwordx4 v5, s[20:23], s49 offen offset:1024 lds
  s_add_u32 s49, s46, 4096
  s_add_u32 m0, s48, 40960
  s_nop 0
  buffer_load_dwordx4 v5, s[20:23], s49 offen offset:0 lds
  buffer_load_dwordx4 v5, s[20:23], s49 offen offset:1024 lds
  s_add_u32 s49, s46, 12288
  buffer_load_dwordx4 v[68:71], v5, s[20:23], s49 offen offset:0
  buffer_load_dwordx4 v[72:75], v5, s[20:23], s49 offen offset:1024
  s_add_u32 s49, s46, 20480
  buffer_load_dwordx4 v[76:79], v5, s[20:23], s49 offen offset:0
  buffer_load_dwordx4 v[80:83], v5, s[20:23], s49 offen offset:1024
  s_add_u32 s49, s46, 28672
  buffer_load_dwordx4 v[84:87], v5, s[20:23], s49 offen offset:0
  buffer_load_dwordx4 v[88:91], v5, s[20:23], s49 offen offset:1024
  s_add_u32 s49, s46, 36864
  buffer_load_dwordx4 v[92:95], v5, s[20:23], s49 offen offset:0
  buffer_load_dwordx4 v[96:99], v5, s[20:23], s49 offen offset:1024
  s_add_u32 s49, s46, 45056
  buffer_load_dwordx4 v[100:103], v5, s[20:23], s49 offen offset:0
  buffer_load_dwordx4 v[104:107], v5, s[20:23], s49 offen offset:1024
  s_add_u32 s49, s46, 53248
  buffer_load_dwordx4 v[108:111], v5, s[20:23], s49 offen offset:0
  buffer_load_dwordx4 v[112:115], v5, s[20:23], s49 offen offset:1024
  s_add_u32 s49, s46, 61440
  buffer_load_dwordx4 v[116:119], v5, s[20:23], s49 offen offset:0
  buffer_load_dwordx4 v[120:123], v5, s[20:23], s49 offen offset:1024
  s_add_u32 s49, s46, 69632
  buffer_load_dwordx4 v[124:127], v5, s[20:23], s49 offen offset:0
  buffer_load_dwordx4 v[128:131], v5, s[20:23], s49 offen offset:1024
  s_barrier
  s_barrier
  s_add_u32 s49, s46, 77824
  buffer_load_dwordx4 v[132:135], v5, s[20:23], s49 offen offset:0
  buffer_load_dwordx4 v[136:139], v5, s[20:23], s49 offen offset:1024
  s_add_u32 s49, s46, 86016
  buffer_load_dwordx4 v[140:143], v5, s[20:23], s49 offen offset:0
  buffer_load_dwordx4 v[144:147], v5, s[20:23], s49 offen offset:1024
  s_add_u32 s49, s46, 94208
  buffer_load_dwordx4 v[148:151], v5, s[20:23], s49 offen offset:0
  buffer_load_dwordx4 v[152:155], v5, s[20:23], s49 offen offset:1024
  s_add_u32 s49, s46, 102400
  buffer_load_dwordx4 v[156:159], v5, s[20:23], s49 offen offset:0
  buffer_load_dwordx4 v[160:163], v5, s[20:23], s49 offen offset:1024
  s_add_u32 s49, s46, 110592
  buffer_load_dwordx4 v[164:167], v5, s[20:23], s49 offen offset:0
  buffer_load_dwordx4 v[168:171], v5, s[20:23], s49 offen offset:1024
  s_add_u32 s49, s46, 118784
  buffer_load_dwordx4 v[172:175], v5, s[20:23], s49 offen offset:0
  buffer_load_dwordx4 v[176:179], v5, s[20:23], s49 offen offset:1024
  s_lshr_b32 s53, s42, 1
  s_lshl_b32 s49, s41, 1
  s_add_u32 s49, s49, s53
  s_mul_i32 s49, s49, 6144
  s_and_b32 s50, s42, 1
  s_mul_i32 s51, s50, 2016
  s_add_u32 s49, s49, s51
  s_add_u32 s49, s49, 0x1450000
  v_mov_b32 v18, 0x80000000
  v_cmp_gt_u32 vcc, 62, v1
  s_mul_i32 s51, s42, 1008
  s_add_u32 s51, s51, 151616
  v_cndmask_b32 v17, v18, v5, vcc
  v_lshlrev_b32 v18, 3, v1
  v_add_u32 v18, s51, v18
  s_mov_b32 s52, 0x41800000
  s_mov_b32 s58, 0
kv1_poll:
  buffer_load_dwordx4 v[20:23], v5, s[20:23], s49 offen sc1
  buffer_load_dwordx4 v[24:27], v17, s[20:23], s49 offen offset:1024 sc1
  s_add_u32 s58, s58, 1
  s_waitcnt vmcnt(0)
  v_cmp_eq_u32 s[50:51], s52, v23
  v_cmp_eq_u32 vcc, s52, v27
  s_or_b32 s50, s50, 0x55555555
  s_or_b32 s51, s51, 0x55555555
  s_or_b32 vcc_lo, vcc_lo, 0x55555555
  s_or_b32 vcc_hi, vcc_hi, 0xd5555555
  s_and_b64 vcc, vcc, s[50:51]
  s_cmp_eq_u64 vcc, -1
  s_cbranch_scc1 kv1_ok
  s_cmp_lg_u32 s19, 0
  s_cbranch_scc1 kv1_ok
  s_cmp_lt_u32 s58, 131072
  s_cbranch_scc1 kv1_poll
  s_mov_b32 s19, 1
kv1_ok:
  v_cvt_pk_bf16_f32 v20, v20, v21
  v_cvt_pk_bf16_f32 v21, v22, v23
  v_cvt_pk_bf16_f32 v24, v24, v25
  v_cvt_pk_bf16_f32 v25, v26, v27
  ds_write_b64 v18, v[20:21]
  s_mov_b32 exec_hi, 0x3fffffff
  ds_write_b64 v18, v[24:25] offset:512
  s_mov_b64 exec, -1
  s_waitcnt lgkmcnt(0)
  s_barrier
  s_add_u32 s49, s46, 126976
  buffer_load_dwordx4 v[180:183], v5, s[20:23], s49 offen offset:0
  buffer_load_dwordx4 a[0:3], v5, s[20:23], s49 offen offset:1024
  s_add_u32 s49, s46, 135168
  buffer_load_dwordx4 a[4:7], v5, s[20:23], s49 offen offset:0
  buffer_load_dwordx4 a[8:11], v5, s[20:23], s49 offen offset:1024
  s_barrier
  s_barrier
  s_barrier
  s_barrier
  ds_write_b128 v2, v[68:71] offset:49152
  ds_write_b128 v2, v[72:75] offset:50176
  s_barrier
  ds_write_b128 v2, v[76:79] offset:57344
  ds_write_b128 v2, v[80:83] offset:58368
  s_add_u32 s49, s47, 0
  buffer_load_dwordx4 a[12:15], v5, s[20:23], s49 offen offset:0
  buffer_load_dwordx4 a[16:19], v5, s[20:23], s49 offen offset:1024
  s_barrier
  ds_write_b128 v3, v[84:87] offset:0
  ds_write_b128 v3, v[88:91] offset:1024
  s_barrier
  ds_write_b128 v3, v[92:95] offset:8192
  ds_write_b128 v3, v[96:99] offset:9216
  ds_write_b128 v3, v[100:103] offset:16384
  ds_write_b128 v3, v[104:107] offset:17408
  s_barrier
  ds_write_b128 v3, v[108:111] offset:24576
  ds_write_b128 v3, v[112:115] offset:25600
  s_add_u32 s49, s47, 8192
  buffer_load_dwordx4 a[20:23], v5, s[20:23], s49 offen offset:0
  buffer_load_dwordx4 a[24:27], v5, s[20:23], s49 offen offset:1024
  s_barrier
  ds_write_b128 v3, v[116:119] offset:32768
  ds_write_b128 v3, v[120:123] offset:33792
  s_barrier
  ds_write_b128 v3, v[124:127] offset:40960
  ds_write_b128 v3, v[128:131] offset:41984
  s_barrier
  ds_write_b128 v2, v[132:135] offset:0
  ds_write_b128 v2, v[136:139] offset:1024
  ds_write_b128 v2, v[140:143] offset:8192
  ds_write_b128 v2, v[144:147] offset:9216
  s_barrier
  ds_write_b128 v2, v[148:151] offset:16384
  ds_write_b128 v2, v[152:155] offset:17408
  ds_write_b128 v2, v[156:159] offset:24576
  ds_write_b128 v2, v[160:163] offset:25600
  s_add_u32 s49, s47, 16384
  buffer_load_dwordx4 a[28:31], v5, s[20:23], s49 offen offset:0
  buffer_load_dwordx4 a[32:35], v5, s[20:23], s49 offen offset:1024
  s_barrier
  s_add_u32 s49, s47, 24576
  buffer_load_dwordx4 a[36:39], v5, s[20:23], s49 offen offset:0
  buffer_load_dwordx4 a[40:43], v5, s[20:23], s49 offen offset:1024
  s_add_u32 s49, s47, 32768
  buffer_load_dwordx4 a[44:47], v5, s[20:23], s49 offen offset:0
  buffer_load_dwordx4 a[48:51], v5, s[20:23], s49 offen offset:1024
  s_add_u32 s49, s47, 40960
  buffer_load_dwordx4 a[52:55], v5, s[20:23], s49 offen offset:0
  buffer_load_dwordx4 a[56:59], v5, s[20:23], s49 offen offset:1024
  s_add_u32 s49, s47, 49152
  buffer_load_dwordx4 a[60:63], v5, s[20:23], s49 offen offset:0
  buffer_load_dwordx4 a[64:67], v5, s[20:23], s49 offen offset:1024
  s_barrier
  s_barrier
  s_add_u32 s49, s47, 57344
  buffer_load_dwordx4 v[60:63], v5, s[20:23], s49 offen offset:0
  buffer_load_dwordx4 v[64:67], v5, s[20:23], s49 offen offset:1024
  s_waitcnt lgkmcnt(15)
  s_barrier
  s_add_u32 s49, s47, 65536
  buffer_load_dwordx4 v[68:71], v5, s[20:23], s49 offen offset:0
  buffer_load_dwordx4 v[72:75], v5, s[20:23], s49 offen offset:1024
  s_barrier
  ds_write_b128 v2, v[164:167] offset:32768
  ds_write_b128 v2, v[168:171] offset:33792
  s_add_u32 s49, s47, 73728
  buffer_load_dwordx4 v[76:79], v5, s[20:23], s49 offen offset:0
  buffer_load_dwordx4 v[80:83], v5, s[20:23], s49 offen offset:1024
  s_barrier
  ds_write_b128 v2, v[172:175] offset:40960
  ds_write_b128 v2, v[176:179] offset:41984
  s_barrier
  s_waitcnt vmcnt(22)
  ds_write_b128 v2, v[180:183] offset:49152
  ds_write_b128 v2, a[0:3] offset:50176
  s_add_u32 s49, s47, 81920
  buffer_load_dwordx4 v[84:87], v5, s[20:23], s49 offen offset:0
  buffer_load_dwordx4 v[88:91], v5, s[20:23], s49 offen offset:1024
  s_barrier
  s_waitcnt vmcnt(22)
  ds_write_b128 v2, a[4:7] offset:57344
  ds_write_b128 v2, a[8:11] offset:58368
  s_add_u32 s49, s47, 90112
  buffer_load_dwordx4 v[92:95], v5, s[20:23], s49 offen offset:0
  buffer_load_dwordx4 v[96:99], v5, s[20:23], s49 offen offset:1024
  s_waitcnt lgkmcnt(15)
  s_barrier
  s_add_u32 s49, s47, 98304
  buffer_load_dwordx4 v[100:103], v5, s[20:23], s49 offen offset:0
  buffer_load_dwordx4 v[104:107], v5, s[20:23], s49 offen offset:1024
  s_barrier
  s_waitcnt vmcnt(24)
  ds_write_b128 v3, a[12:15] offset:0
  ds_write_b128 v3, a[16:19] offset:1024
  s_barrier
  s_waitcnt vmcnt(22)
  ds_write_b128 v3, a[20:23] offset:8192
  ds_write_b128 v3, a[24:27] offset:9216
  s_add_u32 s49, s47, 106496
  buffer_load_dwordx4 v[108:111], v5, s[20:23], s49 offen offset:0
  buffer_load_dwordx4 v[112:115], v5, s[20:23], s49 offen offset:1024
  s_barrier
  s_waitcnt vmcnt(22)
  ds_write_b128 v3, a[28:31] offset:16384
  ds_write_b128 v3, a[32:35] offset:17408
  s_add_u32 s49, s47, 114688
  buffer_load_dwordx4 v[116:119], v5, s[20:23], s49 offen offset:0
  buffer_load_dwordx4 v[120:123], v5, s[20:23], s49 offen offset:1024
  s_waitcnt lgkmcnt(15)
  s_barrier
  s_waitcnt vmcnt(22)
  ds_write_b128 v3, a[36:39] offset:24576
  ds_write_b128 v3, a[40:43] offset:25600
  s_add_u32 s49, s47, 122880
  buffer_load_dwordx4 v[124:127], v5, s[20:23], s49 offen offset:0
  buffer_load_dwordx4 v[128:131], v5, s[20:23], s49 offen offset:1024
  s_barrier
  s_waitcnt vmcnt(22)
  ds_write_b128 v3, a[44:47] offset:32768
  ds_write_b128 v3, a[48:51] offset:33792
  s_barrier
  s_waitcnt vmcnt(20)
  ds_write_b128 v3, a[52:55] offset:40960
  ds_write_b128 v3, a[56:59] offset:41984
  s_add_u32 s49, s47, 131072
  buffer_load_dwordx4 v[132:135], v5, s[20:23], s49 offen offset:0
  buffer_load_dwordx4 v[136:139], v5, s[20:23], s49 offen offset:1024
  s_barrier
  s_waitcnt vmcnt(20)
  ds_write_b128 v2, a[60:63] offset:0
  ds_write_b128 v2, a[64:67] offset:1024
  s_add_u32 s49, s47, 139264
  buffer_load_dwordx4 v[140:143], v5, s[20:23], s49 offen offset:0
  buffer_load_dwordx4 v[144:147], v5, s[20:23], s49 offen offset:1024
  s_waitcnt lgkmcnt(15)
  s_barrier
  s_add_u32 s49, s47, 147456
  buffer_load_dwordx4 v[148:151], v5, s[20:23], s49 offen offset:0
  buffer_load_dwordx4 v[152:155], v5, s[20:23], s49 offen offset:1024
  s_barrier
  s_waitcnt vmcnt(22)
  ds_write_b128 v2, v[60:63] offset:8192
  ds_write_b128 v2, v[64:67] offset:9216
  s_barrier
  s_waitcnt vmcnt(20)
  ds_write_b128 v2, v[68:71] offset:16384
  ds_write_b128 v2, v[72:75] offset:17408
  s_add_u32 s49, s47, 155648
  buffer_load_dwordx4 v[156:159], v5, s[20:23], s49 offen offset:0
  buffer_load_dwordx4 v[160:163], v5, s[20:23], s49 offen offset:1024
  s_barrier
  s_waitcnt vmcnt(20)
  ds_write_b128 v2, v[76:79] offset:24576
  ds_write_b128 v2, v[80:83] offset:25600
  s_add_u32 s49, s47, 163840
  buffer_load_dwordx4 v[164:167], v5, s[20:23], s49 offen offset:0
  buffer_load_dwordx4 v[168:171], v5, s[20:23], s49 offen offset:1024
  s_waitcnt lgkmcnt(15)
  s_barrier
  s_waitcnt vmcnt(20)
  ds_write_b128 v2, v[84:87] offset:32768
  ds_write_b128 v2, v[88:91] offset:33792
  s_add_u32 s49, s47, 172032
  buffer_load_dwordx4 v[172:175], v5, s[20:23], s49 offen offset:0
  buffer_load_dwordx4 v[176:179], v5, s[20:23], s49 offen offset:1024
  s_barrier
  s_waitcnt vmcnt(20)
  ds_write_b128 v2, v[92:95] offset:40960
  ds_write_b128 v2, v[96:99] offset:41984
  s_barrier
  s_waitcnt vmcnt(18)
  ds_write_b128 v2, v[100:103] offset:49152
  ds_write_b128 v2, v[104:107] offset:50176
  s_waitcnt vmcnt(16)
  ds_write_b128 v2, v[108:111] offset:57344
  ds_write_b128 v2, v[112:115] offset:58368
  s_add_u32 s49, s47, 180224
  buffer_load_dwordx4 v[180:183], v5, s[20:23], s49 offen offset:0
  buffer_load_dwordx4 a[0:3], v5, s[20:23], s49 offen offset:1024
  s_add_u32 s49, s47, 188416
  buffer_load_dwordx4 a[4:7], v5, s[20:23], s49 offen offset:0
  buffer_load_dwordx4 a[8:11], v5, s[20:23], s49 offen offset:1024
  s_add_u32 s49, s47, 196608
  buffer_load_dwordx4 a[12:15], v5, s[20:23], s49 offen offset:0
  buffer_load_dwordx4 a[16:19], v5, s[20:23], s49 offen offset:1024
  s_add_u32 s49, s47, 204800
  buffer_load_dwordx4 a[20:23], v5, s[20:23], s49 offen offset:0
  buffer_load_dwordx4 a[24:27], v5, s[20:23], s49 offen offset:1024
  s_add_u32 s49, s47, 212992
  s_waitcnt lgkmcnt(15)
  buffer_load_dwordx4 a[28:31], v5, s[20:23], s49 offen offset:0
  buffer_load_dwordx4 a[32:35], v5, s[20:23], s49 offen offset:1024
  s_add_u32 s49, s47, 221184
  buffer_load_dwordx4 a[36:39], v5, s[20:23], s49 offen offset:0
  buffer_load_dwordx4 a[40:43], v5, s[20:23], s49 offen offset:1024
  s_add_u32 s49, s47, 229376
  buffer_load_dwordx4 a[44:47], v5, s[20:23], s49 offen offset:0
  buffer_load_dwordx4 a[48:51], v5, s[20:23], s49 offen offset:1024
  s_add_u32 s49, s47, 237568
  buffer_load_dwordx4 a[52:55], v5, s[20:23], s49 offen offset:0
  buffer_load_dwordx4 a[56:59], v5, s[20:23], s49 offen offset:1024
  s_barrier
  s_barrier
  s_add_u32 s49, s47, 245760
  s_waitcnt lgkmcnt(14)
  buffer_load_dwordx4 a[60:63], v5, s[20:23], s49 offen offset:0
  buffer_load_dwordx4 a[64:67], v5, s[20:23], s49 offen offset:1024
  s_barrier
  s_barrier
  s_waitcnt vmcnt(32)
  ds_write_b128 v3, v[116:119] offset:0
  ds_write_b128 v3, v[120:123] offset:1024
  s_barrier
  s_waitcnt vmcnt(30)
  ds_write_b128 v3, v[124:127] offset:8192
  ds_write_b128 v3, v[128:131] offset:9216
  s_add_u32 s49, s47, 253952
  s_waitcnt lgkmcnt(15)
  buffer_load_dwordx4 v[60:63], v5, s[20:23], s49 offen offset:0
  buffer_load_dwordx4 v[64:67], v5, s[20:23], s49 offen offset:1024
  s_barrier
  s_waitcnt vmcnt(30)
  ds_write_b128 v3, v[132:135] offset:16384
  ds_write_b128 v3, v[136:139] offset:17408
  s_barrier
  s_waitcnt vmcnt(28)
  ds_write_b128 v3, v[140:143] offset:24576
  ds_write_b128 v3, v[144:147] offset:25600
  s_waitcnt vmcnt(26)
  ds_write_b128 v3, v[148:151] offset:32768
  ds_write_b128 v3, v[152:155] offset:33792
  s_waitcnt lgkmcnt(15)
  s_barrier
  s_waitcnt vmcnt(24)
  ds_write_b128 v3, v[156:159] offset:40960
  ds_write_b128 v3, v[160:163] offset:41984
  s_add_u32 s49, s47, 262144
  buffer_load_dwordx4 v[68:71], v5, s[20:23], s49 offen offset:0
  buffer_load_dwordx4 v[72:75], v5, s[20:23], s49 offen offset:1024
  s_barrier
  s_waitcnt vmcnt(24)
  ds_write_b128 v2, v[164:167] offset:0
  ds_write_b128 v2, v[168:171] offset:1024
  s_waitcnt lgkmcnt(15)
  s_barrier
  s_waitcnt vmcnt(22)
  ds_write_b128 v2, v[172:175] offset:8192
  ds_write_b128 v2, v[176:179] offset:9216
  s_barrier
  s_waitcnt vmcnt(20)
  ds_write_b128 v2, v[180:183] offset:16384
  ds_write_b128 v2, a[0:3] offset:17408
  s_waitcnt vmcnt(18)
  ds_write_b128 v2, a[4:7] offset:24576
  ds_write_b128 v2, a[8:11] offset:25600
  s_waitcnt lgkmcnt(15)
  s_barrier
  s_waitcnt vmcnt(16)
  ds_write_b128 v2, a[12:15] offset:32768
  ds_write_b128 v2, a[16:19] offset:33792
  s_add_u32 s49, s47, 270336
  buffer_load_dwordx4 v[76:79], v5, s[20:23], s49 offen offset:0
  buffer_load_dwordx4 v[80:83], v5, s[20:23], s49 offen offset:1024
  s_barrier
  s_waitcnt vmcnt(16)
  ds_write_b128 v2, a[20:23] offset:40960
  ds_write_b128 v2, a[24:27] offset:41984
  s_waitcnt lgkmcnt(15)
  s_barrier
  s_waitcnt vmcnt(14)
  ds_write_b128 v2, a[28:31] offset:49152
  ds_write_b128 v2, a[32:35] offset:50176
  s_barrier
  s_waitcnt vmcnt(12)
  ds_write_b128 v2, a[36:39] offset:57344
  ds_write_b128 v2, a[40:43] offset:58368
  s_waitcnt vmcnt(10)
  ds_write_b128 v3, a[44:47] offset:0
  ds_write_b128 v3, a[48:51] offset:1024
  s_waitcnt lgkmcnt(15)
  s_barrier
  s_waitcnt vmcnt(8)
  ds_write_b128 v3, a[52:55] offset:8192
  ds_write_b128 v3, a[56:59] offset:9216
  s_barrier
  s_waitcnt vmcnt(6)
  ds_write_b128 v3, a[60:63] offset:16384
  ds_write_b128 v3, a[64:67] offset:17408
  s_waitcnt lgkmcnt(15)
  s_barrier
  s_waitcnt vmcnt(4)
  ds_write_b128 v3, v[60:63] offset:24576
  ds_write_b128 v3, v[64:67] offset:25600
  s_barrier
  s_waitcnt vmcnt(2)
  ds_write_b128 v3, v[68:71] offset:32768
  ds_write_b128 v3, v[72:75] offset:33792
  s_waitcnt lgkmcnt(15)
  s_barrier
  s_waitcnt vmcnt(0)
  ds_write_b128 v3, v[76:79] offset:40960
  ds_write_b128 v3, v[80:83] offset:41984
  s_barrier
  s_waitcnt lgkmcnt(14)
  s_barrier
  s_waitcnt lgkmcnt(12)
  s_barrier
  s_waitcnt lgkmcnt(10)
  s_barrier
  s_waitcnt lgkmcnt(8)
  s_barrier
  s_waitcnt lgkmcnt(4)
  s_barrier
  s_waitcnt lgkmcnt(2)
  s_barrier
  s_waitcnt lgkmcnt(0)
  s_barrier
  s_barrier
  s_barrier
  s_barrier
  s_waitcnt vmcnt(0) lgkmcnt(0)
  s_endpgm
main_done:
  s_endpgm
.section .rodata,"a"
.p2align 6
.amdhsa_kernel interleave_layers__linear_kernel_hedgehog__mixer_channel_mlp__prompt_kernel
  .amdhsa_next_free_vgpr 256
  .amdhsa_next_free_sgpr 102
  .amdhsa_accum_offset 184
  .amdhsa_group_segment_fixed_size 0
  .amdhsa_kernarg_size 96
  .amdhsa_user_sgpr_count 2
  .amdhsa_user_sgpr_kernarg_segment_ptr 1
  .amdhsa_system_sgpr_workgroup_id_x 1
.end_amdhsa_kernel
.text
```
